```python
import torch

def _softmax(x, axis=-1):
    return torch.softmax(x, dim=axis)
def _gelu(x):
    return torch.nn.functional.gelu(x, approximate="tanh")
def _silu(x):
    return torch.nn.functional.silu(x)
def _sigmoid(x):
    return torch.sigmoid(x)
def _layernorm(x, axis=-1, eps=1e-5):
    m = x.mean(dim=axis, keepdim=True)
    v = x.var(dim=axis, keepdim=True, unbiased=False)
    return (x - m) / torch.sqrt(v + eps)
def _scatter_add(tgt, idx, src, axis=0):
    return tgt.clone().index_add_(axis, idx, src)
def _segment_sum(src, seg, n):
    out = torch.zeros((n,) + src.shape[1:], dtype=src.dtype)
    return out.index_add_(0, seg, src)
def _pad(x, pw):
    flat = tuple(v for pair in reversed(pw) for v in pair)
    return torch.nn.functional.pad(x, flat)

kernel_name = 'interleave_layers__grouped_kv_mqa__glu_gated_glu__prompt'

def setup_inputs():

    _w = (lambda a: (lambda t: t.to(torch.bfloat16) if t.is_floating_point() else t)(torch.as_tensor(a)))
    def _A_setup():
        B, S, D, H = 1, 2048, 448, 16
        Dh = D // H
        return {
            "x": _w((lambda *s: torch.randn(*s, dtype=torch.bfloat16) * 0.05)(B, S, D)),
            "wq": _w((lambda *s: torch.randn(*s, dtype=torch.bfloat16) * 0.05)(D, H * Dh)),
            "wk": _w((lambda *s: torch.randn(*s, dtype=torch.bfloat16) * 0.05)(D, Dh)),
            "wv": _w((lambda *s: torch.randn(*s, dtype=torch.bfloat16) * 0.05)(D, Dh)),
            "wo": _w((lambda *s: torch.randn(*s, dtype=torch.bfloat16) * 0.05)(H * Dh, D)),
        }
    _A_in = _A_setup()

    def _B_setup():
        B, S, D, F = 1, 2048, 448, 1792
        return {
            "x": _w((lambda *s: torch.randn(*s, dtype=torch.bfloat16) * 0.05)(B, S, D)),
            "w_gate": _w((lambda *s: torch.randn(*s, dtype=torch.bfloat16) * 0.05)(D, F)),
            "w_up": _w((lambda *s: torch.randn(*s, dtype=torch.bfloat16) * 0.05)(D, F)),
            "w_down": _w((lambda *s: torch.randn(*s, dtype=torch.bfloat16) * 0.05)(F, D)),
        }
    _B_in = _B_setup()

    return {
        "A_x": _A_in["x"],
        "A_wq": _A_in["wq"],
        "A_wk": _A_in["wk"],
        "A_wv": _A_in["wv"],
        "A_wo": _A_in["wo"],
        "B_x": _B_in["x"],
        "B_w_gate": _B_in["w_gate"],
        "B_w_up": _B_in["w_up"],
        "B_w_down": _B_in["w_down"],
    }

def reference(A_x, A_wq, A_wk, A_wv, A_wo, B_x, B_w_gate, B_w_up, B_w_down):
    def _A_ref(x, wq, wk, wv, wo):
        B, S, D = x.shape
        H = 16
        Dh = D // H
        q = (lambda x, *d: x.permute(*d))((x @ wq).reshape(B, S, H, Dh), 0, 2, 1, 3)
        k = x @ wk
        v = x @ wv
        scores = torch.einsum("bhqd,bkd->bhqk", q, k) * (Dh ** -0.5)
        p = _softmax(scores, axis=-1)
        o = torch.einsum("bhqk,bkd->bhqd", p, v)
        return (lambda x, *d: x.permute(*d))(o, 0, 2, 1, 3).reshape(B, S, H * Dh) @ wo

    def _B_ref(x, w_gate, w_up, w_down):
        g = torch.einsum("bsd,df->bsf", x, w_gate)
        u = torch.einsum("bsd,df->bsf", x, w_up)
        h = _sigmoid(g) * u
        return torch.einsum("bsf,fd->bsd", h, w_down)

    x = A_x
    x = x + _A_ref(_layernorm(x, axis=-1), A_wq, A_wk, A_wv, A_wo)
    x = x + _B_ref(_layernorm(x, axis=-1), B_w_gate, B_w_up, B_w_down)
    x = x + _A_ref(_layernorm(x, axis=-1), A_wq, A_wk, A_wv, A_wo)
    x = x + _B_ref(_layernorm(x, axis=-1), B_w_gate, B_w_up, B_w_down)
    return x
```

```asm
; @launch grid=(256,1,1) block=(256,1,1) lds=155648
.amdgcn_target "amdgcn-amd-amdhsa--gfx950"
.text
.globl interleave_layers__grouped_kv_mqa__glu_gated_glu__prompt_kernel
.p2align 8
.type interleave_layers__grouped_kv_mqa__glu_gated_glu__prompt_kernel,@function
interleave_layers__grouped_kv_mqa__glu_gated_glu__prompt_kernel:
    s_cmp_ge_u32 s2, 256
    s_cbranch_scc1 Lfin_2
    s_load_dwordx2 s[8:9], s[0:1], 88
    v_lshrrev_b32 v1, 6, v0
    v_and_b32 v13, 63, v0
    s_getreg_b32 s57, hwreg(HW_REG_XCC_ID, 0, 4)
    v_readfirstlane_b32 s3, v1
    v_and_b32 v1, 31, v13
    v_lshrrev_b32 v2, 5, v13
    v_lshlrev_b32 v0, 4, v13
    v_lshlrev_b32 v13, 2, v13
    s_mov_b32 s10, 15767552
    s_mov_b32 s11, 0x20000
    s_mov_b32 s39, 0
    s_mov_b32 s37, 0
    s_mov_b32 s7, 0
    s_getpc_b64 s[24:25]
Lpc:
    s_lshr_b32 s26, s2, 3
    s_lshl_b32 s26, s26, 2
    s_add_u32 s26, s26, s3
    s_lshl_b32 s26, s26, 10
    v_add_u32 v8, s26, v0
    v_min_u32 v8, Lcode_end-Lpc-16, v8
    v_mov_b32 v9, s25
    v_add_co_u32 v8, vcc, s24, v8
    v_addc_co_u32 v9, vcc, 0, v9, vcc
    global_load_dwordx4 v[244:247], v[8:9], off
    s_waitcnt lgkmcnt(0)
    s_mov_b32 s26, 15766528
    s_load_dword s56, s[8:9], s26
    s_cmp_ge_u32 s2, 192
    s_cbranch_scc1 Lprep_12
    s_cmp_ge_u32 s2, 191
    s_cbranch_scc1 Lprep_13
    s_cmp_ge_u32 s2, 142
    s_cbranch_scc1 Lprep_11
    s_cmp_ge_u32 s2, 128
    s_cbranch_scc1 Lprep_10
    s_cmp_ge_u32 s2, 112
    s_cbranch_scc1 Lprep_9
    s_cmp_ge_u32 s2, 56
    s_cbranch_scc1 Lprep_8
    s_load_dwordx2 s[12:13], s[0:1], 48
    s_mov_b32 s14, 1605632
    s_mov_b32 s15, 0x20000
    s_mov_b32 s49, s2
    s_mov_b32 s50, 0
    s_branch Lprep_14
Lprep_8:
    s_load_dwordx2 s[12:13], s[0:1], 56
    s_mov_b32 s14, 1605632
    s_mov_b32 s15, 0x20000
    s_sub_u32 s49, s2, 56
    s_mov_b32 s50, 64
Lprep_14:
    s_and_b32 s44, s49, 7
    s_mul_i32 s44, s44, 7
    s_lshr_b32 s49, s49, 3
    s_add_u32 s49, s49, s44
    s_mul_i32 s44, s3, 401408
    s_lshl_b32 s45, s49, 6
    s_add_u32 s44, s44, s45
    s_mul_i32 s45, s49, 57344
    s_mul_i32 s46, s3, 7168
    s_add_u32 s45, s45, s46
    s_add_u32 s45, s45, 974848
    v_lshrrev_b32 v6, 4, v1
    v_and_b32 v7, 15, v1
    v_mul_u32_u24 v5, 28672, v6
    v_lshl_add_u32 v5, v2, 9, v5
    v_lshl_add_u32 v5, v7, 4, v5
    v_lshlrev_b32 v6, 7, v6
    v_lshl_add_u32 v6, v7, 2, v6
    v_add_u32 v6, s50, v6
    s_lshl_b32 s50, s50, 2
    v_add_u32 v5, s50, v5
    s_lshl_b32 s48, s49, 8
    s_add_u32 s48, s48, 5793792
    v_lshrrev_b32 v4, 6, v0
    v_mul_u32_u24 v4, 3584, v4
    v_and_b32 v8, 48, v0
    v_add_u32 v4, v4, v8
    s_lshl_b32 s47, s3, 14
    s_waitcnt lgkmcnt(0)
    s_add_u32 s46, s44, 0
    s_add_u32 m0, s47, 0
    s_nop 0
    buffer_load_dwordx4 v4, s[12:15], s46 offen lds
    s_add_u32 s46, s44, 57344
    s_add_u32 m0, s47, 1024
    s_nop 0
    buffer_load_dwordx4 v4, s[12:15], s46 offen lds
    s_add_u32 s46, s44, 114688
    s_add_u32 m0, s47, 2048
    s_nop 0
    buffer_load_dwordx4 v4, s[12:15], s46 offen lds
    s_add_u32 s46, s44, 172032
    s_add_u32 m0, s47, 3072
    s_nop 0
    buffer_load_dwordx4 v4, s[12:15], s46 offen lds
    s_add_u32 s46, s44, 229376
    s_add_u32 m0, s47, 4096
    s_nop 0
    buffer_load_dwordx4 v4, s[12:15], s46 offen lds
    s_add_u32 s46, s44, 286720
    s_add_u32 m0, s47, 5120
    s_nop 0
    buffer_load_dwordx4 v4, s[12:15], s46 offen lds
    s_add_u32 s46, s44, 344064
    s_add_u32 m0, s47, 6144
    s_nop 0
    buffer_load_dwordx4 v4, s[12:15], s46 offen lds
    v_bfe_u32 v8, v1, 2, 2
    v_lshl_add_u32 v8, v2, 2, v8
    v_mul_u32_u24 v9, 64, v8
    v_lshrrev_b32 v8, 4, v1
    v_lshl_add_u32 v9, v8, 5, v9
    v_and_b32 v8, 3, v1
    v_lshl_add_u32 v9, v8, 3, v9
    v_add_u32 v9, s47, v9
    v_mov_b32 v10, 0
    v_mov_b32 v11, 0
    v_mov_b32 v12, 0x3f803f80
    s_waitcnt vmcnt(6)
    ds_read_b64_tr_b16 v[16:17], v9 offset:0
    ds_read_b64_tr_b16 v[18:19], v9 offset:512
    s_waitcnt vmcnt(5)
    ds_read_b64_tr_b16 v[20:21], v9 offset:1024
    ds_read_b64_tr_b16 v[22:23], v9 offset:1536
    s_add_u32 s46, s45, 0
    s_waitcnt lgkmcnt(2)
    buffer_store_dwordx4 v[16:19], v5, s[8:11], s46 offen offset:0 sc1
    v_dot2c_f32_bf16 v10, v16, v12
    v_dot2c_f32_bf16 v11, v17, v12
    v_dot2c_f32_bf16 v10, v18, v12
    v_dot2c_f32_bf16 v11, v19, v12
    s_waitcnt vmcnt(5)
    ds_read_b64_tr_b16 v[24:25], v9 offset:2048
    ds_read_b64_tr_b16 v[26:27], v9 offset:2560
    s_add_u32 s46, s45, 1024
    s_waitcnt lgkmcnt(2)
    buffer_store_dwordx4 v[20:23], v5, s[8:11], s46 offen offset:0 sc1
    v_dot2c_f32_bf16 v10, v20, v12
    v_dot2c_f32_bf16 v11, v21, v12
    v_dot2c_f32_bf16 v10, v22, v12
    v_dot2c_f32_bf16 v11, v23, v12
    s_waitcnt vmcnt(5)
    ds_read_b64_tr_b16 v[28:29], v9 offset:3072
    ds_read_b64_tr_b16 v[30:31], v9 offset:3584
    s_add_u32 s46, s45, 2048
    s_waitcnt lgkmcnt(2)
    buffer_store_dwordx4 v[24:27], v5, s[8:11], s46 offen offset:0 sc1
    v_dot2c_f32_bf16 v10, v24, v12
    v_dot2c_f32_bf16 v11, v25, v12
    v_dot2c_f32_bf16 v10, v26, v12
    v_dot2c_f32_bf16 v11, v27, v12
    s_waitcnt vmcnt(5)
    ds_read_b64_tr_b16 v[32:33], v9 offset:4096
    ds_read_b64_tr_b16 v[34:35], v9 offset:4608
    s_add_u32 s46, s45, 3072
    s_waitcnt lgkmcnt(2)
    buffer_store_dwordx4 v[28:31], v5, s[8:11], s46 offen offset:0 sc1
    v_dot2c_f32_bf16 v10, v28, v12
    v_dot2c_f32_bf16 v11, v29, v12
    v_dot2c_f32_bf16 v10, v30, v12
    v_dot2c_f32_bf16 v11, v31, v12
    s_waitcnt vmcnt(5)
    ds_read_b64_tr_b16 v[36:37], v9 offset:5120
    ds_read_b64_tr_b16 v[38:39], v9 offset:5632
    s_add_u32 s46, s45, 4096
    s_waitcnt lgkmcnt(2)
    buffer_store_dwordx4 v[32:35], v5, s[8:11], s46 offen offset:0 sc1
    v_dot2c_f32_bf16 v10, v32, v12
    v_dot2c_f32_bf16 v11, v33, v12
    v_dot2c_f32_bf16 v10, v34, v12
    v_dot2c_f32_bf16 v11, v35, v12
    s_waitcnt vmcnt(5)
    ds_read_b64_tr_b16 v[40:41], v9 offset:6144
    ds_read_b64_tr_b16 v[42:43], v9 offset:6656
    s_add_u32 s46, s45, 5120
    s_waitcnt lgkmcnt(2)
    buffer_store_dwordx4 v[36:39], v5, s[8:11], s46 offen offset:0 sc1
    v_dot2c_f32_bf16 v10, v36, v12
    v_dot2c_f32_bf16 v11, v37, v12
    v_dot2c_f32_bf16 v10, v38, v12
    v_dot2c_f32_bf16 v11, v39, v12
    s_add_u32 s46, s45, 6144
    s_waitcnt lgkmcnt(0)
    buffer_store_dwordx4 v[40:43], v5, s[8:11], s46 offen offset:0 sc1
    v_dot2c_f32_bf16 v10, v40, v12
    v_dot2c_f32_bf16 v11, v41, v12
    v_dot2c_f32_bf16 v10, v42, v12
    v_dot2c_f32_bf16 v11, v43, v12
    s_nop 2
    v_add_f32 v10, v10, v11
    v_mov_b32 v11, v10
    s_nop 1
    v_permlane32_swap_b32 v11, v10
    s_nop 1
    v_add_f32 v10, v10, v11
    s_lshl_b32 s30, s3, 7
    v_lshl_add_u32 v11, v1, 2, s30
    v_add_u32 v11, 151552, v11
    ds_write_b32 v11, v10
    s_waitcnt lgkmcnt(0)
    s_barrier
    v_lshlrev_b32 v11, 2, v1
    v_add_u32 v11, 151552, v11
    ds_read2_b32 v[8:9], v11 offset1:32
    ds_read2_b32 v[10:11], v11 offset0:64 offset1:96
    s_waitcnt lgkmcnt(0)
    v_add_f32 v8, v8, v9
    v_add_f32 v10, v10, v11
    v_add_f32 v10, v10, v8
    s_cmp_lg_u32 s3, 0
    s_cbranch_scc1 Lcs_15
    s_mov_b32 exec_hi, 0
    buffer_store_dword v10, v6, s[8:11], s48 offen sc1
    s_mov_b32 exec_hi, -1
Lcs_15:
    s_branch Lpdone_3
Lprep_9:
    s_and_b32 s49, s2, 7
    s_lshl_b32 s49, s49, 1
    s_bfe_u32 s44, s2, 0x10003
    s_add_u32 s49, s49, s44
    s_load_dwordx2 s[12:13], s[0:1], 8
    s_mov_b32 s14, 401408
    s_mov_b32 s15, 0x20000
    s_mul_i32 s44, s3, 100352
    s_mul_i32 s45, s49, 56
    s_add_u32 s44, s44, s45
    s_mul_i32 s45, s49, 28672
    s_mul_i32 s46, s3, 7168
    s_add_u32 s45, s45, s46
    s_add_u32 s45, s45, 0
    v_lshlrev_b32 v6, 2, v1
    s_lshl_b32 s48, s49, 7
    s_add_u32 s48, s48, 5791744
    v_lshrrev_b32 v4, 6, v0
    v_mul_u32_u24 v4, 896, v4
    v_and_b32 v8, 48, v0
    v_add_u32 v4, v4, v8
    s_lshl_b32 s47, s3, 14
    s_waitcnt lgkmcnt(0)
    s_add_u32 s46, s44, 0
    s_add_u32 m0, s47, 0
    s_nop 0
    buffer_load_dwordx4 v4, s[12:15], s46 offen lds
    s_add_u32 s46, s44, 14336
    s_add_u32 m0, s47, 1024
    s_nop 0
    buffer_load_dwordx4 v4, s[12:15], s46 offen lds
    s_add_u32 s46, s44, 28672
    s_add_u32 m0, s47, 2048
    s_nop 0
    buffer_load_dwordx4 v4, s[12:15], s46 offen lds
    s_add_u32 s46, s44, 43008
    s_add_u32 m0, s47, 3072
    s_nop 0
    buffer_load_dwordx4 v4, s[12:15], s46 offen lds
    s_add_u32 s46, s44, 57344
    s_add_u32 m0, s47, 4096
    s_nop 0
    buffer_load_dwordx4 v4, s[12:15], s46 offen lds
    s_add_u32 s46, s44, 71680
    s_add_u32 m0, s47, 5120
    s_nop 0
    buffer_load_dwordx4 v4, s[12:15], s46 offen lds
    s_add_u32 s46, s44, 86016
    s_add_u32 m0, s47, 6144
    s_nop 0
    buffer_load_dwordx4 v4, s[12:15], s46 offen lds
    v_bfe_u32 v8, v1, 2, 2
    v_lshl_add_u32 v8, v2, 2, v8
    v_mul_u32_u24 v9, 64, v8
    v_lshrrev_b32 v8, 4, v1
    v_lshl_add_u32 v9, v8, 5, v9
    v_and_b32 v8, 3, v1
    v_lshl_add_u32 v9, v8, 3, v9
    v_add_u32 v9, s47, v9
    v_mov_b32 v10, 0
    v_mov_b32 v11, 0
    v_mov_b32 v12, 0x3f803f80
    s_waitcnt vmcnt(6)
    ds_read_b64_tr_b16 v[16:17], v9 offset:0
    ds_read_b64_tr_b16 v[18:19], v9 offset:512
    s_waitcnt vmcnt(5)
    ds_read_b64_tr_b16 v[20:21], v9 offset:1024
    ds_read_b64_tr_b16 v[22:23], v9 offset:1536
    s_add_u32 s46, s45, 0
    s_waitcnt lgkmcnt(2)
    buffer_store_dwordx4 v[16:19], v0, s[8:11], s46 offen offset:0 sc1
    v_dot2c_f32_bf16 v10, v16, v12
    v_dot2c_f32_bf16 v11, v17, v12
    v_dot2c_f32_bf16 v10, v18, v12
    v_dot2c_f32_bf16 v11, v19, v12
    s_waitcnt vmcnt(5)
    ds_read_b64_tr_b16 v[24:25], v9 offset:2048
    ds_read_b64_tr_b16 v[26:27], v9 offset:2560
    s_add_u32 s46, s45, 1024
    s_waitcnt lgkmcnt(2)
    buffer_store_dwordx4 v[20:23], v0, s[8:11], s46 offen offset:0 sc1
    v_dot2c_f32_bf16 v10, v20, v12
    v_dot2c_f32_bf16 v11, v21, v12
    v_dot2c_f32_bf16 v10, v22, v12
    v_dot2c_f32_bf16 v11, v23, v12
    s_waitcnt vmcnt(5)
    ds_read_b64_tr_b16 v[28:29], v9 offset:3072
    ds_read_b64_tr_b16 v[30:31], v9 offset:3584
    s_add_u32 s46, s45, 2048
    s_waitcnt lgkmcnt(2)
    buffer_store_dwordx4 v[24:27], v0, s[8:11], s46 offen offset:0 sc1
    v_dot2c_f32_bf16 v10, v24, v12
    v_dot2c_f32_bf16 v11, v25, v12
    v_dot2c_f32_bf16 v10, v26, v12
    v_dot2c_f32_bf16 v11, v27, v12
    s_waitcnt vmcnt(5)
    ds_read_b64_tr_b16 v[32:33], v9 offset:4096
    ds_read_b64_tr_b16 v[34:35], v9 offset:4608
    s_add_u32 s46, s45, 3072
    s_waitcnt lgkmcnt(2)
    buffer_store_dwordx4 v[28:31], v0, s[8:11], s46 offen offset:0 sc1
    v_dot2c_f32_bf16 v10, v28, v12
    v_dot2c_f32_bf16 v11, v29, v12
    v_dot2c_f32_bf16 v10, v30, v12
    v_dot2c_f32_bf16 v11, v31, v12
    s_waitcnt vmcnt(5)
    ds_read_b64_tr_b16 v[36:37], v9 offset:5120
    ds_read_b64_tr_b16 v[38:39], v9 offset:5632
    s_add_u32 s46, s45, 4096
    s_waitcnt lgkmcnt(2)
    buffer_store_dwordx4 v[32:35], v0, s[8:11], s46 offen offset:0 sc1
    v_dot2c_f32_bf16 v10, v32, v12
    v_dot2c_f32_bf16 v11, v33, v12
    v_dot2c_f32_bf16 v10, v34, v12
    v_dot2c_f32_bf16 v11, v35, v12
    s_waitcnt vmcnt(5)
    ds_read_b64_tr_b16 v[40:41], v9 offset:6144
    ds_read_b64_tr_b16 v[42:43], v9 offset:6656
    s_add_u32 s46, s45, 5120
    s_waitcnt lgkmcnt(2)
    buffer_store_dwordx4 v[36:39], v0, s[8:11], s46 offen offset:0 sc1
    v_dot2c_f32_bf16 v10, v36, v12
    v_dot2c_f32_bf16 v11, v37, v12
    v_dot2c_f32_bf16 v10, v38, v12
    v_dot2c_f32_bf16 v11, v39, v12
    s_add_u32 s46, s45, 6144
    s_waitcnt lgkmcnt(0)
    buffer_store_dwordx4 v[40:43], v0, s[8:11], s46 offen offset:0 sc1
    v_dot2c_f32_bf16 v10, v40, v12
    v_dot2c_f32_bf16 v11, v41, v12
    v_dot2c_f32_bf16 v10, v42, v12
    v_dot2c_f32_bf16 v11, v43, v12
    s_nop 2
    v_add_f32 v10, v10, v11
    v_mov_b32 v11, v10
    s_nop 1
    v_permlane32_swap_b32 v11, v10
    s_nop 1
    v_add_f32 v10, v10, v11
    s_lshl_b32 s30, s3, 7
    v_lshl_add_u32 v11, v1, 2, s30
    v_add_u32 v11, 151552, v11
    ds_write_b32 v11, v10
    s_waitcnt lgkmcnt(0)
    s_barrier
    v_lshlrev_b32 v11, 2, v1
    v_add_u32 v11, 151552, v11
    ds_read2_b32 v[8:9], v11 offset1:32
    ds_read2_b32 v[10:11], v11 offset0:64 offset1:96
    s_waitcnt lgkmcnt(0)
    v_add_f32 v8, v8, v9
    v_add_f32 v10, v10, v11
    v_add_f32 v10, v10, v8
    s_cmp_lg_u32 s3, 0
    s_cbranch_scc1 Lcs_16
    s_mov_b32 exec_hi, 0
    buffer_store_dword v10, v6, s[8:11], s48 offen sc1
    s_mov_b32 exec_hi, -1
Lcs_16:
    s_branch Lpdone_3
Lprep_10:
    s_and_b32 s49, s2, 7
    s_lshl_b32 s49, s49, 1
    s_bfe_u32 s44, s2, 0x10003
    s_add_u32 s49, s49, s44
    s_load_dwordx2 s[12:13], s[0:1], 32
    s_mov_b32 s14, 401408
    s_mov_b32 s15, 0x20000
    s_lshr_b32 s45, s49, 1
    s_add_u32 s45, s45, 6
    s_cmp_ge_u32 s49, 12
    s_cselect_b32 s49, s45, s49
    s_mul_i32 s44, s3, 100352
    s_lshl_b32 s45, s49, 6
    s_add_u32 s44, s44, s45
    s_lshl_b32 s45, s49, 15
    s_lshl_b32 s46, s3, 13
    s_add_u32 s45, s45, s46
    s_add_u32 s45, s45, 516096
    v_lshrrev_b32 v4, 6, v0
    v_mul_u32_u24 v4, 896, v4
    v_and_b32 v8, 48, v0
    v_add_u32 v4, v4, v8
    s_lshl_b32 s47, s3, 14
    s_waitcnt lgkmcnt(0)
    s_add_u32 s46, s44, 0
    s_add_u32 m0, s47, 0
    s_nop 0
    buffer_load_dwordx4 v4, s[12:15], s46 offen lds
    s_add_u32 s46, s44, 14336
    s_add_u32 m0, s47, 1024
    s_nop 0
    buffer_load_dwordx4 v4, s[12:15], s46 offen lds
    s_add_u32 s46, s44, 25088
    s_add_u32 m0, s47, 2048
    s_nop 0
    buffer_load_dwordx4 v4, s[12:15], s46 offen lds
    s_add_u32 s46, s44, 39424
    s_add_u32 m0, s47, 3072
    s_nop 0
    buffer_load_dwordx4 v4, s[12:15], s46 offen lds
    s_add_u32 s46, s44, 50176
    s_add_u32 m0, s47, 4096
    s_nop 0
    buffer_load_dwordx4 v4, s[12:15], s46 offen lds
    s_add_u32 s46, s44, 64512
    s_add_u32 m0, s47, 5120
    s_nop 0
    buffer_load_dwordx4 v4, s[12:15], s46 offen lds
    s_add_u32 s46, s44, 75264
    s_add_u32 m0, s47, 6144
    s_nop 0
    buffer_load_dwordx4 v4, s[12:15], s46 offen lds
    s_add_u32 s46, s44, 89600
    s_add_u32 m0, s47, 7168
    s_nop 0
    buffer_load_dwordx4 v4, s[12:15], s46 offen lds
    v_bfe_u32 v8, v1, 2, 2
    v_lshl_add_u32 v8, v2, 2, v8
    v_mul_u32_u24 v9, 64, v8
    v_lshrrev_b32 v8, 4, v1
    v_lshl_add_u32 v9, v8, 5, v9
    v_and_b32 v8, 3, v1
    v_lshl_add_u32 v9, v8, 3, v9
    v_add_u32 v9, s47, v9
    s_waitcnt vmcnt(7)
    ds_read_b64_tr_b16 v[16:17], v9 offset:0
    ds_read_b64_tr_b16 v[18:19], v9 offset:512
    s_waitcnt vmcnt(6)
    ds_read_b64_tr_b16 v[20:21], v9 offset:1024
    ds_read_b64_tr_b16 v[22:23], v9 offset:1536
    s_add_u32 s46, s45, 0
    s_waitcnt lgkmcnt(2)
    buffer_store_dwordx4 v[16:19], v0, s[8:11], s46 offen offset:0 sc1
    s_waitcnt vmcnt(6)
    ds_read_b64_tr_b16 v[24:25], v9 offset:2048
    ds_read_b64_tr_b16 v[26:27], v9 offset:2560
    s_add_u32 s46, s45, 1024
    s_waitcnt lgkmcnt(2)
    s_mov_b32 exec_lo, 0
    v_mov_b32 v22, 0
    v_mov_b32 v23, 0
    s_mov_b32 exec_lo, -1
    buffer_store_dwordx4 v[20:23], v0, s[8:11], s46 offen offset:0 sc1
    s_waitcnt vmcnt(6)
    ds_read_b64_tr_b16 v[28:29], v9 offset:3072
    ds_read_b64_tr_b16 v[30:31], v9 offset:3584
    s_add_u32 s46, s45, 2048
    s_waitcnt lgkmcnt(2)
    buffer_store_dwordx4 v[24:27], v0, s[8:11], s46 offen offset:0 sc1
    s_waitcnt vmcnt(6)
    ds_read_b64_tr_b16 v[32:33], v9 offset:4096
    ds_read_b64_tr_b16 v[34:35], v9 offset:4608
    s_add_u32 s46, s45, 3072
    s_waitcnt lgkmcnt(2)
    s_mov_b32 exec_lo, 0
    v_mov_b32 v30, 0
    v_mov_b32 v31, 0
    s_mov_b32 exec_lo, -1
    buffer_store_dwordx4 v[28:31], v0, s[8:11], s46 offen offset:0 sc1
    s_waitcnt vmcnt(6)
    ds_read_b64_tr_b16 v[36:37], v9 offset:5120
    ds_read_b64_tr_b16 v[38:39], v9 offset:5632
    s_add_u32 s46, s45, 4096
    s_waitcnt lgkmcnt(2)
    buffer_store_dwordx4 v[32:35], v0, s[8:11], s46 offen offset:0 sc1
    s_waitcnt vmcnt(6)
    ds_read_b64_tr_b16 v[40:41], v9 offset:6144
    ds_read_b64_tr_b16 v[42:43], v9 offset:6656
    s_add_u32 s46, s45, 5120
    s_waitcnt lgkmcnt(2)
    s_mov_b32 exec_lo, 0
    v_mov_b32 v38, 0
    v_mov_b32 v39, 0
    s_mov_b32 exec_lo, -1
    buffer_store_dwordx4 v[36:39], v0, s[8:11], s46 offen offset:0 sc1
    s_waitcnt vmcnt(6)
    ds_read_b64_tr_b16 v[44:45], v9 offset:7168
    ds_read_b64_tr_b16 v[46:47], v9 offset:7680
    s_add_u32 s46, s45, 6144
    s_waitcnt lgkmcnt(2)
    buffer_store_dwordx4 v[40:43], v0, s[8:11], s46 offen offset:0 sc1
    s_add_u32 s46, s45, 7168
    s_waitcnt lgkmcnt(0)
    s_mov_b32 exec_lo, 0
    v_mov_b32 v46, 0
    v_mov_b32 v47, 0
    s_mov_b32 exec_lo, -1
    buffer_store_dwordx4 v[44:47], v0, s[8:11], s46 offen offset:0 sc1
    s_branch Lpdone_3
Lprep_11:
    s_sub_u32 s49, s2, 142
    s_load_dwordx2 s[12:13], s[0:1], 64
    s_mov_b32 s14, 1605632
    s_mov_b32 s15, 0x20000
    s_lshl_b32 s49, s49, 2
    s_add_u32 s49, s49, s3
    s_lshr_b32 s50, s49, 1
    s_mul_i32 s50, s50, 9363
    s_lshr_b32 s50, s50, 16
    s_mul_i32 s51, s50, 14
    s_sub_u32 s51, s49, s51
    s_mul_i32 s44, s50, 114688
    s_lshl_b32 s45, s51, 6
    s_add_u32 s44, s44, s45
    s_mul_i32 s45, s51, 114688
    s_lshl_b32 s46, s50, 13
    s_add_u32 s45, s45, s46
    s_add_u32 s45, s45, 4186112
    v_lshrrev_b32 v4, 6, v0
    v_mul_u32_u24 v4, 896, v4
    v_and_b32 v8, 48, v0
    v_add_u32 v4, v4, v8
    s_lshl_b32 s47, s3, 14
    s_waitcnt lgkmcnt(0)
    s_add_u32 s46, s44, 0
    s_add_u32 m0, s47, 0
    s_nop 0
    buffer_load_dwordx4 v4, s[12:15], s46 offen lds
    s_add_u32 s46, s44, 14336
    s_add_u32 m0, s47, 1024
    s_nop 0
    buffer_load_dwordx4 v4, s[12:15], s46 offen lds
    s_add_u32 s46, s44, 28672
    s_add_u32 m0, s47, 2048
    s_nop 0
    buffer_load_dwordx4 v4, s[12:15], s46 offen lds
    s_add_u32 s46, s44, 43008
    s_add_u32 m0, s47, 3072
    s_nop 0
    buffer_load_dwordx4 v4, s[12:15], s46 offen lds
    s_add_u32 s46, s44, 57344
    s_add_u32 m0, s47, 4096
    s_nop 0
    buffer_load_dwordx4 v4, s[12:15], s46 offen lds
    s_add_u32 s46, s44, 71680
    s_add_u32 m0, s47, 5120
    s_nop 0
    buffer_load_dwordx4 v4, s[12:15], s46 offen lds
    s_add_u32 s46, s44, 86016
    s_add_u32 m0, s47, 6144
    s_nop 0
    buffer_load_dwordx4 v4, s[12:15], s46 offen lds
    s_add_u32 s46, s44, 100352
    s_add_u32 m0, s47, 7168
    s_nop 0
    buffer_load_dwordx4 v4, s[12:15], s46 offen lds
    v_bfe_u32 v8, v1, 2, 2
    v_lshl_add_u32 v8, v2, 2, v8
    v_mul_u32_u24 v9, 64, v8
    v_lshrrev_b32 v8, 4, v1
    v_lshl_add_u32 v9, v8, 5, v9
    v_and_b32 v8, 3, v1
    v_lshl_add_u32 v9, v8, 3, v9
    v_add_u32 v9, s47, v9
    s_waitcnt vmcnt(7)
    ds_read_b64_tr_b16 v[16:17], v9 offset:0
    ds_read_b64_tr_b16 v[18:19], v9 offset:512
    s_waitcnt vmcnt(6)
    ds_read_b64_tr_b16 v[20:21], v9 offset:1024
    ds_read_b64_tr_b16 v[22:23], v9 offset:1536
    s_add_u32 s46, s45, 0
    s_waitcnt lgkmcnt(2)
    buffer_store_dwordx4 v[16:19], v0, s[8:11], s46 offen offset:0 sc1
    s_waitcnt vmcnt(6)
    ds_read_b64_tr_b16 v[24:25], v9 offset:2048
    ds_read_b64_tr_b16 v[26:27], v9 offset:2560
    s_add_u32 s46, s45, 1024
    s_waitcnt lgkmcnt(2)
    buffer_store_dwordx4 v[20:23], v0, s[8:11], s46 offen offset:0 sc1
    s_waitcnt vmcnt(6)
    ds_read_b64_tr_b16 v[28:29], v9 offset:3072
    ds_read_b64_tr_b16 v[30:31], v9 offset:3584
    s_add_u32 s46, s45, 2048
    s_waitcnt lgkmcnt(2)
    buffer_store_dwordx4 v[24:27], v0, s[8:11], s46 offen offset:0 sc1
    s_waitcnt vmcnt(6)
    ds_read_b64_tr_b16 v[32:33], v9 offset:4096
    ds_read_b64_tr_b16 v[34:35], v9 offset:4608
    s_add_u32 s46, s45, 3072
    s_waitcnt lgkmcnt(2)
    buffer_store_dwordx4 v[28:31], v0, s[8:11], s46 offen offset:0 sc1
    s_waitcnt vmcnt(6)
    ds_read_b64_tr_b16 v[36:37], v9 offset:5120
    ds_read_b64_tr_b16 v[38:39], v9 offset:5632
    s_add_u32 s46, s45, 4096
    s_waitcnt lgkmcnt(2)
    buffer_store_dwordx4 v[32:35], v0, s[8:11], s46 offen offset:0 sc1
    s_waitcnt vmcnt(6)
    ds_read_b64_tr_b16 v[40:41], v9 offset:6144
    ds_read_b64_tr_b16 v[42:43], v9 offset:6656
    s_add_u32 s46, s45, 5120
    s_waitcnt lgkmcnt(2)
    buffer_store_dwordx4 v[36:39], v0, s[8:11], s46 offen offset:0 sc1
    s_waitcnt vmcnt(6)
    ds_read_b64_tr_b16 v[44:45], v9 offset:7168
    ds_read_b64_tr_b16 v[46:47], v9 offset:7680
    s_add_u32 s46, s45, 6144
    s_waitcnt lgkmcnt(2)
    buffer_store_dwordx4 v[40:43], v0, s[8:11], s46 offen offset:0 sc1
    s_add_u32 s46, s45, 7168
    s_waitcnt lgkmcnt(0)
    buffer_store_dwordx4 v[44:47], v0, s[8:11], s46 offen offset:0 sc1
    s_branch Lpdone_3
Lprep_13:
    s_load_dwordx2 s[16:17], s[0:1], 16
    s_mov_b32 s18, 25088
    s_mov_b32 s19, 0x20000
    s_load_dwordx2 s[20:21], s[0:1], 24
    s_mov_b32 s22, 25088
    s_mov_b32 s23, 0x20000
    s_mul_i32 s45, s3, 6272
    s_mul_i32 s47, s3, 14336
    s_waitcnt lgkmcnt(0)
    s_add_u32 s46, s45, 0
    s_add_u32 m0, s47, 0
    s_nop 0
    buffer_load_dwordx4 v0, s[16:19], s46 offen offset:0 lds
    buffer_load_dwordx4 v0, s[16:19], s46 offen offset:1024 lds
    buffer_load_dwordx4 v0, s[16:19], s46 offen offset:2048 lds
    buffer_load_dwordx4 v0, s[16:19], s46 offen offset:3072 lds
    s_add_u32 s46, s45, 4096
    s_add_u32 m0, s47, 4096
    s_nop 0
    buffer_load_dwordx4 v0, s[16:19], s46 offen offset:0 lds
    buffer_load_dwordx4 v0, s[16:19], s46 offen offset:1024 lds
    buffer_load_dwordx4 v0, s[16:19], s46 offen offset:2048 lds
    s_add_u32 s46, s45, 0
    s_add_u32 m0, s47, 7168
    s_nop 0
    buffer_load_dwordx4 v0, s[20:23], s46 offen offset:0 lds
    buffer_load_dwordx4 v0, s[20:23], s46 offen offset:1024 lds
    buffer_load_dwordx4 v0, s[20:23], s46 offen offset:2048 lds
    buffer_load_dwordx4 v0, s[20:23], s46 offen offset:3072 lds
    s_add_u32 s46, s45, 4096
    s_add_u32 m0, s47, 11264
    s_nop 0
    buffer_load_dwordx4 v0, s[20:23], s46 offen offset:0 lds
    buffer_load_dwordx4 v0, s[20:23], s46 offen offset:1024 lds
    buffer_load_dwordx4 v0, s[20:23], s46 offen offset:2048 lds
    v_bfe_u32 v8, v1, 2, 2
    v_lshl_add_u32 v8, v2, 2, v8
    v_mul_u32_u24 v5, 56, v8
    v_lshrrev_b32 v8, 4, v1
    v_lshl_add_u32 v5, v8, 5, v5
    v_and_b32 v8, 3, v1
    v_lshl_add_u32 v5, v8, 3, v5
    v_add_u32 v5, s47, v5
    s_waitcnt vmcnt(0)
    ds_read_b64_tr_b16 v[132:133], v5 offset:0
    ds_read_b64_tr_b16 v[134:135], v5 offset:448
    ds_read_b64_tr_b16 v[136:137], v5 offset:896
    ds_read_b64_tr_b16 v[138:139], v5 offset:1344
    ds_read_b64_tr_b16 v[140:141], v5 offset:1792
    ds_read_b64_tr_b16 v[142:143], v5 offset:2240
    ds_read_b64_tr_b16 v[144:145], v5 offset:2688
    ds_read_b64_tr_b16 v[146:147], v5 offset:3136
    ds_read_b64_tr_b16 v[148:149], v5 offset:3584
    ds_read_b64_tr_b16 v[150:151], v5 offset:4032
    ds_read_b64_tr_b16 v[152:153], v5 offset:4480
    ds_read_b64_tr_b16 v[154:155], v5 offset:4928
    ds_read_b64_tr_b16 v[156:157], v5 offset:5376
    ds_read_b64_tr_b16 v[158:159], v5 offset:5824
    ds_read_b64_tr_b16 v[160:161], v5 offset:7168
    ds_read_b64_tr_b16 v[162:163], v5 offset:7616
    ds_read_b64_tr_b16 v[164:165], v5 offset:8064
    ds_read_b64_tr_b16 v[166:167], v5 offset:8512
    ds_read_b64_tr_b16 v[168:169], v5 offset:8960
    ds_read_b64_tr_b16 v[170:171], v5 offset:9408
    ds_read_b64_tr_b16 v[172:173], v5 offset:9856
    ds_read_b64_tr_b16 v[174:175], v5 offset:10304
    ds_read_b64_tr_b16 v[176:177], v5 offset:10752
    ds_read_b64_tr_b16 v[178:179], v5 offset:11200
    ds_read_b64_tr_b16 v[180:181], v5 offset:11648
    ds_read_b64_tr_b16 v[182:183], v5 offset:12096
    ds_read_b64_tr_b16 v[184:185], v5 offset:12544
    ds_read_b64_tr_b16 v[186:187], v5 offset:12992
    s_add_u32 s44, s47, 458752
    s_waitcnt lgkmcnt(0)
    buffer_store_dwordx4 v[132:135], v0, s[8:11], s44 offen offset:0 sc1
    buffer_store_dwordx4 v[136:139], v0, s[8:11], s44 offen offset:1024 sc1
    buffer_store_dwordx4 v[140:143], v0, s[8:11], s44 offen offset:2048 sc1
    buffer_store_dwordx4 v[144:147], v0, s[8:11], s44 offen offset:3072 sc1
    s_add_u32 s44, s44, 4096
    buffer_store_dwordx4 v[148:151], v0, s[8:11], s44 offen offset:0 sc1
    buffer_store_dwordx4 v[152:155], v0, s[8:11], s44 offen offset:1024 sc1
    buffer_store_dwordx4 v[156:159], v0, s[8:11], s44 offen offset:2048 sc1
    buffer_store_dwordx4 v[160:163], v0, s[8:11], s44 offen offset:3072 sc1
    s_add_u32 s44, s44, 4096
    buffer_store_dwordx4 v[164:167], v0, s[8:11], s44 offen offset:0 sc1
    buffer_store_dwordx4 v[168:171], v0, s[8:11], s44 offen offset:1024 sc1
    buffer_store_dwordx4 v[172:175], v0, s[8:11], s44 offen offset:2048 sc1
    buffer_store_dwordx4 v[176:179], v0, s[8:11], s44 offen offset:3072 sc1
    s_add_u32 s44, s44, 4096
    buffer_store_dwordx4 v[180:183], v0, s[8:11], s44 offen offset:0 sc1
    buffer_store_dwordx4 v[184:187], v0, s[8:11], s44 offen offset:1024 sc1
    s_branch Lpdone_3
Lprep_12:
    s_sub_u32 s49, s2, 192
    s_load_dwordx2 s[12:13], s[0:1], 0
    s_mov_b32 s14, 1835008
    s_mov_b32 s15, 0x20000
    s_load_dwordx2 s[16:17], s[0:1], 16
    s_mov_b32 s18, 25088
    s_mov_b32 s19, 0x20000
    s_load_dwordx2 s[20:21], s[0:1], 24
    s_mov_b32 s22, 25088
    s_mov_b32 s23, 0x20000
    v_mul_u32_u24 v4, 896, v1
    v_lshl_add_u32 v4, v2, 4, v4
    s_mul_i32 s44, s49, 28672
    s_mul_i32 s45, s3, 224
    s_add_u32 s44, s44, s45
    s_mul_i32 s45, s3, 6272
    s_mul_i32 s47, s3, 14336
    s_waitcnt lgkmcnt(0)
    buffer_load_dwordx4 v[16:19], v4, s[12:15], s44 offen offset:0
    buffer_load_dwordx4 v[20:23], v4, s[12:15], s44 offen offset:32
    buffer_load_dwordx4 v[24:27], v4, s[12:15], s44 offen offset:64
    buffer_load_dwordx4 v[28:31], v4, s[12:15], s44 offen offset:96
    buffer_load_dwordx4 v[32:35], v4, s[12:15], s44 offen offset:128
    buffer_load_dwordx4 v[36:39], v4, s[12:15], s44 offen offset:160
    buffer_load_dwordx4 v[40:43], v4, s[12:15], s44 offen offset:192
    s_add_u32 s46, s45, 0
    s_add_u32 m0, s47, 0
    s_nop 0
    buffer_load_dwordx4 v0, s[16:19], s46 offen offset:0 lds
    buffer_load_dwordx4 v0, s[16:19], s46 offen offset:1024 lds
    buffer_load_dwordx4 v0, s[16:19], s46 offen offset:2048 lds
    buffer_load_dwordx4 v0, s[16:19], s46 offen offset:3072 lds
    s_add_u32 s46, s45, 4096
    s_add_u32 m0, s47, 4096
    s_nop 0
    buffer_load_dwordx4 v0, s[16:19], s46 offen offset:0 lds
    buffer_load_dwordx4 v0, s[16:19], s46 offen offset:1024 lds
    buffer_load_dwordx4 v0, s[16:19], s46 offen offset:2048 lds
    s_add_u32 s46, s45, 0
    s_add_u32 m0, s47, 7168
    s_nop 0
    buffer_load_dwordx4 v0, s[20:23], s46 offen offset:0 lds
    buffer_load_dwordx4 v0, s[20:23], s46 offen offset:1024 lds
    buffer_load_dwordx4 v0, s[20:23], s46 offen offset:2048 lds
    buffer_load_dwordx4 v0, s[20:23], s46 offen offset:3072 lds
    s_add_u32 s46, s45, 4096
    s_add_u32 m0, s47, 11264
    s_nop 0
    buffer_load_dwordx4 v0, s[20:23], s46 offen offset:0 lds
    buffer_load_dwordx4 v0, s[20:23], s46 offen offset:1024 lds
    buffer_load_dwordx4 v0, s[20:23], s46 offen offset:2048 lds
    v_bfe_u32 v8, v1, 2, 2
    v_lshl_add_u32 v8, v2, 2, v8
    v_mul_u32_u24 v5, 56, v8
    v_lshrrev_b32 v8, 4, v1
    v_lshl_add_u32 v5, v8, 5, v5
    v_and_b32 v8, 3, v1
    v_lshl_add_u32 v5, v8, 3, v5
    v_add_u32 v5, s47, v5
    s_mul_i32 s44, s49, 28672
    s_mul_i32 s45, s3, 7168
    s_add_u32 s44, s44, s45
    s_add_u32 s44, s44, 5809152
    v_mov_b32 v6, 0
    v_mov_b32 v7, 0
    v_mov_b32 v12, 0x3f803f80
    s_waitcnt vmcnt(14)
    v_permlane32_swap_b32 v16, v18
    v_permlane32_swap_b32 v17, v19
    s_nop 0
    buffer_store_dwordx4 v[16:19], v0, s[8:11], s44 offen offset:0 sc1
    v_dot2c_f32_bf16 v6, v16, v12
    v_dot2c_f32_bf16 v7, v16, v16
    v_dot2c_f32_bf16 v6, v17, v12
    v_dot2c_f32_bf16 v7, v17, v17
    v_dot2c_f32_bf16 v6, v18, v12
    v_dot2c_f32_bf16 v7, v18, v18
    v_dot2c_f32_bf16 v6, v19, v12
    v_dot2c_f32_bf16 v7, v19, v19
    v_permlane32_swap_b32 v20, v22
    v_permlane32_swap_b32 v21, v23
    s_nop 0
    buffer_store_dwordx4 v[20:23], v0, s[8:11], s44 offen offset:1024 sc1
    v_dot2c_f32_bf16 v6, v20, v12
    v_dot2c_f32_bf16 v7, v20, v20
    v_dot2c_f32_bf16 v6, v21, v12
    v_dot2c_f32_bf16 v7, v21, v21
    v_dot2c_f32_bf16 v6, v22, v12
    v_dot2c_f32_bf16 v7, v22, v22
    v_dot2c_f32_bf16 v6, v23, v12
    v_dot2c_f32_bf16 v7, v23, v23
    v_permlane32_swap_b32 v24, v26
    v_permlane32_swap_b32 v25, v27
    s_nop 0
    buffer_store_dwordx4 v[24:27], v0, s[8:11], s44 offen offset:2048 sc1
    v_dot2c_f32_bf16 v6, v24, v12
    v_dot2c_f32_bf16 v7, v24, v24
    v_dot2c_f32_bf16 v6, v25, v12
    v_dot2c_f32_bf16 v7, v25, v25
    v_dot2c_f32_bf16 v6, v26, v12
    v_dot2c_f32_bf16 v7, v26, v26
    v_dot2c_f32_bf16 v6, v27, v12
    v_dot2c_f32_bf16 v7, v27, v27
    v_permlane32_swap_b32 v28, v30
    v_permlane32_swap_b32 v29, v31
    s_nop 0
    buffer_store_dwordx4 v[28:31], v0, s[8:11], s44 offen offset:3072 sc1
    v_dot2c_f32_bf16 v6, v28, v12
    v_dot2c_f32_bf16 v7, v28, v28
    v_dot2c_f32_bf16 v6, v29, v12
    v_dot2c_f32_bf16 v7, v29, v29
    v_dot2c_f32_bf16 v6, v30, v12
    v_dot2c_f32_bf16 v7, v30, v30
    v_dot2c_f32_bf16 v6, v31, v12
    v_dot2c_f32_bf16 v7, v31, v31
    v_permlane32_swap_b32 v32, v34
    v_permlane32_swap_b32 v33, v35
    s_add_u32 s44, s44, 4096
    s_nop 0
    buffer_store_dwordx4 v[32:35], v0, s[8:11], s44 offen offset:0 sc1
    v_dot2c_f32_bf16 v6, v32, v12
    v_dot2c_f32_bf16 v7, v32, v32
    v_dot2c_f32_bf16 v6, v33, v12
    v_dot2c_f32_bf16 v7, v33, v33
    v_dot2c_f32_bf16 v6, v34, v12
    v_dot2c_f32_bf16 v7, v34, v34
    v_dot2c_f32_bf16 v6, v35, v12
    v_dot2c_f32_bf16 v7, v35, v35
    v_permlane32_swap_b32 v36, v38
    v_permlane32_swap_b32 v37, v39
    s_nop 0
    buffer_store_dwordx4 v[36:39], v0, s[8:11], s44 offen offset:1024 sc1
    v_dot2c_f32_bf16 v6, v36, v12
    v_dot2c_f32_bf16 v7, v36, v36
    v_dot2c_f32_bf16 v6, v37, v12
    v_dot2c_f32_bf16 v7, v37, v37
    v_dot2c_f32_bf16 v6, v38, v12
    v_dot2c_f32_bf16 v7, v38, v38
    v_dot2c_f32_bf16 v6, v39, v12
    v_dot2c_f32_bf16 v7, v39, v39
    v_permlane32_swap_b32 v40, v42
    v_permlane32_swap_b32 v41, v43
    s_nop 0
    buffer_store_dwordx4 v[40:43], v0, s[8:11], s44 offen offset:2048 sc1
    v_dot2c_f32_bf16 v6, v40, v12
    v_dot2c_f32_bf16 v7, v40, v40
    v_dot2c_f32_bf16 v6, v41, v12
    v_dot2c_f32_bf16 v7, v41, v41
    v_dot2c_f32_bf16 v6, v42, v12
    v_dot2c_f32_bf16 v7, v42, v42
    v_dot2c_f32_bf16 v6, v43, v12
    v_dot2c_f32_bf16 v7, v43, v43
    s_nop 2
    v_mov_b32 v8, v6
    s_nop 1
    v_permlane32_swap_b32 v8, v6
    s_nop 1
    v_add_f32 v6, v6, v8
    v_mov_b32 v8, v7
    s_nop 1
    v_permlane32_swap_b32 v8, v7
    s_nop 1
    v_add_f32 v7, v7, v8
    s_lshl_b32 s30, s3, 8
    v_lshl_add_u32 v9, v1, 3, s30
    v_add_u32 v9, 151552, v9
    s_mov_b32 exec_hi, 0
    ds_write_b64 v9, v[6:7]
    s_mov_b32 exec_hi, -1
    s_mul_i32 s44, s49, 3584
    s_lshl_b32 s45, s3, 10
    s_add_u32 s44, s44, s45
    s_add_u32 s44, s44, 7644160
    v_lshrrev_b32 v8, 1, v0
    v_mov_b32 v10, 0
    v_mov_b32 v11, 0
    s_mov_b32 exec_lo, 0
    v_mov_b32 v6, 0
    v_mov_b32 v7, 0
    s_mov_b32 exec_lo, -1
    s_waitcnt vmcnt(7)
    ds_read_b64_tr_b16 v[132:133], v5 offset:0
    ds_read_b64_tr_b16 v[134:135], v5 offset:448
    ds_read_b64_tr_b16 v[136:137], v5 offset:896
    ds_read_b64_tr_b16 v[138:139], v5 offset:1344
    ds_read_b64_tr_b16 v[140:141], v5 offset:1792
    ds_read_b64_tr_b16 v[142:143], v5 offset:2240
    ds_read_b64_tr_b16 v[144:145], v5 offset:2688
    ds_read_b64_tr_b16 v[146:147], v5 offset:3136
    ds_read_b64_tr_b16 v[148:149], v5 offset:3584
    ds_read_b64_tr_b16 v[150:151], v5 offset:4032
    ds_read_b64_tr_b16 v[152:153], v5 offset:4480
    ds_read_b64_tr_b16 v[154:155], v5 offset:4928
    ds_read_b64_tr_b16 v[156:157], v5 offset:5376
    ds_read_b64_tr_b16 v[158:159], v5 offset:5824
    ds_read_b64_tr_b16 v[160:161], v5 offset:7168
    ds_read_b64_tr_b16 v[162:163], v5 offset:7616
    ds_read_b64_tr_b16 v[164:165], v5 offset:8064
    ds_read_b64_tr_b16 v[166:167], v5 offset:8512
    ds_read_b64_tr_b16 v[168:169], v5 offset:8960
    ds_read_b64_tr_b16 v[170:171], v5 offset:9408
    ds_read_b64_tr_b16 v[172:173], v5 offset:9856
    ds_read_b64_tr_b16 v[174:175], v5 offset:10304
    ds_read_b64_tr_b16 v[176:177], v5 offset:10752
    ds_read_b64_tr_b16 v[178:179], v5 offset:11200
    ds_read_b64_tr_b16 v[180:181], v5 offset:11648
    ds_read_b64_tr_b16 v[182:183], v5 offset:12096
    ds_read_b64_tr_b16 v[184:185], v5 offset:12544
    ds_read_b64_tr_b16 v[186:187], v5 offset:12992
    buffer_store_dwordx2 v[6:7], v8, s[8:11], s44 offen sc1
    s_cmp_eq_u32 s3, 3
    s_cbranch_scc1 Lsz_17
    buffer_store_dwordx2 v[10:11], v8, s[8:11], s44 offen offset:512 sc1
Lsz_17:
    s_waitcnt lgkmcnt(0)
    s_barrier
    v_lshlrev_b32 v9, 3, v1
    v_add_u32 v9, 151552, v9
    ds_read_b64 v[100:101], v9 offset:0
    ds_read_b64 v[102:103], v9 offset:256
    ds_read_b64 v[104:105], v9 offset:512
    ds_read_b64 v[106:107], v9 offset:768
    s_waitcnt lgkmcnt(0)
    v_add_f32 v100, v100, v102
    v_add_f32 v101, v101, v103
    v_add_f32 v104, v104, v106
    v_add_f32 v105, v105, v107
    v_add_f32 v6, v100, v104
    v_add_f32 v7, v101, v105
    v_mul_f32 v6, 0x3b124925, v6
    v_mul_f32 v7, 0x3b124925, v7
    v_fma_f32 v7, -v6, v6, v7
    v_max_f32 v7, 0, v7
    v_add_f32 v7, 0x3727c5ac, v7
    v_rsq_f32 v7, v7
    s_nop 0
    s_lshl_b32 s48, s49, 12
    s_lshl_b32 s45, s3, 10
    s_add_u32 s48, s48, s45
    s_add_u32 s48, s48, 15213568
    v_mul_f32 v8, v6, v7
    v_sub_f32 v8, 0, v8
    v_lshlrev_b32 v9, 16, v16
    v_and_b32 v10, 0xffff0000, v16
    v_fma_f32 v9, v9, v7, v8
    v_fma_f32 v10, v10, v7, v8
    v_cvt_pk_bf16_f32 v16, v9, v10
    v_lshlrev_b32 v9, 16, v17
    v_and_b32 v10, 0xffff0000, v17
    v_fma_f32 v9, v9, v7, v8
    v_fma_f32 v10, v10, v7, v8
    v_cvt_pk_bf16_f32 v17, v9, v10
    v_lshlrev_b32 v9, 16, v18
    v_and_b32 v10, 0xffff0000, v18
    v_fma_f32 v9, v9, v7, v8
    v_fma_f32 v10, v10, v7, v8
    v_cvt_pk_bf16_f32 v18, v9, v10
    v_lshlrev_b32 v9, 16, v19
    v_and_b32 v10, 0xffff0000, v19
    v_fma_f32 v9, v9, v7, v8
    v_fma_f32 v10, v10, v7, v8
    v_cvt_pk_bf16_f32 v19, v9, v10
    s_nop 1
    v_mfma_f32_32x32x16_bf16 v[48:63], v[132:135], v[16:19], 0
    v_mfma_f32_32x32x16_bf16 v[64:79], v[16:19], v[160:163], 0
    v_lshlrev_b32 v9, 16, v20
    v_and_b32 v10, 0xffff0000, v20
    v_fma_f32 v9, v9, v7, v8
    v_fma_f32 v10, v10, v7, v8
    v_cvt_pk_bf16_f32 v20, v9, v10
    v_lshlrev_b32 v9, 16, v21
    v_and_b32 v10, 0xffff0000, v21
    v_fma_f32 v9, v9, v7, v8
    v_fma_f32 v10, v10, v7, v8
    v_cvt_pk_bf16_f32 v21, v9, v10
    v_lshlrev_b32 v9, 16, v22
    v_and_b32 v10, 0xffff0000, v22
    v_fma_f32 v9, v9, v7, v8
    v_fma_f32 v10, v10, v7, v8
    v_cvt_pk_bf16_f32 v22, v9, v10
    v_lshlrev_b32 v9, 16, v23
    v_and_b32 v10, 0xffff0000, v23
    v_fma_f32 v9, v9, v7, v8
    v_fma_f32 v10, v10, v7, v8
    v_cvt_pk_bf16_f32 v23, v9, v10
    s_nop 1
    v_mfma_f32_32x32x16_bf16 v[48:63], v[136:139], v[20:23], v[48:63]
    v_mfma_f32_32x32x16_bf16 v[64:79], v[20:23], v[164:167], v[64:79]
    v_lshlrev_b32 v9, 16, v24
    v_and_b32 v10, 0xffff0000, v24
    v_fma_f32 v9, v9, v7, v8
    v_fma_f32 v10, v10, v7, v8
    v_cvt_pk_bf16_f32 v24, v9, v10
    v_lshlrev_b32 v9, 16, v25
    v_and_b32 v10, 0xffff0000, v25
    v_fma_f32 v9, v9, v7, v8
    v_fma_f32 v10, v10, v7, v8
    v_cvt_pk_bf16_f32 v25, v9, v10
    v_lshlrev_b32 v9, 16, v26
    v_and_b32 v10, 0xffff0000, v26
    v_fma_f32 v9, v9, v7, v8
    v_fma_f32 v10, v10, v7, v8
    v_cvt_pk_bf16_f32 v26, v9, v10
    v_lshlrev_b32 v9, 16, v27
    v_and_b32 v10, 0xffff0000, v27
    v_fma_f32 v9, v9, v7, v8
    v_fma_f32 v10, v10, v7, v8
    v_cvt_pk_bf16_f32 v27, v9, v10
    s_nop 1
    v_mfma_f32_32x32x16_bf16 v[48:63], v[140:143], v[24:27], v[48:63]
    v_mfma_f32_32x32x16_bf16 v[64:79], v[24:27], v[168:171], v[64:79]
    v_lshlrev_b32 v9, 16, v28
    v_and_b32 v10, 0xffff0000, v28
    v_fma_f32 v9, v9, v7, v8
    v_fma_f32 v10, v10, v7, v8
    v_cvt_pk_bf16_f32 v28, v9, v10
    v_lshlrev_b32 v9, 16, v29
    v_and_b32 v10, 0xffff0000, v29
    v_fma_f32 v9, v9, v7, v8
    v_fma_f32 v10, v10, v7, v8
    v_cvt_pk_bf16_f32 v29, v9, v10
    v_lshlrev_b32 v9, 16, v30
    v_and_b32 v10, 0xffff0000, v30
    v_fma_f32 v9, v9, v7, v8
    v_fma_f32 v10, v10, v7, v8
    v_cvt_pk_bf16_f32 v30, v9, v10
    v_lshlrev_b32 v9, 16, v31
    v_and_b32 v10, 0xffff0000, v31
    v_fma_f32 v9, v9, v7, v8
    v_fma_f32 v10, v10, v7, v8
    v_cvt_pk_bf16_f32 v31, v9, v10
    s_nop 1
    v_mfma_f32_32x32x16_bf16 v[48:63], v[144:147], v[28:31], v[48:63]
    v_mfma_f32_32x32x16_bf16 v[64:79], v[28:31], v[172:175], v[64:79]
    v_lshlrev_b32 v9, 16, v32
    v_and_b32 v10, 0xffff0000, v32
    v_fma_f32 v9, v9, v7, v8
    v_fma_f32 v10, v10, v7, v8
    v_cvt_pk_bf16_f32 v32, v9, v10
    v_lshlrev_b32 v9, 16, v33
    v_and_b32 v10, 0xffff0000, v33
    v_fma_f32 v9, v9, v7, v8
    v_fma_f32 v10, v10, v7, v8
    v_cvt_pk_bf16_f32 v33, v9, v10
    v_lshlrev_b32 v9, 16, v34
    v_and_b32 v10, 0xffff0000, v34
    v_fma_f32 v9, v9, v7, v8
    v_fma_f32 v10, v10, v7, v8
    v_cvt_pk_bf16_f32 v34, v9, v10
    v_lshlrev_b32 v9, 16, v35
    v_and_b32 v10, 0xffff0000, v35
    v_fma_f32 v9, v9, v7, v8
    v_fma_f32 v10, v10, v7, v8
    v_cvt_pk_bf16_f32 v35, v9, v10
    s_nop 1
    v_mfma_f32_32x32x16_bf16 v[48:63], v[148:151], v[32:35], v[48:63]
    v_mfma_f32_32x32x16_bf16 v[64:79], v[32:35], v[176:179], v[64:79]
    v_lshlrev_b32 v9, 16, v36
    v_and_b32 v10, 0xffff0000, v36
    v_fma_f32 v9, v9, v7, v8
    v_fma_f32 v10, v10, v7, v8
    v_cvt_pk_bf16_f32 v36, v9, v10
    v_lshlrev_b32 v9, 16, v37
    v_and_b32 v10, 0xffff0000, v37
    v_fma_f32 v9, v9, v7, v8
    v_fma_f32 v10, v10, v7, v8
    v_cvt_pk_bf16_f32 v37, v9, v10
    v_lshlrev_b32 v9, 16, v38
    v_and_b32 v10, 0xffff0000, v38
    v_fma_f32 v9, v9, v7, v8
    v_fma_f32 v10, v10, v7, v8
    v_cvt_pk_bf16_f32 v38, v9, v10
    v_lshlrev_b32 v9, 16, v39
    v_and_b32 v10, 0xffff0000, v39
    v_fma_f32 v9, v9, v7, v8
    v_fma_f32 v10, v10, v7, v8
    v_cvt_pk_bf16_f32 v39, v9, v10
    s_nop 1
    v_mfma_f32_32x32x16_bf16 v[48:63], v[152:155], v[36:39], v[48:63]
    v_mfma_f32_32x32x16_bf16 v[64:79], v[36:39], v[180:183], v[64:79]
    v_lshlrev_b32 v9, 16, v40
    v_and_b32 v10, 0xffff0000, v40
    v_fma_f32 v9, v9, v7, v8
    v_fma_f32 v10, v10, v7, v8
    v_cvt_pk_bf16_f32 v40, v9, v10
    v_lshlrev_b32 v9, 16, v41
    v_and_b32 v10, 0xffff0000, v41
    v_fma_f32 v9, v9, v7, v8
    v_fma_f32 v10, v10, v7, v8
    v_cvt_pk_bf16_f32 v41, v9, v10
    v_lshlrev_b32 v9, 16, v42
    v_and_b32 v10, 0xffff0000, v42
    v_fma_f32 v9, v9, v7, v8
    v_fma_f32 v10, v10, v7, v8
    v_cvt_pk_bf16_f32 v42, v9, v10
    v_lshlrev_b32 v9, 16, v43
    v_and_b32 v10, 0xffff0000, v43
    v_fma_f32 v9, v9, v7, v8
    v_fma_f32 v10, v10, v7, v8
    v_cvt_pk_bf16_f32 v43, v9, v10
    s_nop 1
    v_mfma_f32_32x32x16_bf16 v[48:63], v[156:159], v[40:43], v[48:63]
    v_mfma_f32_32x32x16_bf16 v[64:79], v[40:43], v[184:187], v[64:79]
    s_lshl_b32 s30, s3, 13
    s_add_u32 s30, s30, 57344
    v_add_u32 v8, s30, v0
    s_lshl_b32 s30, s3, 11
    s_add_u32 s30, s30, 57344
    v_add_u32 v9, s30, v0
    s_cmp_eq_u32 s3, 3
    s_cselect_b32 s30, 0, 0
    v_add_u32 v12, s30, v8
    s_cmp_ge_u32 s3, 2
    s_cselect_b32 s30, 0, 0
    v_add_u32 v14, s30, v9
    v_mov_b32 v10, 1.0
    v_cmp_eq_u32 vcc, 28, v1
    s_cmp_ge_u32 s3, 2
    s_cselect_b32 s30, 0, 1.0
    v_mov_b32 v11, s30
    v_cndmask_b32 v10, v11, v10, vcc
    s_cselect_b32 s44, 0xf0000000, 0
    s_mov_b32 s45, s44
    s_mov_b32 s46, s44
    s_cmp_eq_u32 s3, 1
    s_cselect_b32 s47, -1, s44
    s_nop 4
    ds_write_b128 v8, v[48:51] offset:0
    ds_write_b128 v8, v[52:55] offset:1024
    ds_write_b128 v8, v[56:59] offset:2048
    ds_write_b128 v8, v[60:63] offset:3072
    ds_write_b128 v12, v[64:67] offset:4096
    ds_write_b128 v12, v[68:71] offset:5120
    ds_write_b128 v12, v[72:75] offset:6144
    ds_write_b128 v12, v[76:79] offset:7168
    s_waitcnt lgkmcnt(0)
    s_barrier
    ds_read_b128 v[16:19], v9 offset:0
    ds_read_b128 v[20:23], v9 offset:1024
    ds_read_b128 v[24:27], v9 offset:8192
    ds_read_b128 v[28:31], v9 offset:9216
    ds_read_b128 v[32:35], v9 offset:16384
    ds_read_b128 v[36:39], v9 offset:17408
    ds_read_b128 v[40:43], v14 offset:24576
    ds_read_b128 v[44:47], v14 offset:25600
    s_waitcnt lgkmcnt(4)
    v_add_f32 v16, v16, v24
    v_add_f32 v17, v17, v25
    v_add_f32 v18, v18, v26
    v_add_f32 v19, v19, v27
    v_add_f32 v20, v20, v28
    v_add_f32 v21, v21, v29
    v_add_f32 v22, v22, v30
    v_add_f32 v23, v23, v31
    s_waitcnt lgkmcnt(2)
    v_add_f32 v16, v16, v32
    v_add_f32 v17, v17, v33
    v_add_f32 v18, v18, v34
    v_add_f32 v19, v19, v35
    v_add_f32 v20, v20, v36
    v_add_f32 v21, v21, v37
    v_add_f32 v22, v22, v38
    v_add_f32 v23, v23, v39
    s_waitcnt lgkmcnt(0)
    v_add_f32 v16, v16, v40
    v_add_f32 v17, v17, v41
    v_add_f32 v18, v18, v42
    v_add_f32 v19, v19, v43
    v_add_f32 v20, v20, v44
    v_add_f32 v21, v21, v45
    v_add_f32 v22, v22, v46
    v_add_f32 v23, v23, v47
    v_cndmask_b32 v16, v16, v10, s[44:45]
    v_cndmask_b32 v17, v17, v10, s[44:45]
    v_cndmask_b32 v18, v18, v10, s[44:45]
    v_cndmask_b32 v19, v19, v10, s[44:45]
    v_cndmask_b32 v20, v20, v10, s[46:47]
    v_cndmask_b32 v21, v21, v10, s[46:47]
    v_cndmask_b32 v22, v22, v10, s[46:47]
    v_cndmask_b32 v23, v23, v10, s[46:47]
    v_cvt_pk_bf16_f32 v24, v16, v17
    v_cvt_pk_bf16_f32 v25, v18, v19
    v_cvt_pk_bf16_f32 v26, v20, v21
    v_cvt_pk_bf16_f32 v27, v22, v23
    buffer_store_dwordx4 v[24:27], v0, s[8:11], s48 offen offset:0 sc1
Lpdone_3:
    s_load_dwordx2 s[12:13], s[0:1], 72
    s_mov_b32 s14, 1835008
    s_mov_b32 s15, 0x20000
    s_waitcnt vmcnt(0)
    s_waitcnt lgkmcnt(0)
    s_mul_i32 s32, s56, 0x9E3779B1
    s_add_u32 s32, s32, 0x5bd1e900
    s_andn2_b32 s32, s32, 0xff
    s_add_u32 s36, s32, 1
    s_barrier
    s_cmp_lg_u32 s3, 0
    s_cbranch_scc1 Lw_18
    s_lshl_b32 s24, s2, 6
    s_add_u32 s24, s24, 15737856
    s_add_u32 s32, s32, s57
    s_add_u32 s30, s32, 128
    v_mov_b32 v14, s30
    v_mov_b32 v15, 0
    s_mov_b64 exec, 1
    buffer_store_dword v14, v15, s[8:11], s24 offen sc1
    s_mov_b64 exec, -1
    s_sub_u32 s32, s32, s57
    s_mov_b32 s52, 0
    s_mov_b32 s53, 0
    s_mov_b32 s54, 0
    v_lshlrev_b32 v12, 2, v0
    s_add_u32 s30, s32, 0x80
    s_mov_b32 s31, 15737856
    buffer_load_dword v16, v12, s[8:11], s31 offen sc1
    s_mov_b32 s31, 15741952
    buffer_load_dword v17, v12, s[8:11], s31 offen sc1
    s_mov_b32 s31, 15746048
    buffer_load_dword v18, v12, s[8:11], s31 offen sc1
    s_mov_b32 s31, 15750144
    buffer_load_dword v19, v12, s[8:11], s31 offen sc1
    s_waitcnt vmcnt(0)
    v_subrev_u32 v8, s30, v18
    v_cmp_lt_u32 vcc, 15, v8
    s_cbranch_vccz Lqt_21
    v_lshlrev_b32 v12, 2, v0
    s_add_u32 s30, s32, 128
Lg_22:
    s_add_u32 s39, s39, 1
    s_cmp_gt_u32 s39, 1048576
    s_cbranch_scc1 Lgx_23
    s_mov_b32 s31, 15746048
    buffer_load_dword v8, v12, s[8:11], s31 offen sc1
    s_waitcnt vmcnt(0)
    v_subrev_u32 v8, s30, v8
    v_cmp_lt_u32 vcc, 15, v8
    s_cbranch_vccnz Lg_22
Lgx_23:
Lqt_21:
    v_lshrrev_b32 v12, 4, v0
    v_add_u32 v12, 128, v12
    v_cmp_gt_u32 vcc, s2, v12
    v_cmp_eq_u32 s[26:27], s57, v8
    v_cmp_eq_u32 s[44:45], 0, v8
    v_cmp_eq_u32 s[46:47], 1, v8
    v_cmp_eq_u32 s[48:49], 2, v8
    v_cmp_eq_u32 s[50:51], 3, v8
    s_and_b64 vcc, vcc, s[26:27]
    s_bcnt1_i32_b64 s26, vcc
    s_add_u32 s54, s54, s26
    s_bcnt1_i32_b64 s44, s[44:45]
    s_bcnt1_i32_b64 s46, s[46:47]
    s_bcnt1_i32_b64 s48, s[48:49]
    s_bcnt1_i32_b64 s50, s[50:51]
    s_pack_ll_b32_b16 s44, s44, s48
    s_pack_ll_b32_b16 s46, s46, s50
    s_lshl_b32 s46, s46, 8
    s_or_b32 s44, s44, s46
    s_add_u32 s52, s52, s44
    v_cmp_eq_u32 s[44:45], 4, v8
    v_cmp_eq_u32 s[46:47], 5, v8
    v_cmp_eq_u32 s[48:49], 6, v8
    v_cmp_eq_u32 s[50:51], 7, v8
    s_nop 0
    s_bcnt1_i32_b64 s44, s[44:45]
    s_bcnt1_i32_b64 s46, s[46:47]
    s_bcnt1_i32_b64 s48, s[48:49]
    s_bcnt1_i32_b64 s50, s[50:51]
    s_pack_ll_b32_b16 s44, s44, s48
    s_pack_ll_b32_b16 s46, s46, s50
    s_lshl_b32 s46, s46, 8
    s_or_b32 s44, s44, s46
    s_add_u32 s53, s53, s44
    v_subrev_u32 v8, s30, v16
    v_cmp_lt_u32 vcc, 15, v8
    s_cbranch_vccz Lqt_24
    v_lshlrev_b32 v12, 2, v0
    s_add_u32 s30, s32, 128
Lg_25:
    s_add_u32 s39, s39, 1
    s_cmp_gt_u32 s39, 1048576
    s_cbranch_scc1 Lgx_26
    s_mov_b32 s31, 15737856
    buffer_load_dword v8, v12, s[8:11], s31 offen sc1
    s_waitcnt vmcnt(0)
    v_subrev_u32 v8, s30, v8
    v_cmp_lt_u32 vcc, 15, v8
    s_cbranch_vccnz Lg_25
Lgx_26:
Lqt_24:
    v_lshrrev_b32 v12, 4, v0
    v_add_u32 v12, 0, v12
    v_cmp_gt_u32 vcc, s2, v12
    v_cmp_eq_u32 s[26:27], s57, v8
    v_cmp_eq_u32 s[44:45], 0, v8
    v_cmp_eq_u32 s[46:47], 1, v8
    v_cmp_eq_u32 s[48:49], 2, v8
    v_cmp_eq_u32 s[50:51], 3, v8
    s_and_b64 vcc, vcc, s[26:27]
    s_bcnt1_i32_b64 s26, vcc
    s_add_u32 s54, s54, s26
    s_bcnt1_i32_b64 s44, s[44:45]
    s_bcnt1_i32_b64 s46, s[46:47]
    s_bcnt1_i32_b64 s48, s[48:49]
    s_bcnt1_i32_b64 s50, s[50:51]
    s_pack_ll_b32_b16 s44, s44, s48
    s_pack_ll_b32_b16 s46, s46, s50
    s_lshl_b32 s46, s46, 8
    s_or_b32 s44, s44, s46
    s_add_u32 s52, s52, s44
    v_cmp_eq_u32 s[44:45], 4, v8
    v_cmp_eq_u32 s[46:47], 5, v8
    v_cmp_eq_u32 s[48:49], 6, v8
    v_cmp_eq_u32 s[50:51], 7, v8
    s_nop 0
    s_bcnt1_i32_b64 s44, s[44:45]
    s_bcnt1_i32_b64 s46, s[46:47]
    s_bcnt1_i32_b64 s48, s[48:49]
    s_bcnt1_i32_b64 s50, s[50:51]
    s_pack_ll_b32_b16 s44, s44, s48
    s_pack_ll_b32_b16 s46, s46, s50
    s_lshl_b32 s46, s46, 8
    s_or_b32 s44, s44, s46
    s_add_u32 s53, s53, s44
    v_subrev_u32 v8, s30, v17
    v_cmp_lt_u32 vcc, 15, v8
    s_cbranch_vccz Lqt_27
    v_lshlrev_b32 v12, 2, v0
    s_add_u32 s30, s32, 128
Lg_28:
    s_add_u32 s39, s39, 1
    s_cmp_gt_u32 s39, 1048576
    s_cbranch_scc1 Lgx_29
    s_mov_b32 s31, 15741952
    buffer_load_dword v8, v12, s[8:11], s31 offen sc1
    s_waitcnt vmcnt(0)
    v_subrev_u32 v8, s30, v8
    v_cmp_lt_u32 vcc, 15, v8
    s_cbranch_vccnz Lg_28
Lgx_29:
Lqt_27:
    v_lshrrev_b32 v12, 4, v0
    v_add_u32 v12, 64, v12
    v_cmp_gt_u32 vcc, s2, v12
    v_cmp_eq_u32 s[26:27], s57, v8
    v_cmp_eq_u32 s[44:45], 0, v8
    v_cmp_eq_u32 s[46:47], 1, v8
    v_cmp_eq_u32 s[48:49], 2, v8
    v_cmp_eq_u32 s[50:51], 3, v8
    s_and_b64 vcc, vcc, s[26:27]
    s_bcnt1_i32_b64 s26, vcc
    s_add_u32 s54, s54, s26
    s_bcnt1_i32_b64 s44, s[44:45]
    s_bcnt1_i32_b64 s46, s[46:47]
    s_bcnt1_i32_b64 s48, s[48:49]
    s_bcnt1_i32_b64 s50, s[50:51]
    s_pack_ll_b32_b16 s44, s44, s48
    s_pack_ll_b32_b16 s46, s46, s50
    s_lshl_b32 s46, s46, 8
    s_or_b32 s44, s44, s46
    s_add_u32 s52, s52, s44
    v_cmp_eq_u32 s[44:45], 4, v8
    v_cmp_eq_u32 s[46:47], 5, v8
    v_cmp_eq_u32 s[48:49], 6, v8
    v_cmp_eq_u32 s[50:51], 7, v8
    s_nop 0
    s_bcnt1_i32_b64 s44, s[44:45]
    s_bcnt1_i32_b64 s46, s[46:47]
    s_bcnt1_i32_b64 s48, s[48:49]
    s_bcnt1_i32_b64 s50, s[50:51]
    s_pack_ll_b32_b16 s44, s44, s48
    s_pack_ll_b32_b16 s46, s46, s50
    s_lshl_b32 s46, s46, 8
    s_or_b32 s44, s44, s46
    s_add_u32 s53, s53, s44
    v_subrev_u32 v8, s30, v19
    v_cmp_lt_u32 vcc, 15, v8
    s_cbranch_vccz Lqt_30
    v_lshlrev_b32 v12, 2, v0
    s_add_u32 s30, s32, 128
Lg_31:
    s_add_u32 s39, s39, 1
    s_cmp_gt_u32 s39, 1048576
    s_cbranch_scc1 Lgx_32
    s_mov_b32 s31, 15750144
    buffer_load_dword v8, v12, s[8:11], s31 offen sc1
    s_waitcnt vmcnt(0)
    v_subrev_u32 v8, s30, v8
    v_cmp_lt_u32 vcc, 15, v8
    s_cbranch_vccnz Lg_31
Lgx_32:
Lqt_30:
    v_lshrrev_b32 v12, 4, v0
    v_add_u32 v12, 192, v12
    v_cmp_gt_u32 vcc, s2, v12
    v_cmp_eq_u32 s[26:27], s57, v8
    v_cmp_eq_u32 s[44:45], 0, v8
    v_cmp_eq_u32 s[46:47], 1, v8
    v_cmp_eq_u32 s[48:49], 2, v8
    v_cmp_eq_u32 s[50:51], 3, v8
    s_and_b64 vcc, vcc, s[26:27]
    s_bcnt1_i32_b64 s26, vcc
    s_add_u32 s54, s54, s26
    s_bcnt1_i32_b64 s44, s[44:45]
    s_bcnt1_i32_b64 s46, s[46:47]
    s_bcnt1_i32_b64 s48, s[48:49]
    s_bcnt1_i32_b64 s50, s[50:51]
    s_pack_ll_b32_b16 s44, s44, s48
    s_pack_ll_b32_b16 s46, s46, s50
    s_lshl_b32 s46, s46, 8
    s_or_b32 s44, s44, s46
    s_add_u32 s52, s52, s44
    v_cmp_eq_u32 s[44:45], 4, v8
    v_cmp_eq_u32 s[46:47], 5, v8
    v_cmp_eq_u32 s[48:49], 6, v8
    v_cmp_eq_u32 s[50:51], 7, v8
    s_nop 0
    s_bcnt1_i32_b64 s44, s[44:45]
    s_bcnt1_i32_b64 s46, s[46:47]
    s_bcnt1_i32_b64 s48, s[48:49]
    s_bcnt1_i32_b64 s50, s[50:51]
    s_pack_ll_b32_b16 s44, s44, s48
    s_pack_ll_b32_b16 s46, s46, s50
    s_lshl_b32 s46, s46, 8
    s_or_b32 s44, s44, s46
    s_add_u32 s53, s53, s44
    s_xor_b32 s52, s52, 0x20202020
    s_xor_b32 s53, s53, 0x20202020
    s_or_b32 s25, s52, s53
    s_lshl_b32 s44, s54, 3
    s_or_b32 s44, s44, s57
    s_or_b32 s24, s2, 0x100
    s_cmp_eq_u32 s25, 0
    s_cselect_b32 s24, s44, s24
    v_mov_b32 v8, s24
    v_mov_b32 v9, 152576
    ds_write_b32 v9, v8
    s_waitcnt lgkmcnt(0)
Lw_18:
    s_barrier
    v_mov_b32 v9, 152576
    ds_read_b32 v8, v9
    s_waitcnt lgkmcnt(0)
    v_readfirstlane_b32 s24, v8
    s_nop 3
    s_lshr_b32 s33, s24, 8
    s_and_b32 s25, s24, 7
    s_bfe_u32 s26, s24, 0x50003
    s_lshr_b32 s4, s26, 2
    s_lshl_b32 s27, s25, 3
    s_add_u32 s4, s4, s27
    s_and_b32 s5, s26, 3
    s_and_b32 s6, s26, 15
    s_and_b32 s38, s4, 0x3c
    s_lshl_b32 s34, s38, 6
    s_add_u32 s34, s34, 15758336
    s_lshl_b32 s35, s6, 2
    s_add_u32 s35, s35, s3
    s_lshl_b32 s35, s35, 2
    s_add_u32 s35, s35, s34
    s_cmp_ge_u32 s6, 7
    s_cselect_b32 s40, 1, 0
    s_cselect_b32 s27, 7, 0
    s_sub_u32 s41, s6, s27
    s_min_u32 s41, s41, 6
    s_mul_i32 s25, s3, 7168
    s_mul_i32 s24, s4, 28672
    s_add_u32 s24, s24, s25
    s_add_u32 s24, s24, 5809152
    s_mov_b32 m0, s25
    s_nop 0
    buffer_load_dwordx4 v0, s[8:11], s24 offen offset:0 sc1 lds
    buffer_load_dwordx4 v0, s[8:11], s24 offen offset:1024 sc1 lds
    buffer_load_dwordx4 v0, s[8:11], s24 offen offset:2048 sc1 lds
    buffer_load_dwordx4 v0, s[8:11], s24 offen offset:3072 sc1 lds
    s_add_u32 s24, s24, 4096
    s_add_u32 s25, s25, 4096
    s_mov_b32 m0, s25
    s_nop 0
    buffer_load_dwordx4 v0, s[8:11], s24 offen offset:0 sc1 lds
    buffer_load_dwordx4 v0, s[8:11], s24 offen offset:1024 sc1 lds
    buffer_load_dwordx4 v0, s[8:11], s24 offen offset:2048 sc1 lds
    s_mul_i32 s24, s4, 3584
    s_add_u32 s24, s24, 7644160
    v_mul_u32_u24 v8, 1792, v2
    v_lshl_add_u32 v8, v1, 3, v8
    buffer_load_dwordx2 v[100:101], v8, s[8:11], s24 offen offset:0 sc1
    buffer_load_dwordx2 v[102:103], v8, s[8:11], s24 offen offset:256 sc1
    buffer_load_dwordx2 v[104:105], v8, s[8:11], s24 offen offset:512 sc1
    buffer_load_dwordx2 v[106:107], v8, s[8:11], s24 offen offset:768 sc1
    buffer_load_dwordx2 v[108:109], v8, s[8:11], s24 offen offset:1024 sc1
    buffer_load_dwordx2 v[110:111], v8, s[8:11], s24 offen offset:1280 sc1
    buffer_load_dwordx2 v[112:113], v8, s[8:11], s24 offen offset:1536 sc1
    s_lshl_b32 s25, s5, 2
    s_add_u32 s25, s25, s3
    s_lshl_b32 s28, s25, 7
    s_add_u32 s28, s28, 5791744
    s_mul_i32 s29, s25, 28672
    s_add_u32 s29, s29, 0
    buffer_load_dwordx4 v[16:19], v0, s[8:11], s29 offen offset:0
    buffer_load_dwordx4 v[20:23], v0, s[8:11], s29 offen offset:1024
    buffer_load_dwordx4 v[24:27], v0, s[8:11], s29 offen offset:2048
    buffer_load_dwordx4 v[28:31], v0, s[8:11], s29 offen offset:3072
    s_add_u32 s29, s29, 4096
    buffer_load_dwordx4 v[32:35], v0, s[8:11], s29 offen offset:0
    buffer_load_dwordx4 v[36:39], v0, s[8:11], s29 offen offset:1024
    buffer_load_dwordx4 v[40:43], v0, s[8:11], s29 offen offset:2048
    buffer_load_dwordx4 v[44:47], v0, s[8:11], s29 offen offset:3072
    s_add_u32 s29, s29, 4096
    buffer_load_dwordx4 v[64:67], v0, s[8:11], s29 offen offset:0
    buffer_load_dwordx4 v[68:71], v0, s[8:11], s29 offen offset:1024
    s_lshl_b32 s24, s3, 16
    s_add_u32 s24, s24, s7
    s_add_u32 s24, s24, 15213568
    s_add_u32 s20, s8, s24
    s_addc_u32 s21, s9, 0
    s_mov_b32 s22, 65536
    s_mov_b32 s23, 0x20000
    s_waitcnt vmcnt(10)
    s_barrier
    v_add_f32 v102, v102, v104
    v_add_f32 v103, v103, v105
    v_add_f32 v106, v106, v108
    v_add_f32 v107, v107, v109
    v_add_f32 v110, v110, v112
    v_add_f32 v111, v111, v113
    v_add_f32 v100, v100, v102
    v_add_f32 v101, v101, v103
    v_add_f32 v106, v106, v110
    v_add_f32 v107, v107, v111
    v_add_f32 v6, v100, v106
    v_add_f32 v7, v101, v107
    v_mov_b32 v8, v6
    v_mov_b32 v9, v7
    s_nop 1
    v_permlane32_swap_b32 v8, v6
    v_permlane32_swap_b32 v9, v7
    s_nop 1
    v_add_f32 v6, v6, v8
    v_add_f32 v7, v7, v9
    v_mul_f32 v6, 0x3b124925, v6
    v_mul_f32 v7, 0x3b124925, v7
    v_fma_f32 v7, -v6, v6, v7
    v_max_f32 v7, 0, v7
    v_add_f32 v7, 0x3727c5ac, v7
    v_rsq_f32 v7, v7
    s_nop 0
    ds_read_b128 v[224:227], v0 offset:0
    ds_read_b128 v[228:231], v0 offset:1024
    ds_read_b128 v[232:235], v0 offset:2048
    ds_read_b128 v[236:239], v0 offset:3072
    ds_read_b128 v[240:243], v0 offset:4096
    ds_read_b128 v[244:247], v0 offset:5120
    ds_read_b128 v[248:251], v0 offset:6144
    ds_read_b128 v[252:255], v0 offset:7168
    v_mul_f32 v7, 0x3e8b97f6, v7
    s_waitcnt vmcnt(9) lgkmcnt(7)
    v_mfma_f32_32x32x16_bf16 v[48:63], v[16:19], v[224:227], 0
    ds_read_b128 v[224:227], v0 offset:8192
    buffer_load_dwordx4 v[72:75], v0, s[8:11], s29 offen offset:2048
    s_waitcnt vmcnt(9) lgkmcnt(7)
    v_mfma_f32_32x32x16_bf16 v[48:63], v[20:23], v[228:231], v[48:63]
    ds_read_b128 v[228:231], v0 offset:9216
    buffer_load_dwordx4 v[76:79], v0, s[8:11], s29 offen offset:3072
    s_waitcnt vmcnt(9) lgkmcnt(7)
    v_mfma_f32_32x32x16_bf16 v[48:63], v[24:27], v[232:235], v[48:63]
    ds_read_b128 v[232:235], v0 offset:10240
    s_add_u32 s29, s29, 4096
    buffer_load_dwordx4 v[80:83], v0, s[8:11], s29 offen offset:0
    s_waitcnt vmcnt(9) lgkmcnt(7)
    v_mfma_f32_32x32x16_bf16 v[48:63], v[28:31], v[236:239], v[48:63]
    ds_read_b128 v[236:239], v0 offset:11264
    buffer_load_dwordx4 v[84:87], v0, s[8:11], s29 offen offset:1024
    s_waitcnt vmcnt(9) lgkmcnt(7)
    v_mfma_f32_32x32x16_bf16 v[48:63], v[32:35], v[240:243], v[48:63]
    ds_read_b128 v[240:243], v0 offset:12288
    buffer_load_dwordx4 v[88:91], v0, s[8:11], s29 offen offset:2048
    s_waitcnt vmcnt(9) lgkmcnt(7)
    v_mfma_f32_32x32x16_bf16 v[48:63], v[36:39], v[244:247], v[48:63]
    ds_read_b128 v[244:247], v0 offset:13312
    buffer_load_dwordx4 v[92:95], v0, s[8:11], s29 offen offset:3072
    s_waitcnt vmcnt(9) lgkmcnt(7)
    v_mfma_f32_32x32x16_bf16 v[48:63], v[40:43], v[248:251], v[48:63]
    ds_read_b128 v[248:251], v0 offset:14336
    s_add_u32 s29, s29, 4096
    buffer_load_dwordx4 v[136:139], v0, s[8:11], s29 offen offset:0
    s_waitcnt vmcnt(9) lgkmcnt(7)
    v_mfma_f32_32x32x16_bf16 v[48:63], v[44:47], v[252:255], v[48:63]
    ds_read_b128 v[252:255], v0 offset:15360
    buffer_load_dwordx4 v[140:143], v0, s[8:11], s29 offen offset:1024
    s_waitcnt vmcnt(9) lgkmcnt(7)
    v_mfma_f32_32x32x16_bf16 v[48:63], v[64:67], v[224:227], v[48:63]
    ds_read_b128 v[224:227], v0 offset:16384
    buffer_load_dwordx4 v[144:147], v0, s[8:11], s29 offen offset:2048
    s_waitcnt vmcnt(9) lgkmcnt(7)
    v_mfma_f32_32x32x16_bf16 v[48:63], v[68:71], v[228:231], v[48:63]
    ds_read_b128 v[228:231], v0 offset:17408
    buffer_load_dwordx4 v[148:151], v0, s[8:11], s29 offen offset:3072
    s_waitcnt vmcnt(9) lgkmcnt(7)
    v_mfma_f32_32x32x16_bf16 v[48:63], v[72:75], v[232:235], v[48:63]
    ds_read_b128 v[232:235], v0 offset:18432
    s_add_u32 s29, s29, 4096
    buffer_load_dwordx4 v[152:155], v0, s[8:11], s29 offen offset:0
    s_waitcnt vmcnt(9) lgkmcnt(7)
    v_mfma_f32_32x32x16_bf16 v[48:63], v[76:79], v[236:239], v[48:63]
    ds_read_b128 v[236:239], v0 offset:19456
    buffer_load_dwordx4 v[156:159], v0, s[8:11], s29 offen offset:1024
    s_waitcnt vmcnt(9) lgkmcnt(7)
    v_mfma_f32_32x32x16_bf16 v[48:63], v[80:83], v[240:243], v[48:63]
    ds_read_b128 v[240:243], v0 offset:20480
    buffer_load_dwordx4 v[16:19], v0, s[8:11], s29 offen offset:2048
    s_waitcnt vmcnt(9) lgkmcnt(7)
    v_mfma_f32_32x32x16_bf16 v[48:63], v[84:87], v[244:247], v[48:63]
    ds_read_b128 v[244:247], v0 offset:21504
    buffer_load_dwordx4 v[20:23], v0, s[8:11], s29 offen offset:3072
    s_waitcnt vmcnt(9) lgkmcnt(7)
    v_mfma_f32_32x32x16_bf16 v[48:63], v[88:91], v[248:251], v[48:63]
    ds_read_b128 v[248:251], v0 offset:22528
    s_add_u32 s29, s29, 4096
    buffer_load_dwordx4 v[24:27], v0, s[8:11], s29 offen offset:0
    s_waitcnt vmcnt(9) lgkmcnt(7)
    v_mfma_f32_32x32x16_bf16 v[48:63], v[92:95], v[252:255], v[48:63]
    ds_read_b128 v[252:255], v0 offset:23552
    buffer_load_dwordx4 v[28:31], v0, s[8:11], s29 offen offset:1024
    s_waitcnt vmcnt(9) lgkmcnt(7)
    v_mfma_f32_32x32x16_bf16 v[48:63], v[136:139], v[224:227], v[48:63]
    ds_read_b128 v[224:227], v0 offset:24576
    buffer_load_dwordx4 v[32:35], v0, s[8:11], s29 offen offset:2048
    s_waitcnt vmcnt(9) lgkmcnt(7)
    v_mfma_f32_32x32x16_bf16 v[48:63], v[140:143], v[228:231], v[48:63]
    ds_read_b128 v[228:231], v0 offset:25600
    buffer_load_dwordx4 v[36:39], v0, s[8:11], s29 offen offset:3072
    s_waitcnt vmcnt(9) lgkmcnt(7)
    v_mfma_f32_32x32x16_bf16 v[48:63], v[144:147], v[232:235], v[48:63]
    ds_read_b128 v[232:235], v0 offset:26624
    v_lshlrev_b32 v9, 4, v2
    buffer_load_dwordx4 v[116:119], v9, s[8:11], s28 offen offset:0
    buffer_load_dwordx4 v[120:123], v9, s[8:11], s28 offen offset:32
    buffer_load_dwordx4 v[124:127], v9, s[8:11], s28 offen offset:64
    buffer_load_dwordx4 v[128:131], v9, s[8:11], s28 offen offset:96
    s_waitcnt vmcnt(12) lgkmcnt(7)
    v_mfma_f32_32x32x16_bf16 v[48:63], v[148:151], v[236:239], v[48:63]
    ds_read_b128 v[236:239], v0 offset:27648
    s_mov_b32 s26, 0
    buffer_load_dwordx4 v[160:163], v0, s[20:23], s26 offen offset:0
    buffer_load_dwordx4 v[164:167], v0, s[20:23], s26 offen offset:1024
    s_waitcnt vmcnt(13) lgkmcnt(7)
    v_mfma_f32_32x32x16_bf16 v[48:63], v[152:155], v[240:243], v[48:63]
    s_mov_b32 s27, 0
    buffer_load_dwordx4 v[168:171], v0, s[20:23], s27 offen offset:2048
    buffer_load_dwordx4 v[172:175], v0, s[20:23], s27 offen offset:3072
    s_waitcnt vmcnt(14) lgkmcnt(6)
    v_mfma_f32_32x32x16_bf16 v[48:63], v[156:159], v[244:247], v[48:63]
    s_mov_b32 s26, 4096
    buffer_load_dwordx4 v[176:179], v0, s[20:23], s26 offen offset:0
    buffer_load_dwordx4 v[180:183], v0, s[20:23], s26 offen offset:1024
    s_waitcnt vmcnt(15) lgkmcnt(5)
    v_mfma_f32_32x32x16_bf16 v[48:63], v[16:19], v[248:251], v[48:63]
    s_mov_b32 s27, 4096
    buffer_load_dwordx4 v[184:187], v0, s[20:23], s27 offen offset:2048
    buffer_load_dwordx4 v[188:191], v0, s[20:23], s27 offen offset:3072
    s_waitcnt vmcnt(16) lgkmcnt(4)
    v_mfma_f32_32x32x16_bf16 v[48:63], v[20:23], v[252:255], v[48:63]
    s_mov_b32 s26, 8192
    buffer_load_dwordx4 v[192:195], v0, s[20:23], s26 offen offset:0
    buffer_load_dwordx4 v[196:199], v0, s[20:23], s26 offen offset:1024
    s_waitcnt vmcnt(17) lgkmcnt(3)
    v_mfma_f32_32x32x16_bf16 v[48:63], v[24:27], v[224:227], v[48:63]
    s_mov_b32 s27, 8192
    buffer_load_dwordx4 v[200:203], v0, s[20:23], s27 offen offset:2048
    buffer_load_dwordx4 v[204:207], v0, s[20:23], s27 offen offset:3072
    s_waitcnt vmcnt(18) lgkmcnt(2)
    v_mfma_f32_32x32x16_bf16 v[48:63], v[28:31], v[228:231], v[48:63]
    s_mov_b32 s26, 12288
    buffer_load_dwordx4 v[208:211], v0, s[20:23], s26 offen offset:0
    buffer_load_dwordx4 v[212:215], v0, s[20:23], s26 offen offset:1024
    s_waitcnt vmcnt(19) lgkmcnt(1)
    v_mfma_f32_32x32x16_bf16 v[48:63], v[32:35], v[232:235], v[48:63]
    s_waitcnt vmcnt(18) lgkmcnt(0)
    v_mfma_f32_32x32x16_bf16 v[48:63], v[36:39], v[236:239], v[48:63]
    s_add_u32 s30, s3, 0
    s_and_b32 s30, s30, 3
    s_mul_i32 s30, s30, 2048
    v_add_u32 v5, s30, v0
    s_add_u32 s30, s3, 1
    s_and_b32 s30, s30, 3
    s_mul_i32 s30, s30, 2048
    v_add_u32 v133, s30, v0
    s_add_u32 s30, s3, 2
    s_and_b32 s30, s30, 3
    s_mul_i32 s30, s30, 2048
    v_add_u32 v134, s30, v0
    s_add_u32 s30, s3, 3
    s_and_b32 s30, s30, 3
    s_mul_i32 s30, s30, 2048
    v_add_u32 v135, s30, v0
    s_waitcnt vmcnt(14)
    v_fma_f32 v48, -v6, v116, v48
    v_mul_f32 v48, v7, v48
    v_fma_f32 v49, -v6, v117, v49
    v_mul_f32 v49, v7, v49
    v_fma_f32 v50, -v6, v118, v50
    v_mul_f32 v50, v7, v50
    v_fma_f32 v51, -v6, v119, v51
    v_mul_f32 v51, v7, v51
    v_fma_f32 v52, -v6, v120, v52
    v_mul_f32 v52, v7, v52
    v_fma_f32 v53, -v6, v121, v53
    v_mul_f32 v53, v7, v53
    v_fma_f32 v54, -v6, v122, v54
    v_mul_f32 v54, v7, v54
    v_fma_f32 v55, -v6, v123, v55
    v_mul_f32 v55, v7, v55
    v_fma_f32 v56, -v6, v124, v56
    v_mul_f32 v56, v7, v56
    v_fma_f32 v57, -v6, v125, v57
    v_mul_f32 v57, v7, v57
    v_fma_f32 v58, -v6, v126, v58
    v_mul_f32 v58, v7, v58
    v_fma_f32 v59, -v6, v127, v59
    v_mul_f32 v59, v7, v59
    v_fma_f32 v60, -v6, v128, v60
    v_mul_f32 v60, v7, v60
    v_fma_f32 v61, -v6, v129, v61
    v_mul_f32 v61, v7, v61
    v_fma_f32 v62, -v6, v130, v62
    v_mul_f32 v62, v7, v62
    v_fma_f32 v63, -v6, v131, v63
    v_mul_f32 v63, v7, v63
    v_cvt_pk_bf16_f32 v80, v48, v49
    v_cvt_pk_bf16_f32 v81, v50, v51
    v_cvt_pk_bf16_f32 v82, v52, v53
    v_cvt_pk_bf16_f32 v83, v54, v55
    v_cvt_pk_bf16_f32 v84, v56, v57
    v_cvt_pk_bf16_f32 v85, v58, v59
    v_cvt_pk_bf16_f32 v86, v60, v61
    v_cvt_pk_bf16_f32 v87, v62, v63
    s_mov_b32 exec_lo, 0
    v_mov_b32 v86, 0
    v_mov_b32 v87, 0
    s_mov_b32 exec_lo, -1
    ds_write_b128 v5, v[80:83] offset:49152
    ds_write_b128 v5, v[84:87] offset:50176
    s_waitcnt lgkmcnt(0)
    s_barrier
    ds_read_b128 v[16:19], v5 offset:49152
    ds_read_b128 v[20:23], v5 offset:50176
    ds_read_b128 v[24:27], v133 offset:49152
    ds_read_b128 v[28:31], v133 offset:50176
    ds_read_b128 v[32:35], v134 offset:49152
    ds_read_b128 v[36:39], v134 offset:50176
    ds_read_b128 v[40:43], v135 offset:49152
    ds_read_b128 v[44:47], v135 offset:50176
    s_waitcnt lgkmcnt(0)
    s_mov_b32 s29, 0
    s_mul_i32 s45, s3, 7168
    s_mul_i32 s44, s6, 200704
    s_add_u32 s44, s44, s45
    s_add_u32 s44, s44, 974848
    s_lshl_b32 s47, s5, 2
    s_add_u32 s47, s47, s3
    s_min_u32 s47, s47, 13
    s_lshl_b32 s48, s47, 15
    s_add_u32 s48, s48, 516096
    s_mul_i32 s50, s4, 28672
    s_lshl_b32 s51, s47, 11
    s_add_u32 s50, s50, s51
    s_add_u32 s50, s50, 5809152
    s_mul_i32 s51, s6, 896
    s_add_u32 s51, s51, 5793792
    s_mul_i32 s54, s41, 229376
    s_mul_i32 s52, s3, 28672
    s_add_u32 s54, s54, s52
    s_add_u32 s54, s54, 4186112
    s_bitcmp1_b32 s3, 0
    s_cselect_b32 s52, 114688, 0
    s_lshl_b32 s55, s52, 1
    s_sub_u32 s55, 114688, s55
    s_add_u32 s54, s54, s52
    s_add_u32 s24, s38, s3
    s_lshl_b32 s24, s24, 4
    s_add_u32 s24, s24, s6
    s_mul_i32 s24, s24, 7168
    s_add_u32 s24, s24, 7873536
    s_add_u32 s16, s8, s24
    s_addc_u32 s17, s9, 0
    s_waitcnt vmcnt(12)
    v_mfma_f32_32x32x16_bf16 v[48:63], v[160:163], v[16:19], 0
    v_mfma_f32_32x32x16_bf16 v[48:63], v[164:167], v[20:23], v[48:63]
    s_nop 10
    v_mfma_f32_32x32x16_bf16 v[64:79], v[160:163], v[24:27], 0
    s_add_u32 s49, s48, 0
    buffer_load_dwordx4 a[224:227], v0, s[8:11], s49 offen offset:0
    v_exp_f32 v48, v48
    v_exp_f32 v49, v49
    v_exp_f32 v50, v50
    v_exp_f32 v51, v51
    v_mfma_f32_32x32x16_bf16 v[64:79], v[164:167], v[28:31], v[64:79]
    s_load_dwordx2 s[18:19], s[16:17], 60
    v_exp_f32 v52, v52
    v_exp_f32 v53, v53
    v_exp_f32 v54, v54
    v_exp_f32 v55, v55
    v_cvt_pk_bf16_f32 v80, v48, v49
    v_cvt_pk_bf16_f32 v81, v50, v51
    v_exp_f32 v56, v56
    v_exp_f32 v57, v57
    v_exp_f32 v58, v58
    v_exp_f32 v59, v59
    v_cvt_pk_bf16_f32 v82, v52, v53
    v_cvt_pk_bf16_f32 v83, v54, v55
    buffer_load_dwordx4 a[228:231], v0, s[8:11], s49 offen offset:1024
    v_exp_f32 v60, v60
    v_exp_f32 v61, v61
    v_exp_f32 v62, v62
    v_exp_f32 v63, v63
    v_cvt_pk_bf16_f32 v84, v56, v57
    v_cvt_pk_bf16_f32 v85, v58, v59
    v_cvt_pk_bf16_f32 v86, v60, v61
    v_cvt_pk_bf16_f32 v87, v62, v63
    v_mfma_f32_32x32x16_bf16 v[48:63], v[160:163], v[32:35], 0
    v_exp_f32 v64, v64
    v_exp_f32 v65, v65
    v_exp_f32 v66, v66
    v_exp_f32 v67, v67
    v_mfma_f32_32x32x16_bf16 v[48:63], v[164:167], v[36:39], v[48:63]
    v_exp_f32 v68, v68
    v_exp_f32 v69, v69
    v_exp_f32 v70, v70
    v_exp_f32 v71, v71
    v_cvt_pk_bf16_f32 v88, v64, v65
    v_cvt_pk_bf16_f32 v89, v66, v67
    s_waitcnt vmcnt(12)
    v_mfma_f32_32x32x16_bf16 v[96:111], v[168:171], v[80:83], 0
    s_mov_b32 s27, 12288
    buffer_load_dwordx4 v[216:219], v0, s[20:23], s27 offen offset:2048
    buffer_load_dwordx4 v[220:223], v0, s[20:23], s27 offen offset:3072
    v_exp_f32 v72, v72
    v_exp_f32 v73, v73
    v_exp_f32 v74, v74
    v_exp_f32 v75, v75
    v_cvt_pk_bf16_f32 v90, v68, v69
    v_cvt_pk_bf16_f32 v91, v70, v71
    v_mfma_f32_32x32x16_bf16 v[96:111], v[172:175], v[84:87], v[96:111]
    buffer_load_dwordx4 a[232:235], v0, s[8:11], s49 offen offset:2048
    v_exp_f32 v76, v76
    v_exp_f32 v77, v77
    v_exp_f32 v78, v78
    v_exp_f32 v79, v79
    v_cvt_pk_bf16_f32 v92, v72, v73
    v_cvt_pk_bf16_f32 v93, v74, v75
    v_cvt_pk_bf16_f32 v94, v76, v77
    v_cvt_pk_bf16_f32 v95, v78, v79
    v_mfma_f32_32x32x16_bf16 v[64:79], v[160:163], v[40:43], 0
    buffer_load_dwordx4 a[236:239], v0, s[8:11], s49 offen offset:3072
    v_exp_f32 v48, v48
    v_exp_f32 v49, v49
    v_exp_f32 v50, v50
    v_exp_f32 v51, v51
    v_mfma_f32_32x32x16_bf16 v[64:79], v[164:167], v[44:47], v[64:79]
    s_load_dwordx2 s[18:19], s[16:17], 188
    v_exp_f32 v52, v52
    v_exp_f32 v53, v53
    v_exp_f32 v54, v54
    v_exp_f32 v55, v55
    v_cvt_pk_bf16_f32 v80, v48, v49
    v_cvt_pk_bf16_f32 v81, v50, v51
    v_mfma_f32_32x32x16_bf16 v[112:127], v[168:171], v[88:91], 0
    v_exp_f32 v56, v56
    v_exp_f32 v57, v57
    v_exp_f32 v58, v58
    v_exp_f32 v59, v59
    v_cvt_pk_bf16_f32 v82, v52, v53
    v_cvt_pk_bf16_f32 v83, v54, v55
    v_mfma_f32_32x32x16_bf16 v[112:127], v[172:175], v[92:95], v[112:127]
    s_add_u32 s49, s48, 4096
    buffer_load_dwordx4 a[240:243], v0, s[8:11], s49 offen offset:0
    v_exp_f32 v60, v60
    v_exp_f32 v61, v61
    v_exp_f32 v62, v62
    v_exp_f32 v63, v63
    v_cvt_pk_bf16_f32 v84, v56, v57
    v_cvt_pk_bf16_f32 v85, v58, v59
    v_cvt_pk_bf16_f32 v86, v60, v61
    v_cvt_pk_bf16_f32 v87, v62, v63
    s_waitcnt vmcnt(15)
    v_mfma_f32_32x32x16_bf16 v[48:63], v[176:179], v[16:19], 0
    v_exp_f32 v64, v64
    v_exp_f32 v65, v65
    v_exp_f32 v66, v66
    v_exp_f32 v67, v67
    v_mfma_f32_32x32x16_bf16 v[48:63], v[180:183], v[20:23], v[48:63]
    s_mov_b32 s26, 16384
    buffer_load_dwordx4 v[160:163], v0, s[20:23], s26 offen offset:0
    buffer_load_dwordx4 v[164:167], v0, s[20:23], s26 offen offset:1024
    v_exp_f32 v68, v68
    v_exp_f32 v69, v69
    v_exp_f32 v70, v70
    v_exp_f32 v71, v71
    v_cvt_pk_bf16_f32 v88, v64, v65
    v_cvt_pk_bf16_f32 v89, v66, v67
    v_mfma_f32_32x32x16_bf16 v[128:143], v[168:171], v[80:83], 0
    v_exp_f32 v72, v72
    v_exp_f32 v73, v73
    v_exp_f32 v74, v74
    v_exp_f32 v75, v75
    v_cvt_pk_bf16_f32 v90, v68, v69
    v_cvt_pk_bf16_f32 v91, v70, v71
    v_mfma_f32_32x32x16_bf16 v[128:143], v[172:175], v[84:87], v[128:143]
    buffer_load_dwordx4 a[244:247], v0, s[8:11], s49 offen offset:1024
    v_exp_f32 v76, v76
    v_exp_f32 v77, v77
    v_exp_f32 v78, v78
    v_exp_f32 v79, v79
    v_cvt_pk_bf16_f32 v92, v72, v73
    v_cvt_pk_bf16_f32 v93, v74, v75
    v_cvt_pk_bf16_f32 v94, v76, v77
    v_cvt_pk_bf16_f32 v95, v78, v79
    v_mfma_f32_32x32x16_bf16 v[64:79], v[176:179], v[24:27], 0
    buffer_load_dwordx4 a[248:251], v0, s[8:11], s49 offen offset:2048
    v_exp_f32 v48, v48
    v_exp_f32 v49, v49
    v_exp_f32 v50, v50
    v_exp_f32 v51, v51
    v_mfma_f32_32x32x16_bf16 v[64:79], v[180:183], v[28:31], v[64:79]
    s_load_dwordx2 s[18:19], s[16:17], 316
    v_exp_f32 v52, v52
    v_exp_f32 v53, v53
    v_exp_f32 v54, v54
    v_exp_f32 v55, v55
    v_cvt_pk_bf16_f32 v80, v48, v49
    v_cvt_pk_bf16_f32 v81, v50, v51
    v_mfma_f32_32x32x16_bf16 v[144:159], v[168:171], v[88:91], 0
    v_exp_f32 v56, v56
    v_exp_f32 v57, v57
    v_exp_f32 v58, v58
    v_exp_f32 v59, v59
    v_cvt_pk_bf16_f32 v82, v52, v53
    v_cvt_pk_bf16_f32 v83, v54, v55
    v_mfma_f32_32x32x16_bf16 v[144:159], v[172:175], v[92:95], v[144:159]
    buffer_load_dwordx4 a[252:255], v0, s[8:11], s49 offen offset:3072
    v_exp_f32 v60, v60
    v_exp_f32 v61, v61
    v_exp_f32 v62, v62
    v_exp_f32 v63, v63
    v_cvt_pk_bf16_f32 v84, v56, v57
    v_cvt_pk_bf16_f32 v85, v58, v59
    v_cvt_pk_bf16_f32 v86, v60, v61
    v_cvt_pk_bf16_f32 v87, v62, v63
    v_mfma_f32_32x32x16_bf16 v[48:63], v[176:179], v[32:35], 0
    v_exp_f32 v64, v64
    v_exp_f32 v65, v65
    v_exp_f32 v66, v66
    v_exp_f32 v67, v67
    v_mfma_f32_32x32x16_bf16 v[48:63], v[180:183], v[36:39], v[48:63]
    v_exp_f32 v68, v68
    v_exp_f32 v69, v69
    v_exp_f32 v70, v70
    v_exp_f32 v71, v71
    v_cvt_pk_bf16_f32 v88, v64, v65
    v_cvt_pk_bf16_f32 v89, v66, v67
    s_waitcnt vmcnt(18)
    v_mfma_f32_32x32x16_bf16 v[96:111], v[184:187], v[80:83], v[96:111]
    s_mov_b32 s27, 16384
    buffer_load_dwordx4 v[168:171], v0, s[20:23], s27 offen offset:2048
    buffer_load_dwordx4 v[172:175], v0, s[20:23], s27 offen offset:3072
    v_exp_f32 v72, v72
    v_exp_f32 v73, v73
    v_exp_f32 v74, v74
    v_exp_f32 v75, v75
    v_cvt_pk_bf16_f32 v90, v68, v69
    v_cvt_pk_bf16_f32 v91, v70, v71
    v_mfma_f32_32x32x16_bf16 v[96:111], v[188:191], v[84:87], v[96:111]
    s_add_u32 s49, s48, 8192
    buffer_load_dwordx4 v[232:235], v0, s[8:11], s49 offen offset:0
    v_exp_f32 v76, v76
    v_exp_f32 v77, v77
    v_exp_f32 v78, v78
    v_exp_f32 v79, v79
    v_cvt_pk_bf16_f32 v92, v72, v73
    v_cvt_pk_bf16_f32 v93, v74, v75
    v_cvt_pk_bf16_f32 v94, v76, v77
    v_cvt_pk_bf16_f32 v95, v78, v79
    v_mfma_f32_32x32x16_bf16 v[64:79], v[176:179], v[40:43], 0
    buffer_load_dwordx4 v[236:239], v0, s[8:11], s49 offen offset:1024
    v_exp_f32 v48, v48
    v_exp_f32 v49, v49
    v_exp_f32 v50, v50
    v_exp_f32 v51, v51
    v_mfma_f32_32x32x16_bf16 v[64:79], v[180:183], v[44:47], v[64:79]
    s_load_dwordx2 s[18:19], s[16:17], 444
    v_exp_f32 v52, v52
    v_exp_f32 v53, v53
    v_exp_f32 v54, v54
    v_exp_f32 v55, v55
    v_cvt_pk_bf16_f32 v80, v48, v49
    v_cvt_pk_bf16_f32 v81, v50, v51
    v_mfma_f32_32x32x16_bf16 v[112:127], v[184:187], v[88:91], v[112:127]
    v_exp_f32 v56, v56
    v_exp_f32 v57, v57
    v_exp_f32 v58, v58
    v_exp_f32 v59, v59
    v_cvt_pk_bf16_f32 v82, v52, v53
    v_cvt_pk_bf16_f32 v83, v54, v55
    v_mfma_f32_32x32x16_bf16 v[112:127], v[188:191], v[92:95], v[112:127]
    buffer_load_dwordx4 v[240:243], v0, s[8:11], s49 offen offset:2048
    v_exp_f32 v60, v60
    v_exp_f32 v61, v61
    v_exp_f32 v62, v62
    v_exp_f32 v63, v63
    v_cvt_pk_bf16_f32 v84, v56, v57
    v_cvt_pk_bf16_f32 v85, v58, v59
    v_cvt_pk_bf16_f32 v86, v60, v61
    v_cvt_pk_bf16_f32 v87, v62, v63
    s_waitcnt vmcnt(21)
    v_mfma_f32_32x32x16_bf16 v[48:63], v[192:195], v[16:19], 0
    v_exp_f32 v64, v64
    v_exp_f32 v65, v65
    v_exp_f32 v66, v66
    v_exp_f32 v67, v67
    v_mfma_f32_32x32x16_bf16 v[48:63], v[196:199], v[20:23], v[48:63]
    s_mov_b32 s26, 20480
    buffer_load_dwordx4 v[176:179], v0, s[20:23], s26 offen offset:0
    buffer_load_dwordx4 v[180:183], v0, s[20:23], s26 offen offset:1024
    v_exp_f32 v68, v68
    v_exp_f32 v69, v69
    v_exp_f32 v70, v70
    v_exp_f32 v71, v71
    v_cvt_pk_bf16_f32 v88, v64, v65
    v_cvt_pk_bf16_f32 v89, v66, v67
    v_mfma_f32_32x32x16_bf16 v[128:143], v[184:187], v[80:83], v[128:143]
    v_exp_f32 v72, v72
    v_exp_f32 v73, v73
    v_exp_f32 v74, v74
    v_exp_f32 v75, v75
    v_cvt_pk_bf16_f32 v90, v68, v69
    v_cvt_pk_bf16_f32 v91, v70, v71
    v_mfma_f32_32x32x16_bf16 v[128:143], v[188:191], v[84:87], v[128:143]
    buffer_load_dwordx4 v[244:247], v0, s[8:11], s49 offen offset:3072
    v_exp_f32 v76, v76
    v_exp_f32 v77, v77
    v_exp_f32 v78, v78
    v_exp_f32 v79, v79
    v_cvt_pk_bf16_f32 v92, v72, v73
    v_cvt_pk_bf16_f32 v93, v74, v75
    v_cvt_pk_bf16_f32 v94, v76, v77
    v_cvt_pk_bf16_f32 v95, v78, v79
    v_mfma_f32_32x32x16_bf16 v[64:79], v[192:195], v[24:27], 0
    s_add_u32 s49, s48, 12288
    buffer_load_dwordx4 v[248:251], v0, s[8:11], s49 offen offset:0
    v_exp_f32 v48, v48
    v_exp_f32 v49, v49
    v_exp_f32 v50, v50
    v_exp_f32 v51, v51
    v_mfma_f32_32x32x16_bf16 v[64:79], v[196:199], v[28:31], v[64:79]
    s_load_dwordx2 s[18:19], s[16:17], 572
    v_exp_f32 v52, v52
    v_exp_f32 v53, v53
    v_exp_f32 v54, v54
    v_exp_f32 v55, v55
    v_cvt_pk_bf16_f32 v80, v48, v49
    v_cvt_pk_bf16_f32 v81, v50, v51
    v_mfma_f32_32x32x16_bf16 v[144:159], v[184:187], v[88:91], v[144:159]
    v_exp_f32 v56, v56
    v_exp_f32 v57, v57
    v_exp_f32 v58, v58
    v_exp_f32 v59, v59
    v_cvt_pk_bf16_f32 v82, v52, v53
    v_cvt_pk_bf16_f32 v83, v54, v55
    v_mfma_f32_32x32x16_bf16 v[144:159], v[188:191], v[92:95], v[144:159]
    buffer_load_dwordx4 v[252:255], v0, s[8:11], s49 offen offset:1024
    v_exp_f32 v60, v60
    v_exp_f32 v61, v61
    v_exp_f32 v62, v62
    v_exp_f32 v63, v63
    v_cvt_pk_bf16_f32 v84, v56, v57
    v_cvt_pk_bf16_f32 v85, v58, v59
    v_cvt_pk_bf16_f32 v86, v60, v61
    v_cvt_pk_bf16_f32 v87, v62, v63
    v_mfma_f32_32x32x16_bf16 v[48:63], v[192:195], v[32:35], 0
    v_exp_f32 v64, v64
    v_exp_f32 v65, v65
    v_exp_f32 v66, v66
    v_exp_f32 v67, v67
    v_mfma_f32_32x32x16_bf16 v[48:63], v[196:199], v[36:39], v[48:63]
    v_exp_f32 v68, v68
    v_exp_f32 v69, v69
    v_exp_f32 v70, v70
    v_exp_f32 v71, v71
    v_cvt_pk_bf16_f32 v88, v64, v65
    v_cvt_pk_bf16_f32 v89, v66, v67
    s_waitcnt vmcnt(24)
    v_mfma_f32_32x32x16_bf16 v[96:111], v[200:203], v[80:83], v[96:111]
    s_mov_b32 s27, 20480
    buffer_load_dwordx4 v[184:187], v0, s[20:23], s27 offen offset:2048
    buffer_load_dwordx4 v[188:191], v0, s[20:23], s27 offen offset:3072
    v_exp_f32 v72, v72
    v_exp_f32 v73, v73
    v_exp_f32 v74, v74
    v_exp_f32 v75, v75
    v_cvt_pk_bf16_f32 v90, v68, v69
    v_cvt_pk_bf16_f32 v91, v70, v71
    v_mfma_f32_32x32x16_bf16 v[96:111], v[204:207], v[84:87], v[96:111]
    buffer_load_dwordx4 v[224:227], v0, s[8:11], s50 offen offset:0 sc1
    v_exp_f32 v76, v76
    v_exp_f32 v77, v77
    v_exp_f32 v78, v78
    v_exp_f32 v79, v79
    v_cvt_pk_bf16_f32 v92, v72, v73
    v_cvt_pk_bf16_f32 v93, v74, v75
    v_cvt_pk_bf16_f32 v94, v76, v77
    v_cvt_pk_bf16_f32 v95, v78, v79
    v_mfma_f32_32x32x16_bf16 v[64:79], v[192:195], v[40:43], 0
    buffer_load_dwordx4 v[228:231], v0, s[8:11], s50 offen offset:1024 sc1
    v_exp_f32 v48, v48
    v_exp_f32 v49, v49
    v_exp_f32 v50, v50
    v_exp_f32 v51, v51
    v_mfma_f32_32x32x16_bf16 v[64:79], v[196:199], v[44:47], v[64:79]
    s_load_dwordx2 s[18:19], s[16:17], 700
    v_exp_f32 v52, v52
    v_exp_f32 v53, v53
    v_exp_f32 v54, v54
    v_exp_f32 v55, v55
    v_cvt_pk_bf16_f32 v80, v48, v49
    v_cvt_pk_bf16_f32 v81, v50, v51
    v_mfma_f32_32x32x16_bf16 v[112:127], v[200:203], v[88:91], v[112:127]
    v_exp_f32 v56, v56
    v_exp_f32 v57, v57
    v_exp_f32 v58, v58
    v_exp_f32 v59, v59
    v_cvt_pk_bf16_f32 v82, v52, v53
    v_cvt_pk_bf16_f32 v83, v54, v55
    v_mfma_f32_32x32x16_bf16 v[112:127], v[204:207], v[92:95], v[112:127]
    s_mov_b32 m0, 143360
    s_nop 0
    buffer_load_dwordx4 v0, s[8:11], s51 offen lds
    v_exp_f32 v60, v60
    v_exp_f32 v61, v61
    v_exp_f32 v62, v62
    v_exp_f32 v63, v63
    v_cvt_pk_bf16_f32 v84, v56, v57
    v_cvt_pk_bf16_f32 v85, v58, v59
    v_cvt_pk_bf16_f32 v86, v60, v61
    v_cvt_pk_bf16_f32 v87, v62, v63
    s_waitcnt vmcnt(27)
    v_mfma_f32_32x32x16_bf16 v[48:63], v[208:211], v[16:19], 0
    v_exp_f32 v64, v64
    v_exp_f32 v65, v65
    v_exp_f32 v66, v66
    v_exp_f32 v67, v67
    v_mfma_f32_32x32x16_bf16 v[48:63], v[212:215], v[20:23], v[48:63]
    s_mov_b32 s26, 24576
    buffer_load_dwordx4 v[192:195], v0, s[20:23], s26 offen offset:0
    buffer_load_dwordx4 v[196:199], v0, s[20:23], s26 offen offset:1024
    v_exp_f32 v68, v68
    v_exp_f32 v69, v69
    v_exp_f32 v70, v70
    v_exp_f32 v71, v71
    v_cvt_pk_bf16_f32 v88, v64, v65
    v_cvt_pk_bf16_f32 v89, v66, v67
    v_mfma_f32_32x32x16_bf16 v[128:143], v[200:203], v[80:83], v[128:143]
    v_exp_f32 v72, v72
    v_exp_f32 v73, v73
    v_exp_f32 v74, v74
    v_exp_f32 v75, v75
    v_cvt_pk_bf16_f32 v90, v68, v69
    v_cvt_pk_bf16_f32 v91, v70, v71
    v_mfma_f32_32x32x16_bf16 v[128:143], v[204:207], v[84:87], v[128:143]
    s_add_u32 m0, s45, 57344
    s_add_u32 s46, s44, 0
    buffer_load_dwordx4 v0, s[8:11], s46 offen offset:0 lds
    v_exp_f32 v76, v76
    v_exp_f32 v77, v77
    v_exp_f32 v78, v78
    v_exp_f32 v79, v79
    v_cvt_pk_bf16_f32 v92, v72, v73
    v_cvt_pk_bf16_f32 v93, v74, v75
    v_cvt_pk_bf16_f32 v94, v76, v77
    v_cvt_pk_bf16_f32 v95, v78, v79
    v_mfma_f32_32x32x16_bf16 v[64:79], v[208:211], v[24:27], 0
    buffer_load_dwordx4 v0, s[8:11], s46 offen offset:1024 lds
    v_exp_f32 v48, v48
    v_exp_f32 v49, v49
    v_exp_f32 v50, v50
    v_exp_f32 v51, v51
    v_mfma_f32_32x32x16_bf16 v[64:79], v[212:215], v[28:31], v[64:79]
    s_load_dwordx2 s[18:19], s[16:17], 828
    v_exp_f32 v52, v52
    v_exp_f32 v53, v53
    v_exp_f32 v54, v54
    v_exp_f32 v55, v55
    v_cvt_pk_bf16_f32 v80, v48, v49
    v_cvt_pk_bf16_f32 v81, v50, v51
    v_mfma_f32_32x32x16_bf16 v[144:159], v[200:203], v[88:91], v[144:159]
    v_exp_f32 v56, v56
    v_exp_f32 v57, v57
    v_exp_f32 v58, v58
    v_exp_f32 v59, v59
    v_cvt_pk_bf16_f32 v82, v52, v53
    v_cvt_pk_bf16_f32 v83, v54, v55
    v_mfma_f32_32x32x16_bf16 v[144:159], v[204:207], v[92:95], v[144:159]
    buffer_load_dwordx4 v0, s[8:11], s46 offen offset:2048 lds
    v_exp_f32 v60, v60
    v_exp_f32 v61, v61
    v_exp_f32 v62, v62
    v_exp_f32 v63, v63
    v_cvt_pk_bf16_f32 v84, v56, v57
    v_cvt_pk_bf16_f32 v85, v58, v59
    v_cvt_pk_bf16_f32 v86, v60, v61
    v_cvt_pk_bf16_f32 v87, v62, v63
    v_mfma_f32_32x32x16_bf16 v[48:63], v[208:211], v[32:35], 0
    v_exp_f32 v64, v64
    v_exp_f32 v65, v65
    v_exp_f32 v66, v66
    v_exp_f32 v67, v67
    v_mfma_f32_32x32x16_bf16 v[48:63], v[212:215], v[36:39], v[48:63]
    v_exp_f32 v68, v68
    v_exp_f32 v69, v69
    v_exp_f32 v70, v70
    v_exp_f32 v71, v71
    v_cvt_pk_bf16_f32 v88, v64, v65
    v_cvt_pk_bf16_f32 v89, v66, v67
    s_waitcnt vmcnt(28)
    v_mfma_f32_32x32x16_bf16 v[96:111], v[216:219], v[80:83], v[96:111]
    s_mov_b32 s27, 24576
    buffer_load_dwordx4 v[200:203], v0, s[20:23], s27 offen offset:2048
    buffer_load_dwordx4 v[204:207], v0, s[20:23], s27 offen offset:3072
    v_exp_f32 v72, v72
    v_exp_f32 v73, v73
    v_exp_f32 v74, v74
    v_exp_f32 v75, v75
    v_cvt_pk_bf16_f32 v90, v68, v69
    v_cvt_pk_bf16_f32 v91, v70, v71
    v_mfma_f32_32x32x16_bf16 v[96:111], v[220:223], v[84:87], v[96:111]
    buffer_load_dwordx4 v0, s[8:11], s46 offen offset:3072 lds
    v_exp_f32 v76, v76
    v_exp_f32 v77, v77
    v_exp_f32 v78, v78
    v_exp_f32 v79, v79
    v_cvt_pk_bf16_f32 v92, v72, v73
    v_cvt_pk_bf16_f32 v93, v74, v75
    v_cvt_pk_bf16_f32 v94, v76, v77
    v_cvt_pk_bf16_f32 v95, v78, v79
    v_mfma_f32_32x32x16_bf16 v[64:79], v[208:211], v[40:43], 0
    s_add_u32 m0, s45, 61440
    s_add_u32 s46, s44, 4096
    buffer_load_dwordx4 v0, s[8:11], s46 offen offset:0 lds
    v_exp_f32 v48, v48
    v_exp_f32 v49, v49
    v_exp_f32 v50, v50
    v_exp_f32 v51, v51
    v_mfma_f32_32x32x16_bf16 v[64:79], v[212:215], v[44:47], v[64:79]
    s_load_dwordx2 s[18:19], s[16:17], 956
    v_exp_f32 v52, v52
    v_exp_f32 v53, v53
    v_exp_f32 v54, v54
    v_exp_f32 v55, v55
    v_cvt_pk_bf16_f32 v80, v48, v49
    v_cvt_pk_bf16_f32 v81, v50, v51
    v_mfma_f32_32x32x16_bf16 v[112:127], v[216:219], v[88:91], v[112:127]
    v_exp_f32 v56, v56
    v_exp_f32 v57, v57
    v_exp_f32 v58, v58
    v_exp_f32 v59, v59
    v_cvt_pk_bf16_f32 v82, v52, v53
    v_cvt_pk_bf16_f32 v83, v54, v55
    v_mfma_f32_32x32x16_bf16 v[112:127], v[220:223], v[92:95], v[112:127]
    buffer_load_dwordx4 v0, s[8:11], s46 offen offset:1024 lds
    v_exp_f32 v60, v60
    v_exp_f32 v61, v61
    v_exp_f32 v62, v62
    v_exp_f32 v63, v63
    v_cvt_pk_bf16_f32 v84, v56, v57
    v_cvt_pk_bf16_f32 v85, v58, v59
    v_cvt_pk_bf16_f32 v86, v60, v61
    v_cvt_pk_bf16_f32 v87, v62, v63
    s_waitcnt vmcnt(28)
    v_mfma_f32_32x32x16_bf16 v[48:63], v[160:163], v[16:19], 0
    v_exp_f32 v64, v64
    v_exp_f32 v65, v65
    v_exp_f32 v66, v66
    v_exp_f32 v67, v67
    v_mfma_f32_32x32x16_bf16 v[48:63], v[164:167], v[20:23], v[48:63]
    s_mov_b32 s26, 28672
    buffer_load_dwordx4 v[208:211], v0, s[20:23], s26 offen offset:0
    buffer_load_dwordx4 v[212:215], v0, s[20:23], s26 offen offset:1024
    v_exp_f32 v68, v68
    v_exp_f32 v69, v69
    v_exp_f32 v70, v70
    v_exp_f32 v71, v71
    v_cvt_pk_bf16_f32 v88, v64, v65
    v_cvt_pk_bf16_f32 v89, v66, v67
    v_mfma_f32_32x32x16_bf16 v[128:143], v[216:219], v[80:83], v[128:143]
    v_exp_f32 v72, v72
    v_exp_f32 v73, v73
    v_exp_f32 v74, v74
    v_exp_f32 v75, v75
    v_cvt_pk_bf16_f32 v90, v68, v69
    v_cvt_pk_bf16_f32 v91, v70, v71
    v_mfma_f32_32x32x16_bf16 v[128:143], v[220:223], v[84:87], v[128:143]
    buffer_load_dwordx4 v0, s[8:11], s46 offen offset:2048 lds
    v_exp_f32 v76, v76
    v_exp_f32 v77, v77
    v_exp_f32 v78, v78
    v_exp_f32 v79, v79
    v_cvt_pk_bf16_f32 v92, v72, v73
    v_cvt_pk_bf16_f32 v93, v74, v75
    v_cvt_pk_bf16_f32 v94, v76, v77
    v_cvt_pk_bf16_f32 v95, v78, v79
    v_mfma_f32_32x32x16_bf16 v[64:79], v[160:163], v[24:27], 0
    s_add_u32 m0, s45, 86016
    s_add_u32 s46, s44, 28672
    buffer_load_dwordx4 v0, s[8:11], s46 offen offset:0 lds
    v_exp_f32 v48, v48
    v_exp_f32 v49, v49
    v_exp_f32 v50, v50
    v_exp_f32 v51, v51
    v_mfma_f32_32x32x16_bf16 v[64:79], v[164:167], v[28:31], v[64:79]
    s_load_dwordx2 s[18:19], s[16:17], 1084
    v_exp_f32 v52, v52
    v_exp_f32 v53, v53
    v_exp_f32 v54, v54
    v_exp_f32 v55, v55
    v_cvt_pk_bf16_f32 v80, v48, v49
    v_cvt_pk_bf16_f32 v81, v50, v51
    v_mfma_f32_32x32x16_bf16 v[144:159], v[216:219], v[88:91], v[144:159]
    v_exp_f32 v56, v56
    v_exp_f32 v57, v57
    v_exp_f32 v58, v58
    v_exp_f32 v59, v59
    v_cvt_pk_bf16_f32 v82, v52, v53
    v_cvt_pk_bf16_f32 v83, v54, v55
    v_mfma_f32_32x32x16_bf16 v[144:159], v[220:223], v[92:95], v[144:159]
    buffer_load_dwordx4 v0, s[8:11], s46 offen offset:1024 lds
    v_exp_f32 v60, v60
    v_exp_f32 v61, v61
    v_exp_f32 v62, v62
    v_exp_f32 v63, v63
    v_cvt_pk_bf16_f32 v84, v56, v57
    v_cvt_pk_bf16_f32 v85, v58, v59
    v_cvt_pk_bf16_f32 v86, v60, v61
    v_cvt_pk_bf16_f32 v87, v62, v63
    v_mfma_f32_32x32x16_bf16 v[48:63], v[160:163], v[32:35], 0
    v_exp_f32 v64, v64
    v_exp_f32 v65, v65
    v_exp_f32 v66, v66
    v_exp_f32 v67, v67
    v_mfma_f32_32x32x16_bf16 v[48:63], v[164:167], v[36:39], v[48:63]
    v_exp_f32 v68, v68
    v_exp_f32 v69, v69
    v_exp_f32 v70, v70
    v_exp_f32 v71, v71
    v_cvt_pk_bf16_f32 v88, v64, v65
    v_cvt_pk_bf16_f32 v89, v66, v67
    s_waitcnt vmcnt(28)
    v_mfma_f32_32x32x16_bf16 v[96:111], v[168:171], v[80:83], v[96:111]
    s_mov_b32 s27, 28672
    buffer_load_dwordx4 v[216:219], v0, s[20:23], s27 offen offset:2048
    buffer_load_dwordx4 v[220:223], v0, s[20:23], s27 offen offset:3072
    v_exp_f32 v72, v72
    v_exp_f32 v73, v73
    v_exp_f32 v74, v74
    v_exp_f32 v75, v75
    v_cvt_pk_bf16_f32 v90, v68, v69
    v_cvt_pk_bf16_f32 v91, v70, v71
    v_mfma_f32_32x32x16_bf16 v[96:111], v[172:175], v[84:87], v[96:111]
    buffer_load_dwordx4 v0, s[8:11], s46 offen offset:2048 lds
    v_exp_f32 v76, v76
    v_exp_f32 v77, v77
    v_exp_f32 v78, v78
    v_exp_f32 v79, v79
    v_cvt_pk_bf16_f32 v92, v72, v73
    v_cvt_pk_bf16_f32 v93, v74, v75
    v_cvt_pk_bf16_f32 v94, v76, v77
    v_cvt_pk_bf16_f32 v95, v78, v79
    v_mfma_f32_32x32x16_bf16 v[64:79], v[160:163], v[40:43], 0
    buffer_load_dwordx4 v0, s[8:11], s46 offen offset:3072 lds
    v_exp_f32 v48, v48
    v_exp_f32 v49, v49
    v_exp_f32 v50, v50
    v_exp_f32 v51, v51
    v_mfma_f32_32x32x16_bf16 v[64:79], v[164:167], v[44:47], v[64:79]
    s_load_dwordx2 s[18:19], s[16:17], 1212
    v_exp_f32 v52, v52
    v_exp_f32 v53, v53
    v_exp_f32 v54, v54
    v_exp_f32 v55, v55
    v_cvt_pk_bf16_f32 v80, v48, v49
    v_cvt_pk_bf16_f32 v81, v50, v51
    v_mfma_f32_32x32x16_bf16 v[112:127], v[168:171], v[88:91], v[112:127]
    v_exp_f32 v56, v56
    v_exp_f32 v57, v57
    v_exp_f32 v58, v58
    v_exp_f32 v59, v59
    v_cvt_pk_bf16_f32 v82, v52, v53
    v_cvt_pk_bf16_f32 v83, v54, v55
    v_mfma_f32_32x32x16_bf16 v[112:127], v[172:175], v[92:95], v[112:127]
    s_add_u32 m0, s45, 90112
    s_add_u32 s46, s44, 32768
    buffer_load_dwordx4 v0, s[8:11], s46 offen offset:0 lds
    v_exp_f32 v60, v60
    v_exp_f32 v61, v61
    v_exp_f32 v62, v62
    v_exp_f32 v63, v63
    v_cvt_pk_bf16_f32 v84, v56, v57
    v_cvt_pk_bf16_f32 v85, v58, v59
    v_cvt_pk_bf16_f32 v86, v60, v61
    v_cvt_pk_bf16_f32 v87, v62, v63
    s_waitcnt vmcnt(28)
    v_mfma_f32_32x32x16_bf16 v[48:63], v[176:179], v[16:19], 0
    v_exp_f32 v64, v64
    v_exp_f32 v65, v65
    v_exp_f32 v66, v66
    v_exp_f32 v67, v67
    v_mfma_f32_32x32x16_bf16 v[48:63], v[180:183], v[20:23], v[48:63]
    s_mov_b32 s26, 32768
    buffer_load_dwordx4 v[160:163], v0, s[20:23], s26 offen offset:0
    buffer_load_dwordx4 v[164:167], v0, s[20:23], s26 offen offset:1024
    v_exp_f32 v68, v68
    v_exp_f32 v69, v69
    v_exp_f32 v70, v70
    v_exp_f32 v71, v71
    v_cvt_pk_bf16_f32 v88, v64, v65
    v_cvt_pk_bf16_f32 v89, v66, v67
    v_mfma_f32_32x32x16_bf16 v[128:143], v[168:171], v[80:83], v[128:143]
    v_exp_f32 v72, v72
    v_exp_f32 v73, v73
    v_exp_f32 v74, v74
    v_exp_f32 v75, v75
    v_cvt_pk_bf16_f32 v90, v68, v69
    v_cvt_pk_bf16_f32 v91, v70, v71
    v_mfma_f32_32x32x16_bf16 v[128:143], v[172:175], v[84:87], v[128:143]
    buffer_load_dwordx4 v0, s[8:11], s46 offen offset:1024 lds
    v_exp_f32 v76, v76
    v_exp_f32 v77, v77
    v_exp_f32 v78, v78
    v_exp_f32 v79, v79
    v_cvt_pk_bf16_f32 v92, v72, v73
    v_cvt_pk_bf16_f32 v93, v74, v75
    v_cvt_pk_bf16_f32 v94, v76, v77
    v_cvt_pk_bf16_f32 v95, v78, v79
    v_mfma_f32_32x32x16_bf16 v[64:79], v[176:179], v[24:27], 0
    buffer_load_dwordx4 v0, s[8:11], s46 offen offset:2048 lds
    v_exp_f32 v48, v48
    v_exp_f32 v49, v49
    v_exp_f32 v50, v50
    v_exp_f32 v51, v51
    v_mfma_f32_32x32x16_bf16 v[64:79], v[180:183], v[28:31], v[64:79]
    s_load_dwordx2 s[18:19], s[16:17], 1340
    v_exp_f32 v52, v52
    v_exp_f32 v53, v53
    v_exp_f32 v54, v54
    v_exp_f32 v55, v55
    v_cvt_pk_bf16_f32 v80, v48, v49
    v_cvt_pk_bf16_f32 v81, v50, v51
    v_mfma_f32_32x32x16_bf16 v[144:159], v[168:171], v[88:91], v[144:159]
    v_exp_f32 v56, v56
    v_exp_f32 v57, v57
    v_exp_f32 v58, v58
    v_exp_f32 v59, v59
    v_cvt_pk_bf16_f32 v82, v52, v53
    v_cvt_pk_bf16_f32 v83, v54, v55
    v_mfma_f32_32x32x16_bf16 v[144:159], v[172:175], v[92:95], v[144:159]
    s_add_u32 m0, s45, 114688
    s_add_u32 s46, s44, 57344
    buffer_load_dwordx4 v0, s[8:11], s46 offen offset:0 lds
    v_exp_f32 v60, v60
    v_exp_f32 v61, v61
    v_exp_f32 v62, v62
    v_exp_f32 v63, v63
    v_cvt_pk_bf16_f32 v84, v56, v57
    v_cvt_pk_bf16_f32 v85, v58, v59
    v_cvt_pk_bf16_f32 v86, v60, v61
    v_cvt_pk_bf16_f32 v87, v62, v63
    v_mfma_f32_32x32x16_bf16 v[48:63], v[176:179], v[32:35], 0
    v_exp_f32 v64, v64
    v_exp_f32 v65, v65
    v_exp_f32 v66, v66
    v_exp_f32 v67, v67
    v_mfma_f32_32x32x16_bf16 v[48:63], v[180:183], v[36:39], v[48:63]
    v_exp_f32 v68, v68
    v_exp_f32 v69, v69
    v_exp_f32 v70, v70
    v_exp_f32 v71, v71
    v_cvt_pk_bf16_f32 v88, v64, v65
    v_cvt_pk_bf16_f32 v89, v66, v67
    s_waitcnt vmcnt(28)
    v_mfma_f32_32x32x16_bf16 v[96:111], v[184:187], v[80:83], v[96:111]
    s_mov_b32 s27, 32768
    buffer_load_dwordx4 v[168:171], v0, s[20:23], s27 offen offset:2048
    buffer_load_dwordx4 v[172:175], v0, s[20:23], s27 offen offset:3072
    v_exp_f32 v72, v72
    v_exp_f32 v73, v73
    v_exp_f32 v74, v74
    v_exp_f32 v75, v75
    v_cvt_pk_bf16_f32 v90, v68, v69
    v_cvt_pk_bf16_f32 v91, v70, v71
    v_mfma_f32_32x32x16_bf16 v[96:111], v[188:191], v[84:87], v[96:111]
    buffer_load_dwordx4 v0, s[8:11], s46 offen offset:1024 lds
    v_exp_f32 v76, v76
    v_exp_f32 v77, v77
    v_exp_f32 v78, v78
    v_exp_f32 v79, v79
    v_cvt_pk_bf16_f32 v92, v72, v73
    v_cvt_pk_bf16_f32 v93, v74, v75
    v_cvt_pk_bf16_f32 v94, v76, v77
    v_cvt_pk_bf16_f32 v95, v78, v79
    v_mfma_f32_32x32x16_bf16 v[64:79], v[176:179], v[40:43], 0
    buffer_load_dwordx4 v0, s[8:11], s46 offen offset:2048 lds
    v_exp_f32 v48, v48
    v_exp_f32 v49, v49
    v_exp_f32 v50, v50
    v_exp_f32 v51, v51
    v_mfma_f32_32x32x16_bf16 v[64:79], v[180:183], v[44:47], v[64:79]
    s_load_dwordx2 s[18:19], s[16:17], 1468
    v_exp_f32 v52, v52
    v_exp_f32 v53, v53
    v_exp_f32 v54, v54
    v_exp_f32 v55, v55
    v_cvt_pk_bf16_f32 v80, v48, v49
    v_cvt_pk_bf16_f32 v81, v50, v51
    v_mfma_f32_32x32x16_bf16 v[112:127], v[184:187], v[88:91], v[112:127]
    v_exp_f32 v56, v56
    v_exp_f32 v57, v57
    v_exp_f32 v58, v58
    v_exp_f32 v59, v59
    v_cvt_pk_bf16_f32 v82, v52, v53
    v_cvt_pk_bf16_f32 v83, v54, v55
    v_mfma_f32_32x32x16_bf16 v[112:127], v[188:191], v[92:95], v[112:127]
    buffer_load_dwordx4 v0, s[8:11], s46 offen offset:3072 lds
    v_exp_f32 v60, v60
    v_exp_f32 v61, v61
    v_exp_f32 v62, v62
    v_exp_f32 v63, v63
    v_cvt_pk_bf16_f32 v84, v56, v57
    v_cvt_pk_bf16_f32 v85, v58, v59
    v_cvt_pk_bf16_f32 v86, v60, v61
    v_cvt_pk_bf16_f32 v87, v62, v63
    s_waitcnt vmcnt(28)
    v_mfma_f32_32x32x16_bf16 v[48:63], v[192:195], v[16:19], 0
    v_exp_f32 v64, v64
    v_exp_f32 v65, v65
    v_exp_f32 v66, v66
    v_exp_f32 v67, v67
    v_mfma_f32_32x32x16_bf16 v[48:63], v[196:199], v[20:23], v[48:63]
    s_mov_b32 s26, 36864
    buffer_load_dwordx4 v[176:179], v0, s[20:23], s26 offen offset:0
    buffer_load_dwordx4 v[180:183], v0, s[20:23], s26 offen offset:1024
    v_exp_f32 v68, v68
    v_exp_f32 v69, v69
    v_exp_f32 v70, v70
    v_exp_f32 v71, v71
    v_cvt_pk_bf16_f32 v88, v64, v65
    v_cvt_pk_bf16_f32 v89, v66, v67
    v_mfma_f32_32x32x16_bf16 v[128:143], v[184:187], v[80:83], v[128:143]
    v_exp_f32 v72, v72
    v_exp_f32 v73, v73
    v_exp_f32 v74, v74
    v_exp_f32 v75, v75
    v_cvt_pk_bf16_f32 v90, v68, v69
    v_cvt_pk_bf16_f32 v91, v70, v71
    v_mfma_f32_32x32x16_bf16 v[128:143], v[188:191], v[84:87], v[128:143]
    s_add_u32 m0, s45, 118784
    s_add_u32 s46, s44, 61440
    buffer_load_dwordx4 v0, s[8:11], s46 offen offset:0 lds
    v_exp_f32 v76, v76
    v_exp_f32 v77, v77
    v_exp_f32 v78, v78
    v_exp_f32 v79, v79
    v_cvt_pk_bf16_f32 v92, v72, v73
    v_cvt_pk_bf16_f32 v93, v74, v75
    v_cvt_pk_bf16_f32 v94, v76, v77
    v_cvt_pk_bf16_f32 v95, v78, v79
    v_mfma_f32_32x32x16_bf16 v[64:79], v[192:195], v[24:27], 0
    buffer_load_dwordx4 v0, s[8:11], s46 offen offset:1024 lds
    v_exp_f32 v48, v48
    v_exp_f32 v49, v49
    v_exp_f32 v50, v50
    v_exp_f32 v51, v51
    v_mfma_f32_32x32x16_bf16 v[64:79], v[196:199], v[28:31], v[64:79]
    s_load_dwordx2 s[18:19], s[16:17], 1596
    v_exp_f32 v52, v52
    v_exp_f32 v53, v53
    v_exp_f32 v54, v54
    v_exp_f32 v55, v55
    v_cvt_pk_bf16_f32 v80, v48, v49
    v_cvt_pk_bf16_f32 v81, v50, v51
    v_mfma_f32_32x32x16_bf16 v[144:159], v[184:187], v[88:91], v[144:159]
    v_exp_f32 v56, v56
    v_exp_f32 v57, v57
    v_exp_f32 v58, v58
    v_exp_f32 v59, v59
    v_cvt_pk_bf16_f32 v82, v52, v53
    v_cvt_pk_bf16_f32 v83, v54, v55
    v_mfma_f32_32x32x16_bf16 v[144:159], v[188:191], v[92:95], v[144:159]
    buffer_load_dwordx4 v0, s[8:11], s46 offen offset:2048 lds
    v_exp_f32 v60, v60
    v_exp_f32 v61, v61
    v_exp_f32 v62, v62
    v_exp_f32 v63, v63
    v_cvt_pk_bf16_f32 v84, v56, v57
    v_cvt_pk_bf16_f32 v85, v58, v59
    v_cvt_pk_bf16_f32 v86, v60, v61
    v_cvt_pk_bf16_f32 v87, v62, v63
    v_mfma_f32_32x32x16_bf16 v[48:63], v[192:195], v[32:35], 0
    v_exp_f32 v64, v64
    v_exp_f32 v65, v65
    v_exp_f32 v66, v66
    v_exp_f32 v67, v67
    v_mfma_f32_32x32x16_bf16 v[48:63], v[196:199], v[36:39], v[48:63]
    v_exp_f32 v68, v68
    v_exp_f32 v69, v69
    v_exp_f32 v70, v70
    v_exp_f32 v71, v71
    v_cvt_pk_bf16_f32 v88, v64, v65
    v_cvt_pk_bf16_f32 v89, v66, v67
    s_waitcnt vmcnt(28)
    v_mfma_f32_32x32x16_bf16 v[96:111], v[200:203], v[80:83], v[96:111]
    s_mov_b32 s27, 36864
    buffer_load_dwordx4 v[184:187], v0, s[20:23], s27 offen offset:2048
    buffer_load_dwordx4 v[188:191], v0, s[20:23], s27 offen offset:3072
    v_exp_f32 v72, v72
    v_exp_f32 v73, v73
    v_exp_f32 v74, v74
    v_exp_f32 v75, v75
    v_cvt_pk_bf16_f32 v90, v68, v69
    v_cvt_pk_bf16_f32 v91, v70, v71
    v_mfma_f32_32x32x16_bf16 v[96:111], v[204:207], v[84:87], v[96:111]
    s_add_u32 s52, s54, 0
    buffer_load_dwordx4 a[0:3], v0, s[8:11], s52 offen offset:0
    v_exp_f32 v76, v76
    v_exp_f32 v77, v77
    v_exp_f32 v78, v78
    v_exp_f32 v79, v79
    v_cvt_pk_bf16_f32 v92, v72, v73
    v_cvt_pk_bf16_f32 v93, v74, v75
    v_cvt_pk_bf16_f32 v94, v76, v77
    v_cvt_pk_bf16_f32 v95, v78, v79
    v_mfma_f32_32x32x16_bf16 v[64:79], v[192:195], v[40:43], 0
    s_add_u32 s53, s52, s55
    buffer_load_dwordx4 a[4:7], v0, s[8:11], s53 offen offset:0
    v_exp_f32 v48, v48
    v_exp_f32 v49, v49
    v_exp_f32 v50, v50
    v_exp_f32 v51, v51
    v_mfma_f32_32x32x16_bf16 v[64:79], v[196:199], v[44:47], v[64:79]
    s_load_dwordx2 s[18:19], s[16:17], 1724
    v_exp_f32 v52, v52
    v_exp_f32 v53, v53
    v_exp_f32 v54, v54
    v_exp_f32 v55, v55
    v_cvt_pk_bf16_f32 v80, v48, v49
    v_cvt_pk_bf16_f32 v81, v50, v51
    v_mfma_f32_32x32x16_bf16 v[112:127], v[200:203], v[88:91], v[112:127]
    v_exp_f32 v56, v56
    v_exp_f32 v57, v57
    v_exp_f32 v58, v58
    v_exp_f32 v59, v59
    v_cvt_pk_bf16_f32 v82, v52, v53
    v_cvt_pk_bf16_f32 v83, v54, v55
    v_mfma_f32_32x32x16_bf16 v[112:127], v[204:207], v[92:95], v[112:127]
    buffer_load_dwordx4 a[8:11], v0, s[8:11], s52 offen offset:1024
    v_exp_f32 v60, v60
    v_exp_f32 v61, v61
    v_exp_f32 v62, v62
    v_exp_f32 v63, v63
    v_cvt_pk_bf16_f32 v84, v56, v57
    v_cvt_pk_bf16_f32 v85, v58, v59
    v_cvt_pk_bf16_f32 v86, v60, v61
    v_cvt_pk_bf16_f32 v87, v62, v63
    s_waitcnt vmcnt(28)
    v_mfma_f32_32x32x16_bf16 v[48:63], v[208:211], v[16:19], 0
    v_exp_f32 v64, v64
    v_exp_f32 v65, v65
    v_exp_f32 v66, v66
    v_exp_f32 v67, v67
    v_mfma_f32_32x32x16_bf16 v[48:63], v[212:215], v[20:23], v[48:63]
    s_mov_b32 s26, 40960
    buffer_load_dwordx4 v[192:195], v0, s[20:23], s26 offen offset:0
    buffer_load_dwordx4 v[196:199], v0, s[20:23], s26 offen offset:1024
    v_exp_f32 v68, v68
    v_exp_f32 v69, v69
    v_exp_f32 v70, v70
    v_exp_f32 v71, v71
    v_cvt_pk_bf16_f32 v88, v64, v65
    v_cvt_pk_bf16_f32 v89, v66, v67
    v_mfma_f32_32x32x16_bf16 v[128:143], v[200:203], v[80:83], v[128:143]
    v_exp_f32 v72, v72
    v_exp_f32 v73, v73
    v_exp_f32 v74, v74
    v_exp_f32 v75, v75
    v_cvt_pk_bf16_f32 v90, v68, v69
    v_cvt_pk_bf16_f32 v91, v70, v71
    v_mfma_f32_32x32x16_bf16 v[128:143], v[204:207], v[84:87], v[128:143]
    buffer_load_dwordx4 a[12:15], v0, s[8:11], s53 offen offset:1024
    v_exp_f32 v76, v76
    v_exp_f32 v77, v77
    v_exp_f32 v78, v78
    v_exp_f32 v79, v79
    v_cvt_pk_bf16_f32 v92, v72, v73
    v_cvt_pk_bf16_f32 v93, v74, v75
    v_cvt_pk_bf16_f32 v94, v76, v77
    v_cvt_pk_bf16_f32 v95, v78, v79
    v_mfma_f32_32x32x16_bf16 v[64:79], v[208:211], v[24:27], 0
    buffer_load_dwordx4 a[16:19], v0, s[8:11], s52 offen offset:2048
    v_exp_f32 v48, v48
    v_exp_f32 v49, v49
    v_exp_f32 v50, v50
    v_exp_f32 v51, v51
    v_mfma_f32_32x32x16_bf16 v[64:79], v[212:215], v[28:31], v[64:79]
    s_load_dwordx2 s[18:19], s[16:17], 1852
    v_exp_f32 v52, v52
    v_exp_f32 v53, v53
    v_exp_f32 v54, v54
    v_exp_f32 v55, v55
    v_cvt_pk_bf16_f32 v80, v48, v49
    v_cvt_pk_bf16_f32 v81, v50, v51
    v_mfma_f32_32x32x16_bf16 v[144:159], v[200:203], v[88:91], v[144:159]
    v_exp_f32 v56, v56
    v_exp_f32 v57, v57
    v_exp_f32 v58, v58
    v_exp_f32 v59, v59
    v_cvt_pk_bf16_f32 v82, v52, v53
    v_cvt_pk_bf16_f32 v83, v54, v55
    v_mfma_f32_32x32x16_bf16 v[144:159], v[204:207], v[92:95], v[144:159]
    buffer_load_dwordx4 a[20:23], v0, s[8:11], s53 offen offset:2048
    v_exp_f32 v60, v60
    v_exp_f32 v61, v61
    v_exp_f32 v62, v62
    v_exp_f32 v63, v63
    v_cvt_pk_bf16_f32 v84, v56, v57
    v_cvt_pk_bf16_f32 v85, v58, v59
    v_cvt_pk_bf16_f32 v86, v60, v61
    v_cvt_pk_bf16_f32 v87, v62, v63
    v_mfma_f32_32x32x16_bf16 v[48:63], v[208:211], v[32:35], 0
    v_exp_f32 v64, v64
    v_exp_f32 v65, v65
    v_exp_f32 v66, v66
    v_exp_f32 v67, v67
    v_mfma_f32_32x32x16_bf16 v[48:63], v[212:215], v[36:39], v[48:63]
    v_exp_f32 v68, v68
    v_exp_f32 v69, v69
    v_exp_f32 v70, v70
    v_exp_f32 v71, v71
    v_cvt_pk_bf16_f32 v88, v64, v65
    v_cvt_pk_bf16_f32 v89, v66, v67
    s_waitcnt vmcnt(28)
    v_mfma_f32_32x32x16_bf16 v[96:111], v[216:219], v[80:83], v[96:111]
    s_mov_b32 s27, 40960
    buffer_load_dwordx4 v[200:203], v0, s[20:23], s27 offen offset:2048
    buffer_load_dwordx4 v[204:207], v0, s[20:23], s27 offen offset:3072
    v_exp_f32 v72, v72
    v_exp_f32 v73, v73
    v_exp_f32 v74, v74
    v_exp_f32 v75, v75
    v_cvt_pk_bf16_f32 v90, v68, v69
    v_cvt_pk_bf16_f32 v91, v70, v71
    v_mfma_f32_32x32x16_bf16 v[96:111], v[220:223], v[84:87], v[96:111]
    buffer_load_dwordx4 a[24:27], v0, s[8:11], s52 offen offset:3072
    v_exp_f32 v76, v76
    v_exp_f32 v77, v77
    v_exp_f32 v78, v78
    v_exp_f32 v79, v79
    v_cvt_pk_bf16_f32 v92, v72, v73
    v_cvt_pk_bf16_f32 v93, v74, v75
    v_cvt_pk_bf16_f32 v94, v76, v77
    v_cvt_pk_bf16_f32 v95, v78, v79
    v_mfma_f32_32x32x16_bf16 v[64:79], v[208:211], v[40:43], 0
    buffer_load_dwordx4 a[28:31], v0, s[8:11], s53 offen offset:3072
    v_exp_f32 v48, v48
    v_exp_f32 v49, v49
    v_exp_f32 v50, v50
    v_exp_f32 v51, v51
    v_mfma_f32_32x32x16_bf16 v[64:79], v[212:215], v[44:47], v[64:79]
    s_load_dwordx2 s[18:19], s[16:17], 1980
    v_exp_f32 v52, v52
    v_exp_f32 v53, v53
    v_exp_f32 v54, v54
    v_exp_f32 v55, v55
    v_cvt_pk_bf16_f32 v80, v48, v49
    v_cvt_pk_bf16_f32 v81, v50, v51
    v_mfma_f32_32x32x16_bf16 v[112:127], v[216:219], v[88:91], v[112:127]
    v_exp_f32 v56, v56
    v_exp_f32 v57, v57
    v_exp_f32 v58, v58
    v_exp_f32 v59, v59
    v_cvt_pk_bf16_f32 v82, v52, v53
    v_cvt_pk_bf16_f32 v83, v54, v55
    v_mfma_f32_32x32x16_bf16 v[112:127], v[220:223], v[92:95], v[112:127]
    s_add_u32 s52, s54, 4096
    buffer_load_dwordx4 a[32:35], v0, s[8:11], s52 offen offset:0
    v_exp_f32 v60, v60
    v_exp_f32 v61, v61
    v_exp_f32 v62, v62
    v_exp_f32 v63, v63
    v_cvt_pk_bf16_f32 v84, v56, v57
    v_cvt_pk_bf16_f32 v85, v58, v59
    v_cvt_pk_bf16_f32 v86, v60, v61
    v_cvt_pk_bf16_f32 v87, v62, v63
    s_waitcnt vmcnt(28)
    v_mfma_f32_32x32x16_bf16 v[48:63], v[160:163], v[16:19], 0
    v_exp_f32 v64, v64
    v_exp_f32 v65, v65
    v_exp_f32 v66, v66
    v_exp_f32 v67, v67
    v_mfma_f32_32x32x16_bf16 v[48:63], v[164:167], v[20:23], v[48:63]
    s_mov_b32 s26, 45056
    buffer_load_dwordx4 v[208:211], v0, s[20:23], s26 offen offset:0
    buffer_load_dwordx4 v[212:215], v0, s[20:23], s26 offen offset:1024
    v_exp_f32 v68, v68
    v_exp_f32 v69, v69
    v_exp_f32 v70, v70
    v_exp_f32 v71, v71
    v_cvt_pk_bf16_f32 v88, v64, v65
    v_cvt_pk_bf16_f32 v89, v66, v67
    v_mfma_f32_32x32x16_bf16 v[128:143], v[216:219], v[80:83], v[128:143]
    v_exp_f32 v72, v72
    v_exp_f32 v73, v73
    v_exp_f32 v74, v74
    v_exp_f32 v75, v75
    v_cvt_pk_bf16_f32 v90, v68, v69
    v_cvt_pk_bf16_f32 v91, v70, v71
    v_mfma_f32_32x32x16_bf16 v[128:143], v[220:223], v[84:87], v[128:143]
    s_add_u32 s53, s52, s55
    buffer_load_dwordx4 a[36:39], v0, s[8:11], s53 offen offset:0
    v_exp_f32 v76, v76
    v_exp_f32 v77, v77
    v_exp_f32 v78, v78
    v_exp_f32 v79, v79
    v_cvt_pk_bf16_f32 v92, v72, v73
    v_cvt_pk_bf16_f32 v93, v74, v75
    v_cvt_pk_bf16_f32 v94, v76, v77
    v_cvt_pk_bf16_f32 v95, v78, v79
    v_mfma_f32_32x32x16_bf16 v[64:79], v[160:163], v[24:27], 0
    buffer_load_dwordx4 a[40:43], v0, s[8:11], s52 offen offset:1024
    v_exp_f32 v48, v48
    v_exp_f32 v49, v49
    v_exp_f32 v50, v50
    v_exp_f32 v51, v51
    v_mfma_f32_32x32x16_bf16 v[64:79], v[164:167], v[28:31], v[64:79]
    s_load_dwordx2 s[18:19], s[16:17], 2108
    v_exp_f32 v52, v52
    v_exp_f32 v53, v53
    v_exp_f32 v54, v54
    v_exp_f32 v55, v55
    v_cvt_pk_bf16_f32 v80, v48, v49
    v_cvt_pk_bf16_f32 v81, v50, v51
    v_mfma_f32_32x32x16_bf16 v[144:159], v[216:219], v[88:91], v[144:159]
    v_exp_f32 v56, v56
    v_exp_f32 v57, v57
    v_exp_f32 v58, v58
    v_exp_f32 v59, v59
    v_cvt_pk_bf16_f32 v82, v52, v53
    v_cvt_pk_bf16_f32 v83, v54, v55
    v_mfma_f32_32x32x16_bf16 v[144:159], v[220:223], v[92:95], v[144:159]
    buffer_load_dwordx4 a[44:47], v0, s[8:11], s53 offen offset:1024
    v_exp_f32 v60, v60
    v_exp_f32 v61, v61
    v_exp_f32 v62, v62
    v_exp_f32 v63, v63
    v_cvt_pk_bf16_f32 v84, v56, v57
    v_cvt_pk_bf16_f32 v85, v58, v59
    v_cvt_pk_bf16_f32 v86, v60, v61
    v_cvt_pk_bf16_f32 v87, v62, v63
    v_mfma_f32_32x32x16_bf16 v[48:63], v[160:163], v[32:35], 0
    v_exp_f32 v64, v64
    v_exp_f32 v65, v65
    v_exp_f32 v66, v66
    v_exp_f32 v67, v67
    v_mfma_f32_32x32x16_bf16 v[48:63], v[164:167], v[36:39], v[48:63]
    v_exp_f32 v68, v68
    v_exp_f32 v69, v69
    v_exp_f32 v70, v70
    v_exp_f32 v71, v71
    v_cvt_pk_bf16_f32 v88, v64, v65
    v_cvt_pk_bf16_f32 v89, v66, v67
    s_waitcnt vmcnt(28)
    v_mfma_f32_32x32x16_bf16 v[96:111], v[168:171], v[80:83], v[96:111]
    s_mov_b32 s27, 45056
    buffer_load_dwordx4 v[216:219], v0, s[20:23], s27 offen offset:2048
    buffer_load_dwordx4 v[220:223], v0, s[20:23], s27 offen offset:3072
    v_exp_f32 v72, v72
    v_exp_f32 v73, v73
    v_exp_f32 v74, v74
    v_exp_f32 v75, v75
    v_cvt_pk_bf16_f32 v90, v68, v69
    v_cvt_pk_bf16_f32 v91, v70, v71
    v_mfma_f32_32x32x16_bf16 v[96:111], v[172:175], v[84:87], v[96:111]
    buffer_load_dwordx4 a[48:51], v0, s[8:11], s52 offen offset:2048
    v_exp_f32 v76, v76
    v_exp_f32 v77, v77
    v_exp_f32 v78, v78
    v_exp_f32 v79, v79
    v_cvt_pk_bf16_f32 v92, v72, v73
    v_cvt_pk_bf16_f32 v93, v74, v75
    v_cvt_pk_bf16_f32 v94, v76, v77
    v_cvt_pk_bf16_f32 v95, v78, v79
    v_mfma_f32_32x32x16_bf16 v[64:79], v[160:163], v[40:43], 0
    buffer_load_dwordx4 a[52:55], v0, s[8:11], s53 offen offset:2048
    v_exp_f32 v48, v48
    v_exp_f32 v49, v49
    v_exp_f32 v50, v50
    v_exp_f32 v51, v51
    v_mfma_f32_32x32x16_bf16 v[64:79], v[164:167], v[44:47], v[64:79]
    s_load_dwordx2 s[18:19], s[16:17], 2236
    v_exp_f32 v52, v52
    v_exp_f32 v53, v53
    v_exp_f32 v54, v54
    v_exp_f32 v55, v55
    v_cvt_pk_bf16_f32 v80, v48, v49
    v_cvt_pk_bf16_f32 v81, v50, v51
    v_mfma_f32_32x32x16_bf16 v[112:127], v[168:171], v[88:91], v[112:127]
    v_exp_f32 v56, v56
    v_exp_f32 v57, v57
    v_exp_f32 v58, v58
    v_exp_f32 v59, v59
    v_cvt_pk_bf16_f32 v82, v52, v53
    v_cvt_pk_bf16_f32 v83, v54, v55
    v_mfma_f32_32x32x16_bf16 v[112:127], v[172:175], v[92:95], v[112:127]
    buffer_load_dwordx4 a[56:59], v0, s[8:11], s52 offen offset:3072
    v_exp_f32 v60, v60
    v_exp_f32 v61, v61
    v_exp_f32 v62, v62
    v_exp_f32 v63, v63
    v_cvt_pk_bf16_f32 v84, v56, v57
    v_cvt_pk_bf16_f32 v85, v58, v59
    v_cvt_pk_bf16_f32 v86, v60, v61
    v_cvt_pk_bf16_f32 v87, v62, v63
    s_waitcnt vmcnt(28)
    v_mfma_f32_32x32x16_bf16 v[48:63], v[176:179], v[16:19], 0
    v_exp_f32 v64, v64
    v_exp_f32 v65, v65
    v_exp_f32 v66, v66
    v_exp_f32 v67, v67
    v_mfma_f32_32x32x16_bf16 v[48:63], v[180:183], v[20:23], v[48:63]
    s_mov_b32 s26, 49152
    buffer_load_dwordx4 v[160:163], v0, s[20:23], s26 offen offset:0
    buffer_load_dwordx4 v[164:167], v0, s[20:23], s26 offen offset:1024
    v_exp_f32 v68, v68
    v_exp_f32 v69, v69
    v_exp_f32 v70, v70
    v_exp_f32 v71, v71
    v_cvt_pk_bf16_f32 v88, v64, v65
    v_cvt_pk_bf16_f32 v89, v66, v67
    v_mfma_f32_32x32x16_bf16 v[128:143], v[168:171], v[80:83], v[128:143]
    v_exp_f32 v72, v72
    v_exp_f32 v73, v73
    v_exp_f32 v74, v74
    v_exp_f32 v75, v75
    v_cvt_pk_bf16_f32 v90, v68, v69
    v_cvt_pk_bf16_f32 v91, v70, v71
    v_mfma_f32_32x32x16_bf16 v[128:143], v[172:175], v[84:87], v[128:143]
    buffer_load_dwordx4 a[60:63], v0, s[8:11], s53 offen offset:3072
    v_exp_f32 v76, v76
    v_exp_f32 v77, v77
    v_exp_f32 v78, v78
    v_exp_f32 v79, v79
    v_cvt_pk_bf16_f32 v92, v72, v73
    v_cvt_pk_bf16_f32 v93, v74, v75
    v_cvt_pk_bf16_f32 v94, v76, v77
    v_cvt_pk_bf16_f32 v95, v78, v79
    v_mfma_f32_32x32x16_bf16 v[64:79], v[176:179], v[24:27], 0
    s_add_u32 s52, s54, 8192
    buffer_load_dwordx4 a[64:67], v0, s[8:11], s52 offen offset:0
    v_exp_f32 v48, v48
    v_exp_f32 v49, v49
    v_exp_f32 v50, v50
    v_exp_f32 v51, v51
    v_mfma_f32_32x32x16_bf16 v[64:79], v[180:183], v[28:31], v[64:79]
    s_load_dwordx2 s[18:19], s[16:17], 2364
    v_exp_f32 v52, v52
    v_exp_f32 v53, v53
    v_exp_f32 v54, v54
    v_exp_f32 v55, v55
    v_cvt_pk_bf16_f32 v80, v48, v49
    v_cvt_pk_bf16_f32 v81, v50, v51
    v_mfma_f32_32x32x16_bf16 v[144:159], v[168:171], v[88:91], v[144:159]
    v_exp_f32 v56, v56
    v_exp_f32 v57, v57
    v_exp_f32 v58, v58
    v_exp_f32 v59, v59
    v_cvt_pk_bf16_f32 v82, v52, v53
    v_cvt_pk_bf16_f32 v83, v54, v55
    v_mfma_f32_32x32x16_bf16 v[144:159], v[172:175], v[92:95], v[144:159]
    s_add_u32 s53, s52, s55
    buffer_load_dwordx4 a[68:71], v0, s[8:11], s53 offen offset:0
    v_exp_f32 v60, v60
    v_exp_f32 v61, v61
    v_exp_f32 v62, v62
    v_exp_f32 v63, v63
    v_cvt_pk_bf16_f32 v84, v56, v57
    v_cvt_pk_bf16_f32 v85, v58, v59
    v_cvt_pk_bf16_f32 v86, v60, v61
    v_cvt_pk_bf16_f32 v87, v62, v63
    v_mfma_f32_32x32x16_bf16 v[48:63], v[176:179], v[32:35], 0
    v_exp_f32 v64, v64
    v_exp_f32 v65, v65
    v_exp_f32 v66, v66
    v_exp_f32 v67, v67
    v_mfma_f32_32x32x16_bf16 v[48:63], v[180:183], v[36:39], v[48:63]
    v_exp_f32 v68, v68
    v_exp_f32 v69, v69
    v_exp_f32 v70, v70
    v_exp_f32 v71, v71
    v_cvt_pk_bf16_f32 v88, v64, v65
    v_cvt_pk_bf16_f32 v89, v66, v67
    s_waitcnt vmcnt(28)
    v_mfma_f32_32x32x16_bf16 v[96:111], v[184:187], v[80:83], v[96:111]
    s_mov_b32 s27, 49152
    buffer_load_dwordx4 v[168:171], v0, s[20:23], s27 offen offset:2048
    buffer_load_dwordx4 v[172:175], v0, s[20:23], s27 offen offset:3072
    v_exp_f32 v72, v72
    v_exp_f32 v73, v73
    v_exp_f32 v74, v74
    v_exp_f32 v75, v75
    v_cvt_pk_bf16_f32 v90, v68, v69
    v_cvt_pk_bf16_f32 v91, v70, v71
    v_mfma_f32_32x32x16_bf16 v[96:111], v[188:191], v[84:87], v[96:111]
    buffer_load_dwordx4 a[72:75], v0, s[8:11], s52 offen offset:1024
    v_exp_f32 v76, v76
    v_exp_f32 v77, v77
    v_exp_f32 v78, v78
    v_exp_f32 v79, v79
    v_cvt_pk_bf16_f32 v92, v72, v73
    v_cvt_pk_bf16_f32 v93, v74, v75
    v_cvt_pk_bf16_f32 v94, v76, v77
    v_cvt_pk_bf16_f32 v95, v78, v79
    v_mfma_f32_32x32x16_bf16 v[64:79], v[176:179], v[40:43], 0
    buffer_load_dwordx4 a[76:79], v0, s[8:11], s53 offen offset:1024
    v_exp_f32 v48, v48
    v_exp_f32 v49, v49
    v_exp_f32 v50, v50
    v_exp_f32 v51, v51
    v_mfma_f32_32x32x16_bf16 v[64:79], v[180:183], v[44:47], v[64:79]
    s_load_dwordx2 s[18:19], s[16:17], 2492
    v_exp_f32 v52, v52
    v_exp_f32 v53, v53
    v_exp_f32 v54, v54
    v_exp_f32 v55, v55
    v_cvt_pk_bf16_f32 v80, v48, v49
    v_cvt_pk_bf16_f32 v81, v50, v51
    v_mfma_f32_32x32x16_bf16 v[112:127], v[184:187], v[88:91], v[112:127]
    v_exp_f32 v56, v56
    v_exp_f32 v57, v57
    v_exp_f32 v58, v58
    v_exp_f32 v59, v59
    v_cvt_pk_bf16_f32 v82, v52, v53
    v_cvt_pk_bf16_f32 v83, v54, v55
    v_mfma_f32_32x32x16_bf16 v[112:127], v[188:191], v[92:95], v[112:127]
    buffer_load_dwordx4 a[80:83], v0, s[8:11], s52 offen offset:2048
    v_exp_f32 v60, v60
    v_exp_f32 v61, v61
    v_exp_f32 v62, v62
    v_exp_f32 v63, v63
    v_cvt_pk_bf16_f32 v84, v56, v57
    v_cvt_pk_bf16_f32 v85, v58, v59
    v_cvt_pk_bf16_f32 v86, v60, v61
    v_cvt_pk_bf16_f32 v87, v62, v63
    s_waitcnt vmcnt(28)
    v_mfma_f32_32x32x16_bf16 v[48:63], v[192:195], v[16:19], 0
    v_exp_f32 v64, v64
    v_exp_f32 v65, v65
    v_exp_f32 v66, v66
    v_exp_f32 v67, v67
    v_mfma_f32_32x32x16_bf16 v[48:63], v[196:199], v[20:23], v[48:63]
    s_mov_b32 s26, 53248
    buffer_load_dwordx4 v[176:179], v0, s[20:23], s26 offen offset:0
    buffer_load_dwordx4 v[180:183], v0, s[20:23], s26 offen offset:1024
    v_exp_f32 v68, v68
    v_exp_f32 v69, v69
    v_exp_f32 v70, v70
    v_exp_f32 v71, v71
    v_cvt_pk_bf16_f32 v88, v64, v65
    v_cvt_pk_bf16_f32 v89, v66, v67
    v_mfma_f32_32x32x16_bf16 v[128:143], v[184:187], v[80:83], v[128:143]
    v_exp_f32 v72, v72
    v_exp_f32 v73, v73
    v_exp_f32 v74, v74
    v_exp_f32 v75, v75
    v_cvt_pk_bf16_f32 v90, v68, v69
    v_cvt_pk_bf16_f32 v91, v70, v71
    v_mfma_f32_32x32x16_bf16 v[128:143], v[188:191], v[84:87], v[128:143]
    buffer_load_dwordx4 a[84:87], v0, s[8:11], s53 offen offset:2048
    v_exp_f32 v76, v76
    v_exp_f32 v77, v77
    v_exp_f32 v78, v78
    v_exp_f32 v79, v79
    v_cvt_pk_bf16_f32 v92, v72, v73
    v_cvt_pk_bf16_f32 v93, v74, v75
    v_cvt_pk_bf16_f32 v94, v76, v77
    v_cvt_pk_bf16_f32 v95, v78, v79
    v_mfma_f32_32x32x16_bf16 v[64:79], v[192:195], v[24:27], 0
    buffer_load_dwordx4 a[88:91], v0, s[8:11], s52 offen offset:3072
    v_exp_f32 v48, v48
    v_exp_f32 v49, v49
    v_exp_f32 v50, v50
    v_exp_f32 v51, v51
    v_mfma_f32_32x32x16_bf16 v[64:79], v[196:199], v[28:31], v[64:79]
    s_load_dwordx2 s[18:19], s[16:17], 2620
    v_exp_f32 v52, v52
    v_exp_f32 v53, v53
    v_exp_f32 v54, v54
    v_exp_f32 v55, v55
    v_cvt_pk_bf16_f32 v80, v48, v49
    v_cvt_pk_bf16_f32 v81, v50, v51
    v_mfma_f32_32x32x16_bf16 v[144:159], v[184:187], v[88:91], v[144:159]
    v_exp_f32 v56, v56
    v_exp_f32 v57, v57
    v_exp_f32 v58, v58
    v_exp_f32 v59, v59
    v_cvt_pk_bf16_f32 v82, v52, v53
    v_cvt_pk_bf16_f32 v83, v54, v55
    v_mfma_f32_32x32x16_bf16 v[144:159], v[188:191], v[92:95], v[144:159]
    buffer_load_dwordx4 a[92:95], v0, s[8:11], s53 offen offset:3072
    v_exp_f32 v60, v60
    v_exp_f32 v61, v61
    v_exp_f32 v62, v62
    v_exp_f32 v63, v63
    v_cvt_pk_bf16_f32 v84, v56, v57
    v_cvt_pk_bf16_f32 v85, v58, v59
    v_cvt_pk_bf16_f32 v86, v60, v61
    v_cvt_pk_bf16_f32 v87, v62, v63
    v_mfma_f32_32x32x16_bf16 v[48:63], v[192:195], v[32:35], 0
    v_exp_f32 v64, v64
    v_exp_f32 v65, v65
    v_exp_f32 v66, v66
    v_exp_f32 v67, v67
    v_mfma_f32_32x32x16_bf16 v[48:63], v[196:199], v[36:39], v[48:63]
    v_exp_f32 v68, v68
    v_exp_f32 v69, v69
    v_exp_f32 v70, v70
    v_exp_f32 v71, v71
    v_cvt_pk_bf16_f32 v88, v64, v65
    v_cvt_pk_bf16_f32 v89, v66, v67
    s_waitcnt vmcnt(28)
    v_mfma_f32_32x32x16_bf16 v[96:111], v[200:203], v[80:83], v[96:111]
    s_mov_b32 s27, 53248
    buffer_load_dwordx4 v[184:187], v0, s[20:23], s27 offen offset:2048
    buffer_load_dwordx4 v[188:191], v0, s[20:23], s27 offen offset:3072
    v_exp_f32 v72, v72
    v_exp_f32 v73, v73
    v_exp_f32 v74, v74
    v_exp_f32 v75, v75
    v_cvt_pk_bf16_f32 v90, v68, v69
    v_cvt_pk_bf16_f32 v91, v70, v71
    v_mfma_f32_32x32x16_bf16 v[96:111], v[204:207], v[84:87], v[96:111]
    s_add_u32 s52, s54, 12288
    buffer_load_dwordx4 a[96:99], v0, s[8:11], s52 offen offset:0
    v_exp_f32 v76, v76
    v_exp_f32 v77, v77
    v_exp_f32 v78, v78
    v_exp_f32 v79, v79
    v_cvt_pk_bf16_f32 v92, v72, v73
    v_cvt_pk_bf16_f32 v93, v74, v75
    v_cvt_pk_bf16_f32 v94, v76, v77
    v_cvt_pk_bf16_f32 v95, v78, v79
    v_mfma_f32_32x32x16_bf16 v[64:79], v[192:195], v[40:43], 0
    s_add_u32 s53, s52, s55
    buffer_load_dwordx4 a[100:103], v0, s[8:11], s53 offen offset:0
    v_exp_f32 v48, v48
    v_exp_f32 v49, v49
    v_exp_f32 v50, v50
    v_exp_f32 v51, v51
    v_mfma_f32_32x32x16_bf16 v[64:79], v[196:199], v[44:47], v[64:79]
    s_load_dwordx2 s[18:19], s[16:17], 2748
    v_exp_f32 v52, v52
    v_exp_f32 v53, v53
    v_exp_f32 v54, v54
    v_exp_f32 v55, v55
    v_cvt_pk_bf16_f32 v80, v48, v49
    v_cvt_pk_bf16_f32 v81, v50, v51
    v_mfma_f32_32x32x16_bf16 v[112:127], v[200:203], v[88:91], v[112:127]
    v_exp_f32 v56, v56
    v_exp_f32 v57, v57
    v_exp_f32 v58, v58
    v_exp_f32 v59, v59
    v_cvt_pk_bf16_f32 v82, v52, v53
    v_cvt_pk_bf16_f32 v83, v54, v55
    v_mfma_f32_32x32x16_bf16 v[112:127], v[204:207], v[92:95], v[112:127]
    buffer_load_dwordx4 a[104:107], v0, s[8:11], s52 offen offset:1024
    v_exp_f32 v60, v60
    v_exp_f32 v61, v61
    v_exp_f32 v62, v62
    v_exp_f32 v63, v63
    v_cvt_pk_bf16_f32 v84, v56, v57
    v_cvt_pk_bf16_f32 v85, v58, v59
    v_cvt_pk_bf16_f32 v86, v60, v61
    v_cvt_pk_bf16_f32 v87, v62, v63
    s_waitcnt vmcnt(28)
    v_mfma_f32_32x32x16_bf16 v[48:63], v[208:211], v[16:19], 0
    v_exp_f32 v64, v64
    v_exp_f32 v65, v65
    v_exp_f32 v66, v66
    v_exp_f32 v67, v67
    v_mfma_f32_32x32x16_bf16 v[48:63], v[212:215], v[20:23], v[48:63]
    s_mov_b32 s26, 57344
    buffer_load_dwordx4 v[192:195], v0, s[20:23], s26 offen offset:0
    buffer_load_dwordx4 v[196:199], v0, s[20:23], s26 offen offset:1024
    v_exp_f32 v68, v68
    v_exp_f32 v69, v69
    v_exp_f32 v70, v70
    v_exp_f32 v71, v71
    v_cvt_pk_bf16_f32 v88, v64, v65
    v_cvt_pk_bf16_f32 v89, v66, v67
    v_mfma_f32_32x32x16_bf16 v[128:143], v[200:203], v[80:83], v[128:143]
    v_exp_f32 v72, v72
    v_exp_f32 v73, v73
    v_exp_f32 v74, v74
    v_exp_f32 v75, v75
    v_cvt_pk_bf16_f32 v90, v68, v69
    v_cvt_pk_bf16_f32 v91, v70, v71
    v_mfma_f32_32x32x16_bf16 v[128:143], v[204:207], v[84:87], v[128:143]
    buffer_load_dwordx4 a[108:111], v0, s[8:11], s53 offen offset:1024
    v_exp_f32 v76, v76
    v_exp_f32 v77, v77
    v_exp_f32 v78, v78
    v_exp_f32 v79, v79
    v_cvt_pk_bf16_f32 v92, v72, v73
    v_cvt_pk_bf16_f32 v93, v74, v75
    v_cvt_pk_bf16_f32 v94, v76, v77
    v_cvt_pk_bf16_f32 v95, v78, v79
    v_mfma_f32_32x32x16_bf16 v[64:79], v[208:211], v[24:27], 0
    buffer_load_dwordx4 a[112:115], v0, s[8:11], s52 offen offset:2048
    v_exp_f32 v48, v48
    v_exp_f32 v49, v49
    v_exp_f32 v50, v50
    v_exp_f32 v51, v51
    v_mfma_f32_32x32x16_bf16 v[64:79], v[212:215], v[28:31], v[64:79]
    s_load_dwordx2 s[18:19], s[16:17], 2876
    v_exp_f32 v52, v52
    v_exp_f32 v53, v53
    v_exp_f32 v54, v54
    v_exp_f32 v55, v55
    v_cvt_pk_bf16_f32 v80, v48, v49
    v_cvt_pk_bf16_f32 v81, v50, v51
    v_mfma_f32_32x32x16_bf16 v[144:159], v[200:203], v[88:91], v[144:159]
    v_exp_f32 v56, v56
    v_exp_f32 v57, v57
    v_exp_f32 v58, v58
    v_exp_f32 v59, v59
    v_cvt_pk_bf16_f32 v82, v52, v53
    v_cvt_pk_bf16_f32 v83, v54, v55
    v_mfma_f32_32x32x16_bf16 v[144:159], v[204:207], v[92:95], v[144:159]
    buffer_load_dwordx4 a[116:119], v0, s[8:11], s53 offen offset:2048
    v_exp_f32 v60, v60
    v_exp_f32 v61, v61
    v_exp_f32 v62, v62
    v_exp_f32 v63, v63
    v_cvt_pk_bf16_f32 v84, v56, v57
    v_cvt_pk_bf16_f32 v85, v58, v59
    v_cvt_pk_bf16_f32 v86, v60, v61
    v_cvt_pk_bf16_f32 v87, v62, v63
    v_mfma_f32_32x32x16_bf16 v[48:63], v[208:211], v[32:35], 0
    v_exp_f32 v64, v64
    v_exp_f32 v65, v65
    v_exp_f32 v66, v66
    v_exp_f32 v67, v67
    v_mfma_f32_32x32x16_bf16 v[48:63], v[212:215], v[36:39], v[48:63]
    v_exp_f32 v68, v68
    v_exp_f32 v69, v69
    v_exp_f32 v70, v70
    v_exp_f32 v71, v71
    v_cvt_pk_bf16_f32 v88, v64, v65
    v_cvt_pk_bf16_f32 v89, v66, v67
    s_waitcnt vmcnt(28)
    v_mfma_f32_32x32x16_bf16 v[96:111], v[216:219], v[80:83], v[96:111]
    s_mov_b32 s27, 57344
    buffer_load_dwordx4 v[200:203], v0, s[20:23], s27 offen offset:2048
    buffer_load_dwordx4 v[204:207], v0, s[20:23], s27 offen offset:3072
    v_exp_f32 v72, v72
    v_exp_f32 v73, v73
    v_exp_f32 v74, v74
    v_exp_f32 v75, v75
    v_cvt_pk_bf16_f32 v90, v68, v69
    v_cvt_pk_bf16_f32 v91, v70, v71
    v_mfma_f32_32x32x16_bf16 v[96:111], v[220:223], v[84:87], v[96:111]
    buffer_load_dwordx4 a[120:123], v0, s[8:11], s52 offen offset:3072
    v_exp_f32 v76, v76
    v_exp_f32 v77, v77
    v_exp_f32 v78, v78
    v_exp_f32 v79, v79
    v_cvt_pk_bf16_f32 v92, v72, v73
    v_cvt_pk_bf16_f32 v93, v74, v75
    v_cvt_pk_bf16_f32 v94, v76, v77
    v_cvt_pk_bf16_f32 v95, v78, v79
    v_mfma_f32_32x32x16_bf16 v[64:79], v[208:211], v[40:43], 0
    buffer_load_dwordx4 a[124:127], v0, s[8:11], s53 offen offset:3072
    v_exp_f32 v48, v48
    v_exp_f32 v49, v49
    v_exp_f32 v50, v50
    v_exp_f32 v51, v51
    v_mfma_f32_32x32x16_bf16 v[64:79], v[212:215], v[44:47], v[64:79]
    s_load_dwordx2 s[18:19], s[16:17], 3004
    v_exp_f32 v52, v52
    v_exp_f32 v53, v53
    v_exp_f32 v54, v54
    v_exp_f32 v55, v55
    v_cvt_pk_bf16_f32 v80, v48, v49
    v_cvt_pk_bf16_f32 v81, v50, v51
    v_mfma_f32_32x32x16_bf16 v[112:127], v[216:219], v[88:91], v[112:127]
    v_exp_f32 v56, v56
    v_exp_f32 v57, v57
    v_exp_f32 v58, v58
    v_exp_f32 v59, v59
    v_cvt_pk_bf16_f32 v82, v52, v53
    v_cvt_pk_bf16_f32 v83, v54, v55
    v_mfma_f32_32x32x16_bf16 v[112:127], v[220:223], v[92:95], v[112:127]
    s_add_u32 s52, s54, 16384
    buffer_load_dwordx4 a[128:131], v0, s[8:11], s52 offen offset:0
    v_exp_f32 v60, v60
    v_exp_f32 v61, v61
    v_exp_f32 v62, v62
    v_exp_f32 v63, v63
    v_cvt_pk_bf16_f32 v84, v56, v57
    v_cvt_pk_bf16_f32 v85, v58, v59
    v_cvt_pk_bf16_f32 v86, v60, v61
    v_cvt_pk_bf16_f32 v87, v62, v63
    s_waitcnt vmcnt(28)
    v_mfma_f32_32x32x16_bf16 v[48:63], v[160:163], v[16:19], 0
    v_exp_f32 v64, v64
    v_exp_f32 v65, v65
    v_exp_f32 v66, v66
    v_exp_f32 v67, v67
    v_mfma_f32_32x32x16_bf16 v[48:63], v[164:167], v[20:23], v[48:63]
    s_mov_b32 s26, 61440
    buffer_load_dwordx4 v[208:211], v0, s[20:23], s26 offen offset:0
    buffer_load_dwordx4 v[212:215], v0, s[20:23], s26 offen offset:1024
    v_exp_f32 v68, v68
    v_exp_f32 v69, v69
    v_exp_f32 v70, v70
    v_exp_f32 v71, v71
    v_cvt_pk_bf16_f32 v88, v64, v65
    v_cvt_pk_bf16_f32 v89, v66, v67
    v_mfma_f32_32x32x16_bf16 v[128:143], v[216:219], v[80:83], v[128:143]
    v_exp_f32 v72, v72
    v_exp_f32 v73, v73
    v_exp_f32 v74, v74
    v_exp_f32 v75, v75
    v_cvt_pk_bf16_f32 v90, v68, v69
    v_cvt_pk_bf16_f32 v91, v70, v71
    v_mfma_f32_32x32x16_bf16 v[128:143], v[220:223], v[84:87], v[128:143]
    s_add_u32 s53, s52, s55
    buffer_load_dwordx4 a[132:135], v0, s[8:11], s53 offen offset:0
    v_exp_f32 v76, v76
    v_exp_f32 v77, v77
    v_exp_f32 v78, v78
    v_exp_f32 v79, v79
    v_cvt_pk_bf16_f32 v92, v72, v73
    v_cvt_pk_bf16_f32 v93, v74, v75
    v_cvt_pk_bf16_f32 v94, v76, v77
    v_cvt_pk_bf16_f32 v95, v78, v79
    v_mfma_f32_32x32x16_bf16 v[64:79], v[160:163], v[24:27], 0
    buffer_load_dwordx4 a[136:139], v0, s[8:11], s52 offen offset:1024
    v_exp_f32 v48, v48
    v_exp_f32 v49, v49
    v_exp_f32 v50, v50
    v_exp_f32 v51, v51
    v_mfma_f32_32x32x16_bf16 v[64:79], v[164:167], v[28:31], v[64:79]
    s_load_dwordx2 s[18:19], s[16:17], 3132
    v_exp_f32 v52, v52
    v_exp_f32 v53, v53
    v_exp_f32 v54, v54
    v_exp_f32 v55, v55
    v_cvt_pk_bf16_f32 v80, v48, v49
    v_cvt_pk_bf16_f32 v81, v50, v51
    v_mfma_f32_32x32x16_bf16 v[144:159], v[216:219], v[88:91], v[144:159]
    v_exp_f32 v56, v56
    v_exp_f32 v57, v57
    v_exp_f32 v58, v58
    v_exp_f32 v59, v59
    v_cvt_pk_bf16_f32 v82, v52, v53
    v_cvt_pk_bf16_f32 v83, v54, v55
    v_mfma_f32_32x32x16_bf16 v[144:159], v[220:223], v[92:95], v[144:159]
    buffer_load_dwordx4 a[140:143], v0, s[8:11], s53 offen offset:1024
    v_exp_f32 v60, v60
    v_exp_f32 v61, v61
    v_exp_f32 v62, v62
    v_exp_f32 v63, v63
    v_cvt_pk_bf16_f32 v84, v56, v57
    v_cvt_pk_bf16_f32 v85, v58, v59
    v_cvt_pk_bf16_f32 v86, v60, v61
    v_cvt_pk_bf16_f32 v87, v62, v63
    v_mfma_f32_32x32x16_bf16 v[48:63], v[160:163], v[32:35], 0
    v_exp_f32 v64, v64
    v_exp_f32 v65, v65
    v_exp_f32 v66, v66
    v_exp_f32 v67, v67
    v_mfma_f32_32x32x16_bf16 v[48:63], v[164:167], v[36:39], v[48:63]
    v_exp_f32 v68, v68
    v_exp_f32 v69, v69
    v_exp_f32 v70, v70
    v_exp_f32 v71, v71
    v_cvt_pk_bf16_f32 v88, v64, v65
    v_cvt_pk_bf16_f32 v89, v66, v67
    s_waitcnt vmcnt(28)
    v_mfma_f32_32x32x16_bf16 v[96:111], v[168:171], v[80:83], v[96:111]
    s_mov_b32 s27, 61440
    buffer_load_dwordx4 v[216:219], v0, s[20:23], s27 offen offset:2048
    buffer_load_dwordx4 v[220:223], v0, s[20:23], s27 offen offset:3072
    v_exp_f32 v72, v72
    v_exp_f32 v73, v73
    v_exp_f32 v74, v74
    v_exp_f32 v75, v75
    v_cvt_pk_bf16_f32 v90, v68, v69
    v_cvt_pk_bf16_f32 v91, v70, v71
    v_mfma_f32_32x32x16_bf16 v[96:111], v[172:175], v[84:87], v[96:111]
    buffer_load_dwordx4 a[144:147], v0, s[8:11], s52 offen offset:2048
    v_exp_f32 v76, v76
    v_exp_f32 v77, v77
    v_exp_f32 v78, v78
    v_exp_f32 v79, v79
    v_cvt_pk_bf16_f32 v92, v72, v73
    v_cvt_pk_bf16_f32 v93, v74, v75
    v_cvt_pk_bf16_f32 v94, v76, v77
    v_cvt_pk_bf16_f32 v95, v78, v79
    v_mfma_f32_32x32x16_bf16 v[64:79], v[160:163], v[40:43], 0
    buffer_load_dwordx4 a[148:151], v0, s[8:11], s53 offen offset:2048
    v_exp_f32 v48, v48
    v_exp_f32 v49, v49
    v_exp_f32 v50, v50
    v_exp_f32 v51, v51
    v_mfma_f32_32x32x16_bf16 v[64:79], v[164:167], v[44:47], v[64:79]
    v_lshlrev_b32 v10, 3, v0
    s_mov_b32 exec_hi, 0
    s_mov_b32 exec_lo, 0xfffffff
    global_load_dword v12, v10, s[16:17] offset:3584
    s_mov_b64 exec, -1
    s_load_dwordx2 s[18:19], s[16:17], 3260
    v_exp_f32 v52, v52
    v_exp_f32 v53, v53
    v_exp_f32 v54, v54
    v_exp_f32 v55, v55
    v_cvt_pk_bf16_f32 v80, v48, v49
    v_cvt_pk_bf16_f32 v81, v50, v51
    v_mfma_f32_32x32x16_bf16 v[112:127], v[168:171], v[88:91], v[112:127]
    s_getpc_b64 s[24:25]
Lpc2:
    s_and_b32 s30, s4, 7
    s_lshl_b32 s30, s30, 2
    s_add_u32 s30, s30, s5
    s_lshl_b32 s30, s30, 2
    s_add_u32 s30, s30, s3
    s_lshl_b32 s30, s30, 10
    v_add_u32 v8, s30, v0
    v_min_u32 v8, Lcode_end-Lpc2-16, v8
    v_mov_b32 v9, s25
    v_add_co_u32 v8, vcc, s24, v8
    v_addc_co_u32 v9, vcc, 0, v9, vcc
    global_load_dword v12, v[8:9], off
    v_exp_f32 v56, v56
    v_exp_f32 v57, v57
    v_exp_f32 v58, v58
    v_exp_f32 v59, v59
    v_cvt_pk_bf16_f32 v82, v52, v53
    v_cvt_pk_bf16_f32 v83, v54, v55
    v_mfma_f32_32x32x16_bf16 v[112:127], v[172:175], v[92:95], v[112:127]
    buffer_load_dwordx4 a[152:155], v0, s[8:11], s52 offen offset:3072
    v_exp_f32 v60, v60
    v_exp_f32 v61, v61
    v_exp_f32 v62, v62
    v_exp_f32 v63, v63
    v_cvt_pk_bf16_f32 v84, v56, v57
    v_cvt_pk_bf16_f32 v85, v58, v59
    v_cvt_pk_bf16_f32 v86, v60, v61
    v_cvt_pk_bf16_f32 v87, v62, v63
    s_waitcnt vmcnt(30)
    v_mfma_f32_32x32x16_bf16 v[48:63], v[176:179], v[16:19], 0
    v_exp_f32 v64, v64
    v_exp_f32 v65, v65
    v_exp_f32 v66, v66
    v_exp_f32 v67, v67
    v_mfma_f32_32x32x16_bf16 v[48:63], v[180:183], v[20:23], v[48:63]
    s_add_u32 s49, s48, 12288
    buffer_load_dwordx4 v[160:163], v0, s[8:11], s49 offen offset:2048
    v_exp_f32 v68, v68
    v_exp_f32 v69, v69
    v_exp_f32 v70, v70
    v_exp_f32 v71, v71
    v_cvt_pk_bf16_f32 v88, v64, v65
    v_cvt_pk_bf16_f32 v89, v66, v67
    v_mfma_f32_32x32x16_bf16 v[128:143], v[168:171], v[80:83], v[128:143]
    buffer_load_dwordx4 v[164:167], v0, s[8:11], s49 offen offset:3072
    v_exp_f32 v72, v72
    v_exp_f32 v73, v73
    v_exp_f32 v74, v74
    v_exp_f32 v75, v75
    v_cvt_pk_bf16_f32 v90, v68, v69
    v_cvt_pk_bf16_f32 v91, v70, v71
    v_mfma_f32_32x32x16_bf16 v[128:143], v[172:175], v[84:87], v[128:143]
    buffer_load_dwordx4 a[156:159], v0, s[8:11], s53 offen offset:3072
    v_exp_f32 v76, v76
    v_exp_f32 v77, v77
    v_exp_f32 v78, v78
    v_exp_f32 v79, v79
    v_cvt_pk_bf16_f32 v92, v72, v73
    v_cvt_pk_bf16_f32 v93, v74, v75
    v_cvt_pk_bf16_f32 v94, v76, v77
    v_cvt_pk_bf16_f32 v95, v78, v79
    v_mfma_f32_32x32x16_bf16 v[64:79], v[176:179], v[24:27], 0
    s_add_u32 s52, s54, 20480
    buffer_load_dwordx4 a[160:163], v0, s[8:11], s52 offen offset:0
    v_exp_f32 v48, v48
    v_exp_f32 v49, v49
    v_exp_f32 v50, v50
    v_exp_f32 v51, v51
    v_mfma_f32_32x32x16_bf16 v[64:79], v[180:183], v[28:31], v[64:79]
    s_load_dwordx2 s[18:19], s[16:17], 3388
    v_exp_f32 v52, v52
    v_exp_f32 v53, v53
    v_exp_f32 v54, v54
    v_exp_f32 v55, v55
    v_cvt_pk_bf16_f32 v80, v48, v49
    v_cvt_pk_bf16_f32 v81, v50, v51
    v_mfma_f32_32x32x16_bf16 v[144:159], v[168:171], v[88:91], v[144:159]
    v_exp_f32 v56, v56
    v_exp_f32 v57, v57
    v_exp_f32 v58, v58
    v_exp_f32 v59, v59
    v_cvt_pk_bf16_f32 v82, v52, v53
    v_cvt_pk_bf16_f32 v83, v54, v55
    v_mfma_f32_32x32x16_bf16 v[144:159], v[172:175], v[92:95], v[144:159]
    s_add_u32 s53, s52, s55
    buffer_load_dwordx4 a[164:167], v0, s[8:11], s53 offen offset:0
    v_exp_f32 v60, v60
    v_exp_f32 v61, v61
    v_exp_f32 v62, v62
    v_exp_f32 v63, v63
    v_cvt_pk_bf16_f32 v84, v56, v57
    v_cvt_pk_bf16_f32 v85, v58, v59
    v_cvt_pk_bf16_f32 v86, v60, v61
    v_cvt_pk_bf16_f32 v87, v62, v63
    v_mfma_f32_32x32x16_bf16 v[48:63], v[176:179], v[32:35], 0
    v_exp_f32 v64, v64
    v_exp_f32 v65, v65
    v_exp_f32 v66, v66
    v_exp_f32 v67, v67
    v_mfma_f32_32x32x16_bf16 v[48:63], v[180:183], v[36:39], v[48:63]
    s_add_u32 s49, s48, 16384
    buffer_load_dwordx4 v[168:171], v0, s[8:11], s49 offen offset:0
    v_exp_f32 v68, v68
    v_exp_f32 v69, v69
    v_exp_f32 v70, v70
    v_exp_f32 v71, v71
    v_cvt_pk_bf16_f32 v88, v64, v65
    v_cvt_pk_bf16_f32 v89, v66, v67
    s_waitcnt vmcnt(31)
    v_mfma_f32_32x32x16_bf16 v[96:111], v[184:187], v[80:83], v[96:111]
    buffer_load_dwordx4 v[172:175], v0, s[8:11], s49 offen offset:1024
    v_exp_f32 v72, v72
    v_exp_f32 v73, v73
    v_exp_f32 v74, v74
    v_exp_f32 v75, v75
    v_cvt_pk_bf16_f32 v90, v68, v69
    v_cvt_pk_bf16_f32 v91, v70, v71
    v_mfma_f32_32x32x16_bf16 v[96:111], v[188:191], v[84:87], v[96:111]
    buffer_load_dwordx4 a[168:171], v0, s[8:11], s52 offen offset:1024
    v_exp_f32 v76, v76
    v_exp_f32 v77, v77
    v_exp_f32 v78, v78
    v_exp_f32 v79, v79
    v_cvt_pk_bf16_f32 v92, v72, v73
    v_cvt_pk_bf16_f32 v93, v74, v75
    v_cvt_pk_bf16_f32 v94, v76, v77
    v_cvt_pk_bf16_f32 v95, v78, v79
    v_mfma_f32_32x32x16_bf16 v[64:79], v[176:179], v[40:43], 0
    buffer_load_dwordx4 a[172:175], v0, s[8:11], s53 offen offset:1024
    v_exp_f32 v48, v48
    v_exp_f32 v49, v49
    v_exp_f32 v50, v50
    v_exp_f32 v51, v51
    v_mfma_f32_32x32x16_bf16 v[64:79], v[180:183], v[44:47], v[64:79]
    s_load_dwordx2 s[18:19], s[16:17], 3516
    v_exp_f32 v52, v52
    v_exp_f32 v53, v53
    v_exp_f32 v54, v54
    v_exp_f32 v55, v55
    v_cvt_pk_bf16_f32 v80, v48, v49
    v_cvt_pk_bf16_f32 v81, v50, v51
    v_mfma_f32_32x32x16_bf16 v[112:127], v[184:187], v[88:91], v[112:127]
    v_exp_f32 v56, v56
    v_exp_f32 v57, v57
    v_exp_f32 v58, v58
    v_exp_f32 v59, v59
    v_cvt_pk_bf16_f32 v82, v52, v53
    v_cvt_pk_bf16_f32 v83, v54, v55
    v_mfma_f32_32x32x16_bf16 v[112:127], v[188:191], v[92:95], v[112:127]
    buffer_load_dwordx4 a[176:179], v0, s[8:11], s52 offen offset:2048
    v_exp_f32 v60, v60
    v_exp_f32 v61, v61
    v_exp_f32 v62, v62
    v_exp_f32 v63, v63
    v_cvt_pk_bf16_f32 v84, v56, v57
    v_cvt_pk_bf16_f32 v85, v58, v59
    v_cvt_pk_bf16_f32 v86, v60, v61
    v_cvt_pk_bf16_f32 v87, v62, v63
    s_waitcnt vmcnt(30)
    v_mfma_f32_32x32x16_bf16 v[48:63], v[192:195], v[16:19], 0
    v_exp_f32 v64, v64
    v_exp_f32 v65, v65
    v_exp_f32 v66, v66
    v_exp_f32 v67, v67
    v_mfma_f32_32x32x16_bf16 v[48:63], v[196:199], v[20:23], v[48:63]
    buffer_load_dwordx4 v[176:179], v0, s[8:11], s49 offen offset:2048
    v_exp_f32 v68, v68
    v_exp_f32 v69, v69
    v_exp_f32 v70, v70
    v_exp_f32 v71, v71
    v_cvt_pk_bf16_f32 v88, v64, v65
    v_cvt_pk_bf16_f32 v89, v66, v67
    v_mfma_f32_32x32x16_bf16 v[128:143], v[184:187], v[80:83], v[128:143]
    buffer_load_dwordx4 v[180:183], v0, s[8:11], s49 offen offset:3072
    v_exp_f32 v72, v72
    v_exp_f32 v73, v73
    v_exp_f32 v74, v74
    v_exp_f32 v75, v75
    v_cvt_pk_bf16_f32 v90, v68, v69
    v_cvt_pk_bf16_f32 v91, v70, v71
    v_mfma_f32_32x32x16_bf16 v[128:143], v[188:191], v[84:87], v[128:143]
    buffer_load_dwordx4 a[180:183], v0, s[8:11], s53 offen offset:2048
    v_exp_f32 v76, v76
    v_exp_f32 v77, v77
    v_exp_f32 v78, v78
    v_exp_f32 v79, v79
    v_cvt_pk_bf16_f32 v92, v72, v73
    v_cvt_pk_bf16_f32 v93, v74, v75
    v_cvt_pk_bf16_f32 v94, v76, v77
    v_cvt_pk_bf16_f32 v95, v78, v79
    v_mfma_f32_32x32x16_bf16 v[64:79], v[192:195], v[24:27], 0
    buffer_load_dwordx4 a[184:187], v0, s[8:11], s52 offen offset:3072
    v_exp_f32 v48, v48
    v_exp_f32 v49, v49
    v_exp_f32 v50, v50
    v_exp_f32 v51, v51
    v_mfma_f32_32x32x16_bf16 v[64:79], v[196:199], v[28:31], v[64:79]
    v_exp_f32 v52, v52
    v_exp_f32 v53, v53
    v_exp_f32 v54, v54
    v_exp_f32 v55, v55
    v_cvt_pk_bf16_f32 v80, v48, v49
    v_cvt_pk_bf16_f32 v81, v50, v51
    v_mfma_f32_32x32x16_bf16 v[144:159], v[184:187], v[88:91], v[144:159]
    v_exp_f32 v56, v56
    v_exp_f32 v57, v57
    v_exp_f32 v58, v58
    v_exp_f32 v59, v59
    v_cvt_pk_bf16_f32 v82, v52, v53
    v_cvt_pk_bf16_f32 v83, v54, v55
    v_mfma_f32_32x32x16_bf16 v[144:159], v[188:191], v[92:95], v[144:159]
    buffer_load_dwordx4 a[188:191], v0, s[8:11], s53 offen offset:3072
    v_exp_f32 v60, v60
    v_exp_f32 v61, v61
    v_exp_f32 v62, v62
    v_exp_f32 v63, v63
    v_cvt_pk_bf16_f32 v84, v56, v57
    v_cvt_pk_bf16_f32 v85, v58, v59
    v_cvt_pk_bf16_f32 v86, v60, v61
    v_cvt_pk_bf16_f32 v87, v62, v63
    v_mfma_f32_32x32x16_bf16 v[48:63], v[192:195], v[32:35], 0
    v_exp_f32 v64, v64
    v_exp_f32 v65, v65
    v_exp_f32 v66, v66
    v_exp_f32 v67, v67
    v_mfma_f32_32x32x16_bf16 v[48:63], v[196:199], v[36:39], v[48:63]
    s_add_u32 s49, s48, 20480
    buffer_load_dwordx4 v[184:187], v0, s[8:11], s49 offen offset:0
    v_exp_f32 v68, v68
    v_exp_f32 v69, v69
    v_exp_f32 v70, v70
    v_exp_f32 v71, v71
    v_cvt_pk_bf16_f32 v88, v64, v65
    v_cvt_pk_bf16_f32 v89, v66, v67
    s_waitcnt vmcnt(31)
    v_mfma_f32_32x32x16_bf16 v[96:111], v[200:203], v[80:83], v[96:111]
    buffer_load_dwordx4 v[188:191], v0, s[8:11], s49 offen offset:1024
    v_exp_f32 v72, v72
    v_exp_f32 v73, v73
    v_exp_f32 v74, v74
    v_exp_f32 v75, v75
    v_cvt_pk_bf16_f32 v90, v68, v69
    v_cvt_pk_bf16_f32 v91, v70, v71
    v_mfma_f32_32x32x16_bf16 v[96:111], v[204:207], v[84:87], v[96:111]
    s_add_u32 s52, s54, 24576
    buffer_load_dwordx4 a[192:195], v0, s[8:11], s52 offen offset:0
    v_exp_f32 v76, v76
    v_exp_f32 v77, v77
    v_exp_f32 v78, v78
    v_exp_f32 v79, v79
    v_cvt_pk_bf16_f32 v92, v72, v73
    v_cvt_pk_bf16_f32 v93, v74, v75
    v_cvt_pk_bf16_f32 v94, v76, v77
    v_cvt_pk_bf16_f32 v95, v78, v79
    v_mfma_f32_32x32x16_bf16 v[64:79], v[192:195], v[40:43], 0
    s_add_u32 s53, s52, s55
    buffer_load_dwordx4 a[196:199], v0, s[8:11], s53 offen offset:0
    v_exp_f32 v48, v48
    v_exp_f32 v49, v49
    v_exp_f32 v50, v50
    v_exp_f32 v51, v51
    v_mfma_f32_32x32x16_bf16 v[64:79], v[196:199], v[44:47], v[64:79]
    v_exp_f32 v52, v52
    v_exp_f32 v53, v53
    v_exp_f32 v54, v54
    v_exp_f32 v55, v55
    v_cvt_pk_bf16_f32 v80, v48, v49
    v_cvt_pk_bf16_f32 v81, v50, v51
    v_mfma_f32_32x32x16_bf16 v[112:127], v[200:203], v[88:91], v[112:127]
    v_exp_f32 v56, v56
    v_exp_f32 v57, v57
    v_exp_f32 v58, v58
    v_exp_f32 v59, v59
    v_cvt_pk_bf16_f32 v82, v52, v53
    v_cvt_pk_bf16_f32 v83, v54, v55
    v_mfma_f32_32x32x16_bf16 v[112:127], v[204:207], v[92:95], v[112:127]
    buffer_load_dwordx4 a[200:203], v0, s[8:11], s52 offen offset:1024
    v_exp_f32 v60, v60
    v_exp_f32 v61, v61
    v_exp_f32 v62, v62
    v_exp_f32 v63, v63
    v_cvt_pk_bf16_f32 v84, v56, v57
    v_cvt_pk_bf16_f32 v85, v58, v59
    v_cvt_pk_bf16_f32 v86, v60, v61
    v_cvt_pk_bf16_f32 v87, v62, v63
    s_waitcnt vmcnt(30)
    v_mfma_f32_32x32x16_bf16 v[48:63], v[208:211], v[16:19], 0
    v_exp_f32 v64, v64
    v_exp_f32 v65, v65
    v_exp_f32 v66, v66
    v_exp_f32 v67, v67
    v_mfma_f32_32x32x16_bf16 v[48:63], v[212:215], v[20:23], v[48:63]
    buffer_load_dwordx4 v[192:195], v0, s[8:11], s49 offen offset:2048
    v_exp_f32 v68, v68
    v_exp_f32 v69, v69
    v_exp_f32 v70, v70
    v_exp_f32 v71, v71
    v_cvt_pk_bf16_f32 v88, v64, v65
    v_cvt_pk_bf16_f32 v89, v66, v67
    v_mfma_f32_32x32x16_bf16 v[128:143], v[200:203], v[80:83], v[128:143]
    buffer_load_dwordx4 v[196:199], v0, s[8:11], s49 offen offset:3072
    v_exp_f32 v72, v72
    v_exp_f32 v73, v73
    v_exp_f32 v74, v74
    v_exp_f32 v75, v75
    v_cvt_pk_bf16_f32 v90, v68, v69
    v_cvt_pk_bf16_f32 v91, v70, v71
    v_mfma_f32_32x32x16_bf16 v[128:143], v[204:207], v[84:87], v[128:143]
    buffer_load_dwordx4 a[204:207], v0, s[8:11], s53 offen offset:1024
    v_exp_f32 v76, v76
    v_exp_f32 v77, v77
    v_exp_f32 v78, v78
    v_exp_f32 v79, v79
    v_cvt_pk_bf16_f32 v92, v72, v73
    v_cvt_pk_bf16_f32 v93, v74, v75
    v_cvt_pk_bf16_f32 v94, v76, v77
    v_cvt_pk_bf16_f32 v95, v78, v79
    v_mfma_f32_32x32x16_bf16 v[64:79], v[208:211], v[24:27], 0
    buffer_load_dwordx4 a[208:211], v0, s[8:11], s52 offen offset:2048
    v_exp_f32 v48, v48
    v_exp_f32 v49, v49
    v_exp_f32 v50, v50
    v_exp_f32 v51, v51
    v_mfma_f32_32x32x16_bf16 v[64:79], v[212:215], v[28:31], v[64:79]
    v_exp_f32 v52, v52
    v_exp_f32 v53, v53
    v_exp_f32 v54, v54
    v_exp_f32 v55, v55
    v_cvt_pk_bf16_f32 v80, v48, v49
    v_cvt_pk_bf16_f32 v81, v50, v51
    v_mfma_f32_32x32x16_bf16 v[144:159], v[200:203], v[88:91], v[144:159]
    v_exp_f32 v56, v56
    v_exp_f32 v57, v57
    v_exp_f32 v58, v58
    v_exp_f32 v59, v59
    v_cvt_pk_bf16_f32 v82, v52, v53
    v_cvt_pk_bf16_f32 v83, v54, v55
    v_mfma_f32_32x32x16_bf16 v[144:159], v[204:207], v[92:95], v[144:159]
    buffer_load_dwordx4 a[212:215], v0, s[8:11], s53 offen offset:2048
    v_exp_f32 v60, v60
    v_exp_f32 v61, v61
    v_exp_f32 v62, v62
    v_exp_f32 v63, v63
    v_cvt_pk_bf16_f32 v84, v56, v57
    v_cvt_pk_bf16_f32 v85, v58, v59
    v_cvt_pk_bf16_f32 v86, v60, v61
    v_cvt_pk_bf16_f32 v87, v62, v63
    v_mfma_f32_32x32x16_bf16 v[48:63], v[208:211], v[32:35], 0
    v_exp_f32 v64, v64
    v_exp_f32 v65, v65
    v_exp_f32 v66, v66
    v_exp_f32 v67, v67
    v_mfma_f32_32x32x16_bf16 v[48:63], v[212:215], v[36:39], v[48:63]
    s_add_u32 s49, s48, 24576
    buffer_load_dwordx4 v[200:203], v0, s[8:11], s49 offen offset:0
    v_exp_f32 v68, v68
    v_exp_f32 v69, v69
    v_exp_f32 v70, v70
    v_exp_f32 v71, v71
    v_cvt_pk_bf16_f32 v88, v64, v65
    v_cvt_pk_bf16_f32 v89, v66, v67
    s_waitcnt vmcnt(31)
    v_mfma_f32_32x32x16_bf16 v[96:111], v[216:219], v[80:83], v[96:111]
    buffer_load_dwordx4 v[204:207], v0, s[8:11], s49 offen offset:1024
    v_exp_f32 v72, v72
    v_exp_f32 v73, v73
    v_exp_f32 v74, v74
    v_exp_f32 v75, v75
    v_cvt_pk_bf16_f32 v90, v68, v69
    v_cvt_pk_bf16_f32 v91, v70, v71
    v_mfma_f32_32x32x16_bf16 v[96:111], v[220:223], v[84:87], v[96:111]
    buffer_load_dwordx4 a[216:219], v0, s[8:11], s52 offen offset:3072
    v_exp_f32 v76, v76
    v_exp_f32 v77, v77
    v_exp_f32 v78, v78
    v_exp_f32 v79, v79
    v_cvt_pk_bf16_f32 v92, v72, v73
    v_cvt_pk_bf16_f32 v93, v74, v75
    v_cvt_pk_bf16_f32 v94, v76, v77
    v_cvt_pk_bf16_f32 v95, v78, v79
    v_mfma_f32_32x32x16_bf16 v[64:79], v[208:211], v[40:43], 0
    buffer_load_dwordx4 a[220:223], v0, s[8:11], s53 offen offset:3072
    v_exp_f32 v48, v48
    v_exp_f32 v49, v49
    v_exp_f32 v50, v50
    v_exp_f32 v51, v51
    v_mfma_f32_32x32x16_bf16 v[64:79], v[212:215], v[44:47], v[64:79]
    v_exp_f32 v52, v52
    v_exp_f32 v53, v53
    v_exp_f32 v54, v54
    v_exp_f32 v55, v55
    v_cvt_pk_bf16_f32 v80, v48, v49
    v_cvt_pk_bf16_f32 v81, v50, v51
    v_mfma_f32_32x32x16_bf16 v[112:127], v[216:219], v[88:91], v[112:127]
    v_exp_f32 v56, v56
    v_exp_f32 v57, v57
    v_exp_f32 v58, v58
    v_exp_f32 v59, v59
    v_cvt_pk_bf16_f32 v82, v52, v53
    v_cvt_pk_bf16_f32 v83, v54, v55
    v_mfma_f32_32x32x16_bf16 v[112:127], v[220:223], v[92:95], v[112:127]
    v_exp_f32 v60, v60
    v_exp_f32 v61, v61
    v_exp_f32 v62, v62
    v_exp_f32 v63, v63
    v_cvt_pk_bf16_f32 v84, v56, v57
    v_cvt_pk_bf16_f32 v85, v58, v59
    v_cvt_pk_bf16_f32 v86, v60, v61
    v_cvt_pk_bf16_f32 v87, v62, v63
    v_exp_f32 v64, v64
    v_exp_f32 v65, v65
    v_exp_f32 v66, v66
    v_exp_f32 v67, v67
    buffer_load_dwordx4 v[208:211], v0, s[8:11], s49 offen offset:2048
    v_exp_f32 v68, v68
    v_exp_f32 v69, v69
    v_exp_f32 v70, v70
    v_exp_f32 v71, v71
    v_cvt_pk_bf16_f32 v88, v64, v65
    v_cvt_pk_bf16_f32 v89, v66, v67
    v_mfma_f32_32x32x16_bf16 v[128:143], v[216:219], v[80:83], v[128:143]
    buffer_load_dwordx4 v[212:215], v0, s[8:11], s49 offen offset:3072
    v_exp_f32 v72, v72
    v_exp_f32 v73, v73
    v_exp_f32 v74, v74
    v_exp_f32 v75, v75
    v_cvt_pk_bf16_f32 v90, v68, v69
    v_cvt_pk_bf16_f32 v91, v70, v71
    v_mfma_f32_32x32x16_bf16 v[128:143], v[220:223], v[84:87], v[128:143]
    v_exp_f32 v76, v76
    v_exp_f32 v77, v77
    v_exp_f32 v78, v78
    v_exp_f32 v79, v79
    v_cvt_pk_bf16_f32 v92, v72, v73
    v_cvt_pk_bf16_f32 v93, v74, v75
    v_cvt_pk_bf16_f32 v94, v76, v77
    v_cvt_pk_bf16_f32 v95, v78, v79
    s_nop 0
    v_mfma_f32_32x32x16_bf16 v[144:159], v[216:219], v[88:91], v[144:159]
    v_mfma_f32_32x32x16_bf16 v[144:159], v[220:223], v[92:95], v[144:159]
    s_branch Lfirst_7
Lpro_6:
    s_lshr_b32 s24, s6, 3
    s_mul_i32 s24, s24, 28
    s_bfe_u32 s25, s6, 0x10002
    s_lshl_b32 s25, s25, 1
    s_add_u32 s24, s24, s25
    s_mov_b32 s42, 0x3333333
    s_mov_b32 s43, 0
    s_lshl_b64 s[42:43], s[42:43], s24
    buffer_load_dwordx4 v[200:203], v0, s[8:11], s29 offen offset:1024
    buffer_load_dwordx4 v[204:207], v0, s[8:11], s29 offen offset:2048
    buffer_load_dwordx4 v[208:211], v0, s[8:11], s29 offen offset:3072
    s_add_u32 s29, s29, 4096
    buffer_load_dwordx4 v[212:215], v0, s[8:11], s29 offen offset:0
    buffer_load_dwordx4 v[216:219], v0, s[8:11], s29 offen offset:1024
    s_mov_b64 exec, s[42:43]
Lw_33:
    s_add_u32 s39, s39, 1
    s_cmp_gt_u32 s39, 1048576
    s_cbranch_scc1 Lwx_34
    buffer_load_dword v14, v13, s[8:11], s34 offen sc1
    s_waitcnt vmcnt(0)
    v_subrev_u32 v14, s36, v14
    v_cmp_lt_u32 vcc, 15, v14
    s_cbranch_vccnz Lw_33
Lwx_34:
    s_mov_b64 exec, -1
    s_cmp_eq_u32 s33, 0
    s_cbranch_scc1 Lwf_35
    buffer_inv sc1
    s_waitcnt vmcnt(0)
Lwf_35:
    s_add_u32 s36, s36, 1
    s_mul_i32 s25, s3, 7168
    s_mul_i32 s24, s4, 28672
    s_add_u32 s24, s24, s25
    s_add_u32 s24, s24, 5809152
    s_mov_b32 m0, s25
    s_nop 0
    buffer_load_dwordx4 v0, s[8:11], s24 offen offset:0 sc1 lds
    buffer_load_dwordx4 v0, s[8:11], s24 offen offset:1024 sc1 lds
    buffer_load_dwordx4 v0, s[8:11], s24 offen offset:2048 sc1 lds
    buffer_load_dwordx4 v0, s[8:11], s24 offen offset:3072 sc1 lds
    s_add_u32 s24, s24, 4096
    s_add_u32 s25, s25, 4096
    s_mov_b32 m0, s25
    s_nop 0
    buffer_load_dwordx4 v0, s[8:11], s24 offen offset:0 sc1 lds
    buffer_load_dwordx4 v0, s[8:11], s24 offen offset:1024 sc1 lds
    buffer_load_dwordx4 v0, s[8:11], s24 offen offset:2048 sc1 lds
    s_mul_i32 s24, s4, 3584
    s_add_u32 s24, s24, 7644160
    v_mul_u32_u24 v8, 1792, v2
    v_lshl_add_u32 v8, v1, 3, v8
    buffer_load_dwordx2 v[100:101], v8, s[8:11], s24 offen offset:0 sc1
    buffer_load_dwordx2 v[102:103], v8, s[8:11], s24 offen offset:256 sc1
    buffer_load_dwordx2 v[104:105], v8, s[8:11], s24 offen offset:512 sc1
    buffer_load_dwordx2 v[106:107], v8, s[8:11], s24 offen offset:768 sc1
    buffer_load_dwordx2 v[108:109], v8, s[8:11], s24 offen offset:1024 sc1
    buffer_load_dwordx2 v[110:111], v8, s[8:11], s24 offen offset:1280 sc1
    buffer_load_dwordx2 v[112:113], v8, s[8:11], s24 offen offset:1536 sc1
    s_lshl_b32 s24, s3, 16
    s_add_u32 s24, s24, s7
    s_add_u32 s24, s24, 15213568
    s_add_u32 s20, s8, s24
    s_addc_u32 s21, s9, 0
    s_mov_b32 s22, 65536
    s_mov_b32 s23, 0x20000
    s_cmp_eq_u32 s5, 0
    s_cbranch_scc1 Lkv_37
    buffer_load_dwordx4 v[220:223], v0, s[8:11], s29 offen offset:2048
    buffer_load_dwordx4 v[88:91], v0, s[8:11], s29 offen offset:3072
    s_add_u32 s29, s29, 4096
    buffer_load_dwordx4 v[92:95], v0, s[8:11], s29 offen offset:0
    buffer_load_dwordx4 v[96:99], v0, s[8:11], s29 offen offset:1024
    buffer_load_dwordx4 v[80:83], v0, s[8:11], s29 offen offset:2048
    buffer_load_dwordx4 v[84:87], v0, s[8:11], s29 offen offset:3072
    v_lshlrev_b32 v9, 4, v2
    buffer_load_dwordx4 v[116:119], v9, s[8:11], s28 offen offset:0
    buffer_load_dwordx4 v[120:123], v9, s[8:11], s28 offen offset:32
    buffer_load_dwordx4 v[124:127], v9, s[8:11], s28 offen offset:64
    buffer_load_dwordx4 v[128:131], v9, s[8:11], s28 offen offset:96
    s_waitcnt vmcnt(10)
    v_add_f32 v102, v102, v104
    v_add_f32 v103, v103, v105
    v_add_f32 v106, v106, v108
    v_add_f32 v107, v107, v109
    v_add_f32 v110, v110, v112
    v_add_f32 v111, v111, v113
    v_add_f32 v100, v100, v102
    v_add_f32 v101, v101, v103
    v_add_f32 v106, v106, v110
    v_add_f32 v107, v107, v111
    v_add_f32 v6, v100, v106
    v_add_f32 v7, v101, v107
    v_mov_b32 v8, v6
    v_mov_b32 v9, v7
    s_nop 1
    v_permlane32_swap_b32 v8, v6
    v_permlane32_swap_b32 v9, v7
    s_nop 1
    v_add_f32 v6, v6, v8
    v_add_f32 v7, v7, v9
    v_mul_f32 v6, 0x3b124925, v6
    v_mul_f32 v7, 0x3b124925, v7
    v_fma_f32 v7, -v6, v6, v7
    v_max_f32 v7, 0, v7
    v_add_f32 v7, 0x3727c5ac, v7
    v_rsq_f32 v7, v7
    s_nop 0
    s_barrier
    s_branch Lqp_38
Lkv_37:
    s_waitcnt vmcnt(0)
    v_add_f32 v102, v102, v104
    v_add_f32 v103, v103, v105
    v_add_f32 v106, v106, v108
    v_add_f32 v107, v107, v109
    v_add_f32 v110, v110, v112
    v_add_f32 v111, v111, v113
    v_add_f32 v100, v100, v102
    v_add_f32 v101, v101, v103
    v_add_f32 v106, v106, v110
    v_add_f32 v107, v107, v111
    v_add_f32 v6, v100, v106
    v_add_f32 v7, v101, v107
    v_mov_b32 v8, v6
    v_mov_b32 v9, v7
    s_nop 1
    v_permlane32_swap_b32 v8, v6
    v_permlane32_swap_b32 v9, v7
    s_nop 1
    v_add_f32 v6, v6, v8
    v_add_f32 v7, v7, v9
    v_mul_f32 v6, 0x3b124925, v6
    v_mul_f32 v7, 0x3b124925, v7
    v_fma_f32 v7, -v6, v6, v7
    v_max_f32 v7, 0, v7
    v_add_f32 v7, 0x3727c5ac, v7
    v_rsq_f32 v7, v7
    s_nop 0
    s_mul_i32 s24, s3, 7168
    v_add_u32 v8, s24, v0
    ds_read_b128 v[16:19], v8 offset:0
    ds_read_b128 v[20:23], v8 offset:1024
    ds_read_b128 v[24:27], v8 offset:2048
    ds_read_b128 v[28:31], v8 offset:3072
    ds_read_b128 v[32:35], v8 offset:4096
    ds_read_b128 v[36:39], v8 offset:5120
    ds_read_b128 v[40:43], v8 offset:6144
    s_lshl_b32 s48, s4, 12
    s_lshl_b32 s24, s3, 10
    s_add_u32 s48, s48, s24
    s_add_u32 s48, s48, s7
    s_add_u32 s48, s48, 15213568
    s_waitcnt lgkmcnt(0)
    v_mul_f32 v8, v6, v7
    v_sub_f32 v8, 0, v8
    v_lshlrev_b32 v9, 16, v16
    v_and_b32 v10, 0xffff0000, v16
    v_fma_f32 v9, v9, v7, v8
    v_fma_f32 v10, v10, v7, v8
    v_cvt_pk_bf16_f32 v16, v9, v10
    v_lshlrev_b32 v9, 16, v17
    v_and_b32 v10, 0xffff0000, v17
    v_fma_f32 v9, v9, v7, v8
    v_fma_f32 v10, v10, v7, v8
    v_cvt_pk_bf16_f32 v17, v9, v10
    v_lshlrev_b32 v9, 16, v18
    v_and_b32 v10, 0xffff0000, v18
    v_fma_f32 v9, v9, v7, v8
    v_fma_f32 v10, v10, v7, v8
    v_cvt_pk_bf16_f32 v18, v9, v10
    v_lshlrev_b32 v9, 16, v19
    v_and_b32 v10, 0xffff0000, v19
    v_fma_f32 v9, v9, v7, v8
    v_fma_f32 v10, v10, v7, v8
    v_cvt_pk_bf16_f32 v19, v9, v10
    s_nop 1
    v_mfma_f32_32x32x16_bf16 v[48:63], a[224:227], v[16:19], 0
    v_mfma_f32_32x32x16_bf16 v[64:79], v[16:19], a[252:255], 0
    v_lshlrev_b32 v9, 16, v20
    v_and_b32 v10, 0xffff0000, v20
    v_fma_f32 v9, v9, v7, v8
    v_fma_f32 v10, v10, v7, v8
    v_cvt_pk_bf16_f32 v20, v9, v10
    v_lshlrev_b32 v9, 16, v21
    v_and_b32 v10, 0xffff0000, v21
    v_fma_f32 v9, v9, v7, v8
    v_fma_f32 v10, v10, v7, v8
    v_cvt_pk_bf16_f32 v21, v9, v10
    v_lshlrev_b32 v9, 16, v22
    v_and_b32 v10, 0xffff0000, v22
    v_fma_f32 v9, v9, v7, v8
    v_fma_f32 v10, v10, v7, v8
    v_cvt_pk_bf16_f32 v22, v9, v10
    v_lshlrev_b32 v9, 16, v23
    v_and_b32 v10, 0xffff0000, v23
    v_fma_f32 v9, v9, v7, v8
    v_fma_f32 v10, v10, v7, v8
    v_cvt_pk_bf16_f32 v23, v9, v10
    s_nop 1
    v_mfma_f32_32x32x16_bf16 v[48:63], a[228:231], v[20:23], v[48:63]
    v_mfma_f32_32x32x16_bf16 v[64:79], v[20:23], v[232:235], v[64:79]
    v_lshlrev_b32 v9, 16, v24
    v_and_b32 v10, 0xffff0000, v24
    v_fma_f32 v9, v9, v7, v8
    v_fma_f32 v10, v10, v7, v8
    v_cvt_pk_bf16_f32 v24, v9, v10
    v_lshlrev_b32 v9, 16, v25
    v_and_b32 v10, 0xffff0000, v25
    v_fma_f32 v9, v9, v7, v8
    v_fma_f32 v10, v10, v7, v8
    v_cvt_pk_bf16_f32 v25, v9, v10
    v_lshlrev_b32 v9, 16, v26
    v_and_b32 v10, 0xffff0000, v26
    v_fma_f32 v9, v9, v7, v8
    v_fma_f32 v10, v10, v7, v8
    v_cvt_pk_bf16_f32 v26, v9, v10
    v_lshlrev_b32 v9, 16, v27
    v_and_b32 v10, 0xffff0000, v27
    v_fma_f32 v9, v9, v7, v8
    v_fma_f32 v10, v10, v7, v8
    v_cvt_pk_bf16_f32 v27, v9, v10
    s_nop 1
    v_mfma_f32_32x32x16_bf16 v[48:63], a[232:235], v[24:27], v[48:63]
    v_mfma_f32_32x32x16_bf16 v[64:79], v[24:27], v[236:239], v[64:79]
    v_lshlrev_b32 v9, 16, v28
    v_and_b32 v10, 0xffff0000, v28
    v_fma_f32 v9, v9, v7, v8
    v_fma_f32 v10, v10, v7, v8
    v_cvt_pk_bf16_f32 v28, v9, v10
    v_lshlrev_b32 v9, 16, v29
    v_and_b32 v10, 0xffff0000, v29
    v_fma_f32 v9, v9, v7, v8
    v_fma_f32 v10, v10, v7, v8
    v_cvt_pk_bf16_f32 v29, v9, v10
    v_lshlrev_b32 v9, 16, v30
    v_and_b32 v10, 0xffff0000, v30
    v_fma_f32 v9, v9, v7, v8
    v_fma_f32 v10, v10, v7, v8
    v_cvt_pk_bf16_f32 v30, v9, v10
    v_lshlrev_b32 v9, 16, v31
    v_and_b32 v10, 0xffff0000, v31
    v_fma_f32 v9, v9, v7, v8
    v_fma_f32 v10, v10, v7, v8
    v_cvt_pk_bf16_f32 v31, v9, v10
    s_nop 1
    v_mfma_f32_32x32x16_bf16 v[48:63], a[236:239], v[28:31], v[48:63]
    v_mfma_f32_32x32x16_bf16 v[64:79], v[28:31], v[240:243], v[64:79]
    v_lshlrev_b32 v9, 16, v32
    v_and_b32 v10, 0xffff0000, v32
    v_fma_f32 v9, v9, v7, v8
    v_fma_f32 v10, v10, v7, v8
    v_cvt_pk_bf16_f32 v32, v9, v10
    v_lshlrev_b32 v9, 16, v33
    v_and_b32 v10, 0xffff0000, v33
    v_fma_f32 v9, v9, v7, v8
    v_fma_f32 v10, v10, v7, v8
    v_cvt_pk_bf16_f32 v33, v9, v10
    v_lshlrev_b32 v9, 16, v34
    v_and_b32 v10, 0xffff0000, v34
    v_fma_f32 v9, v9, v7, v8
    v_fma_f32 v10, v10, v7, v8
    v_cvt_pk_bf16_f32 v34, v9, v10
    v_lshlrev_b32 v9, 16, v35
    v_and_b32 v10, 0xffff0000, v35
    v_fma_f32 v9, v9, v7, v8
    v_fma_f32 v10, v10, v7, v8
    v_cvt_pk_bf16_f32 v35, v9, v10
    s_nop 1
    v_mfma_f32_32x32x16_bf16 v[48:63], a[240:243], v[32:35], v[48:63]
    v_mfma_f32_32x32x16_bf16 v[64:79], v[32:35], v[244:247], v[64:79]
    v_lshlrev_b32 v9, 16, v36
    v_and_b32 v10, 0xffff0000, v36
    v_fma_f32 v9, v9, v7, v8
    v_fma_f32 v10, v10, v7, v8
    v_cvt_pk_bf16_f32 v36, v9, v10
    v_lshlrev_b32 v9, 16, v37
    v_and_b32 v10, 0xffff0000, v37
    v_fma_f32 v9, v9, v7, v8
    v_fma_f32 v10, v10, v7, v8
    v_cvt_pk_bf16_f32 v37, v9, v10
    v_lshlrev_b32 v9, 16, v38
    v_and_b32 v10, 0xffff0000, v38
    v_fma_f32 v9, v9, v7, v8
    v_fma_f32 v10, v10, v7, v8
    v_cvt_pk_bf16_f32 v38, v9, v10
    v_lshlrev_b32 v9, 16, v39
    v_and_b32 v10, 0xffff0000, v39
    v_fma_f32 v9, v9, v7, v8
    v_fma_f32 v10, v10, v7, v8
    v_cvt_pk_bf16_f32 v39, v9, v10
    s_nop 1
    v_mfma_f32_32x32x16_bf16 v[48:63], a[244:247], v[36:39], v[48:63]
    v_mfma_f32_32x32x16_bf16 v[64:79], v[36:39], v[248:251], v[64:79]
    v_lshlrev_b32 v9, 16, v40
    v_and_b32 v10, 0xffff0000, v40
    v_fma_f32 v9, v9, v7, v8
    v_fma_f32 v10, v10, v7, v8
    v_cvt_pk_bf16_f32 v40, v9, v10
    v_lshlrev_b32 v9, 16, v41
    v_and_b32 v10, 0xffff0000, v41
    v_fma_f32 v9, v9, v7, v8
    v_fma_f32 v10, v10, v7, v8
    v_cvt_pk_bf16_f32 v41, v9, v10
    v_lshlrev_b32 v9, 16, v42
    v_and_b32 v10, 0xffff0000, v42
    v_fma_f32 v9, v9, v7, v8
    v_fma_f32 v10, v10, v7, v8
    v_cvt_pk_bf16_f32 v42, v9, v10
    v_lshlrev_b32 v9, 16, v43
    v_and_b32 v10, 0xffff0000, v43
    v_fma_f32 v9, v9, v7, v8
    v_fma_f32 v10, v10, v7, v8
    v_cvt_pk_bf16_f32 v43, v9, v10
    s_nop 1
    v_mfma_f32_32x32x16_bf16 v[48:63], a[248:251], v[40:43], v[48:63]
    v_mfma_f32_32x32x16_bf16 v[64:79], v[40:43], v[252:255], v[64:79]
    s_lshl_b32 s30, s3, 13
    s_add_u32 s30, s30, 28672
    v_add_u32 v8, s30, v0
    s_lshl_b32 s30, s3, 11
    s_add_u32 s30, s30, 28672
    v_add_u32 v9, s30, v0
    s_cmp_eq_u32 s3, 3
    s_cselect_b32 s30, 90112, 0
    v_add_u32 v12, s30, v8
    s_cmp_ge_u32 s3, 2
    s_cselect_b32 s30, 90112, 0
    v_add_u32 v14, s30, v9
    v_mov_b32 v10, 1.0
    v_cmp_eq_u32 vcc, 28, v1
    s_cmp_ge_u32 s3, 2
    s_cselect_b32 s30, 0, 1.0
    v_mov_b32 v11, s30
    v_cndmask_b32 v10, v11, v10, vcc
    s_cselect_b32 s44, 0xf0000000, 0
    s_mov_b32 s45, s44
    s_mov_b32 s46, s44
    s_cmp_eq_u32 s3, 1
    s_cselect_b32 s47, -1, s44
    s_nop 4
    ds_write_b128 v8, v[48:51] offset:0
    ds_write_b128 v8, v[52:55] offset:1024
    ds_write_b128 v8, v[56:59] offset:2048
    ds_write_b128 v8, v[60:63] offset:3072
    ds_write_b128 v12, v[64:67] offset:4096
    ds_write_b128 v12, v[68:71] offset:5120
    ds_write_b128 v12, v[72:75] offset:6144
    ds_write_b128 v12, v[76:79] offset:7168
    s_waitcnt lgkmcnt(0)
    s_barrier
    ds_read_b128 v[16:19], v9 offset:0
    ds_read_b128 v[20:23], v9 offset:1024
    ds_read_b128 v[24:27], v9 offset:8192
    ds_read_b128 v[28:31], v9 offset:9216
    ds_read_b128 v[32:35], v9 offset:16384
    ds_read_b128 v[36:39], v9 offset:17408
    ds_read_b128 v[40:43], v14 offset:24576
    ds_read_b128 v[44:47], v14 offset:25600
    s_waitcnt lgkmcnt(4)
    v_add_f32 v16, v16, v24
    v_add_f32 v17, v17, v25
    v_add_f32 v18, v18, v26
    v_add_f32 v19, v19, v27
    v_add_f32 v20, v20, v28
    v_add_f32 v21, v21, v29
    v_add_f32 v22, v22, v30
    v_add_f32 v23, v23, v31
    s_waitcnt lgkmcnt(2)
    v_add_f32 v16, v16, v32
    v_add_f32 v17, v17, v33
    v_add_f32 v18, v18, v34
    v_add_f32 v19, v19, v35
    v_add_f32 v20, v20, v36
    v_add_f32 v21, v21, v37
    v_add_f32 v22, v22, v38
    v_add_f32 v23, v23, v39
    s_waitcnt lgkmcnt(0)
    v_add_f32 v16, v16, v40
    v_add_f32 v17, v17, v41
    v_add_f32 v18, v18, v42
    v_add_f32 v19, v19, v43
    v_add_f32 v20, v20, v44
    v_add_f32 v21, v21, v45
    v_add_f32 v22, v22, v46
    v_add_f32 v23, v23, v47
    v_cndmask_b32 v16, v16, v10, s[44:45]
    v_cndmask_b32 v17, v17, v10, s[44:45]
    v_cndmask_b32 v18, v18, v10, s[44:45]
    v_cndmask_b32 v19, v19, v10, s[44:45]
    v_cndmask_b32 v20, v20, v10, s[46:47]
    v_cndmask_b32 v21, v21, v10, s[46:47]
    v_cndmask_b32 v22, v22, v10, s[46:47]
    v_cndmask_b32 v23, v23, v10, s[46:47]
    v_cvt_pk_bf16_f32 v24, v16, v17
    v_cvt_pk_bf16_f32 v25, v18, v19
    v_cvt_pk_bf16_f32 v26, v20, v21
    v_cvt_pk_bf16_f32 v27, v22, v23
    buffer_store_dwordx4 v[24:27], v0, s[8:11], s48 offen offset:0 sc1
    buffer_load_dwordx4 v[220:223], v0, s[8:11], s29 offen offset:2048
    buffer_load_dwordx4 v[88:91], v0, s[8:11], s29 offen offset:3072
    s_add_u32 s29, s29, 4096
    buffer_load_dwordx4 v[92:95], v0, s[8:11], s29 offen offset:0
    buffer_load_dwordx4 v[96:99], v0, s[8:11], s29 offen offset:1024
    buffer_load_dwordx4 v[80:83], v0, s[8:11], s29 offen offset:2048
    buffer_load_dwordx4 v[84:87], v0, s[8:11], s29 offen offset:3072
    v_lshlrev_b32 v9, 4, v2
    buffer_load_dwordx4 v[116:119], v9, s[8:11], s28 offen offset:0
    buffer_load_dwordx4 v[120:123], v9, s[8:11], s28 offen offset:32
    buffer_load_dwordx4 v[124:127], v9, s[8:11], s28 offen offset:64
    buffer_load_dwordx4 v[128:131], v9, s[8:11], s28 offen offset:96
Lqp_38:
    ds_read_b128 v[224:227], v0 offset:0
    ds_read_b128 v[228:231], v0 offset:1024
    ds_read_b128 v[232:235], v0 offset:2048
    ds_read_b128 v[236:239], v0 offset:3072
    ds_read_b128 v[240:243], v0 offset:4096
    ds_read_b128 v[244:247], v0 offset:5120
    ds_read_b128 v[248:251], v0 offset:6144
    ds_read_b128 v[252:255], v0 offset:7168
    v_mul_f32 v7, 0x3e8b97f6, v7
    s_waitcnt lgkmcnt(7)
    v_mfma_f32_32x32x16_bf16 v[48:63], v[132:135], v[224:227], 0
    s_cmp_lg_u32 s5, 0
    s_cbranch_scc1 Ldm_39
    s_waitcnt vmcnt(10)
    s_barrier
    s_cmp_lg_u32 s3, 0
    s_cbranch_scc1 Ldm_39
    s_lshl_b32 s24, s4, 6
    s_add_u32 s24, s24, 15754240
    s_add_u32 s30, s32, 64
    v_mov_b32 v14, s30
    v_mov_b32 v15, 0
    s_mov_b64 exec, 1
    buffer_store_dword v14, v15, s[8:11], s24 offen sc1
    s_mov_b64 exec, -1
    s_branch Lnokv_36
Ldm_39:
    buffer_load_dword v11, v13, s[8:11], s28 offen
Lnokv_36:
    ds_read_b128 v[224:227], v0 offset:8192
    s_waitcnt lgkmcnt(7)
    v_mfma_f32_32x32x16_bf16 v[48:63], v[136:139], v[228:231], v[48:63]
    ds_read_b128 v[228:231], v0 offset:9216
    s_waitcnt lgkmcnt(7)
    v_mfma_f32_32x32x16_bf16 v[48:63], v[140:143], v[232:235], v[48:63]
    ds_read_b128 v[232:235], v0 offset:10240
    s_waitcnt lgkmcnt(7)
    v_mfma_f32_32x32x16_bf16 v[48:63], v[144:147], v[236:239], v[48:63]
    ds_read_b128 v[236:239], v0 offset:11264
    s_waitcnt lgkmcnt(7)
    v_mfma_f32_32x32x16_bf16 v[48:63], v[148:151], v[240:243], v[48:63]
    ds_read_b128 v[240:243], v0 offset:12288
    s_waitcnt lgkmcnt(7)
    v_mfma_f32_32x32x16_bf16 v[48:63], v[152:155], v[244:247], v[48:63]
    ds_read_b128 v[244:247], v0 offset:13312
    s_waitcnt lgkmcnt(7)
    v_mfma_f32_32x32x16_bf16 v[48:63], v[156:159], v[248:251], v[48:63]
    ds_read_b128 v[248:251], v0 offset:14336
    s_waitcnt lgkmcnt(7)
    v_mfma_f32_32x32x16_bf16 v[48:63], v[160:163], v[252:255], v[48:63]
    ds_read_b128 v[252:255], v0 offset:15360
    s_waitcnt lgkmcnt(7)
    v_mfma_f32_32x32x16_bf16 v[48:63], v[164:167], v[224:227], v[48:63]
    ds_read_b128 v[224:227], v0 offset:16384
    s_waitcnt lgkmcnt(7)
    v_mfma_f32_32x32x16_bf16 v[48:63], v[168:171], v[228:231], v[48:63]
    ds_read_b128 v[228:231], v0 offset:17408
    s_waitcnt lgkmcnt(7)
    v_mfma_f32_32x32x16_bf16 v[48:63], v[172:175], v[232:235], v[48:63]
    ds_read_b128 v[232:235], v0 offset:18432
    s_waitcnt lgkmcnt(7)
    v_mfma_f32_32x32x16_bf16 v[48:63], v[176:179], v[236:239], v[48:63]
    ds_read_b128 v[236:239], v0 offset:19456
    s_waitcnt lgkmcnt(7)
    v_mfma_f32_32x32x16_bf16 v[48:63], v[180:183], v[240:243], v[48:63]
    ds_read_b128 v[240:243], v0 offset:20480
    s_waitcnt lgkmcnt(7)
    v_mfma_f32_32x32x16_bf16 v[48:63], v[184:187], v[244:247], v[48:63]
    ds_read_b128 v[244:247], v0 offset:21504
    s_waitcnt lgkmcnt(7)
    v_mfma_f32_32x32x16_bf16 v[48:63], v[188:191], v[248:251], v[48:63]
    ds_read_b128 v[248:251], v0 offset:22528
    s_waitcnt lgkmcnt(7)
    v_mfma_f32_32x32x16_bf16 v[48:63], v[192:195], v[252:255], v[48:63]
    ds_read_b128 v[252:255], v0 offset:23552
    s_waitcnt lgkmcnt(7)
    v_mfma_f32_32x32x16_bf16 v[48:63], v[196:199], v[224:227], v[48:63]
    ds_read_b128 v[224:227], v0 offset:24576
    s_waitcnt lgkmcnt(7)
    v_mfma_f32_32x32x16_bf16 v[48:63], v[200:203], v[228:231], v[48:63]
    ds_read_b128 v[228:231], v0 offset:25600
    s_waitcnt lgkmcnt(7)
    v_mfma_f32_32x32x16_bf16 v[48:63], v[204:207], v[232:235], v[48:63]
    ds_read_b128 v[232:235], v0 offset:26624
    s_waitcnt lgkmcnt(7)
    v_mfma_f32_32x32x16_bf16 v[48:63], v[208:211], v[236:239], v[48:63]
    ds_read_b128 v[236:239], v0 offset:27648
    s_waitcnt lgkmcnt(7)
    v_mfma_f32_32x32x16_bf16 v[48:63], v[212:215], v[240:243], v[48:63]
    s_waitcnt lgkmcnt(6)
    v_mfma_f32_32x32x16_bf16 v[48:63], v[216:219], v[244:247], v[48:63]
    s_waitcnt vmcnt(1) lgkmcnt(5)
    v_mfma_f32_32x32x16_bf16 v[48:63], v[220:223], v[248:251], v[48:63]
    s_waitcnt lgkmcnt(4)
    v_mfma_f32_32x32x16_bf16 v[48:63], v[88:91], v[252:255], v[48:63]
    s_waitcnt lgkmcnt(3)
    v_mfma_f32_32x32x16_bf16 v[48:63], v[92:95], v[224:227], v[48:63]
    s_waitcnt lgkmcnt(2)
    v_mfma_f32_32x32x16_bf16 v[48:63], v[96:99], v[228:231], v[48:63]
    s_waitcnt lgkmcnt(1)
    v_mfma_f32_32x32x16_bf16 v[48:63], v[80:83], v[232:235], v[48:63]
    s_waitcnt lgkmcnt(0)
    v_mfma_f32_32x32x16_bf16 v[48:63], v[84:87], v[236:239], v[48:63]
    s_add_u32 s30, s3, 0
    s_and_b32 s30, s30, 3
    s_mul_i32 s30, s30, 2048
    v_add_u32 v5, s30, v0
    s_add_u32 s30, s3, 1
    s_and_b32 s30, s30, 3
    s_mul_i32 s30, s30, 2048
    v_add_u32 v133, s30, v0
    s_add_u32 s30, s3, 2
    s_and_b32 s30, s30, 3
    s_mul_i32 s30, s30, 2048
    v_add_u32 v134, s30, v0
    s_add_u32 s30, s3, 3
    s_and_b32 s30, s30, 3
    s_mul_i32 s30, s30, 2048
    v_add_u32 v135, s30, v0
    v_fma_f32 v48, -v6, v116, v48
    v_mul_f32 v48, v7, v48
    v_fma_f32 v49, -v6, v117, v49
    v_mul_f32 v49, v7, v49
    v_fma_f32 v50, -v6, v118, v50
    v_mul_f32 v50, v7, v50
    v_fma_f32 v51, -v6, v119, v51
    v_mul_f32 v51, v7, v51
    v_fma_f32 v52, -v6, v120, v52
    v_mul_f32 v52, v7, v52
    v_fma_f32 v53, -v6, v121, v53
    v_mul_f32 v53, v7, v53
    v_fma_f32 v54, -v6, v122, v54
    v_mul_f32 v54, v7, v54
    v_fma_f32 v55, -v6, v123, v55
    v_mul_f32 v55, v7, v55
    v_fma_f32 v56, -v6, v124, v56
    v_mul_f32 v56, v7, v56
    v_fma_f32 v57, -v6, v125, v57
    v_mul_f32 v57, v7, v57
    v_fma_f32 v58, -v6, v126, v58
    v_mul_f32 v58, v7, v58
    v_fma_f32 v59, -v6, v127, v59
    v_mul_f32 v59, v7, v59
    v_fma_f32 v60, -v6, v128, v60
    v_mul_f32 v60, v7, v60
    v_fma_f32 v61, -v6, v129, v61
    v_mul_f32 v61, v7, v61
    v_fma_f32 v62, -v6, v130, v62
    v_mul_f32 v62, v7, v62
    v_fma_f32 v63, -v6, v131, v63
    v_mul_f32 v63, v7, v63
    v_cvt_pk_bf16_f32 v80, v48, v49
    v_cvt_pk_bf16_f32 v81, v50, v51
    v_cvt_pk_bf16_f32 v82, v52, v53
    v_cvt_pk_bf16_f32 v83, v54, v55
    v_cvt_pk_bf16_f32 v84, v56, v57
    v_cvt_pk_bf16_f32 v85, v58, v59
    v_cvt_pk_bf16_f32 v86, v60, v61
    v_cvt_pk_bf16_f32 v87, v62, v63
    s_mov_b32 exec_lo, 0
    v_mov_b32 v86, 0
    v_mov_b32 v87, 0
    s_mov_b32 exec_lo, -1
    ds_write_b128 v5, v[80:83] offset:49152
    ds_write_b128 v5, v[84:87] offset:50176
    s_waitcnt lgkmcnt(0)
    s_barrier
    ds_read_b128 v[16:19], v5 offset:49152
    ds_read_b128 v[20:23], v5 offset:50176
    ds_read_b128 v[24:27], v133 offset:49152
    ds_read_b128 v[28:31], v133 offset:50176
    ds_read_b128 v[32:35], v134 offset:49152
    ds_read_b128 v[36:39], v134 offset:50176
    ds_read_b128 v[40:43], v135 offset:49152
    ds_read_b128 v[44:47], v135 offset:50176
    s_lshl_b32 s24, s3, 10
    s_add_u32 s24, s24, 15754240
    s_mov_b64 exec, 0xffff
    v_lshlrev_b32 v12, 2, v0
    s_add_u32 s30, s32, 64
Lg_40:
    s_add_u32 s39, s39, 1
    s_cmp_gt_u32 s39, 1048576
    s_cbranch_scc1 Lgx_41
    s_mov_b32 s31, s24
    buffer_load_dword v8, v12, s[8:11], s31 offen sc1
    s_waitcnt vmcnt(0)
    v_subrev_u32 v8, s30, v8
    v_cmp_lt_u32 vcc, 15, v8
    s_cbranch_vccnz Lg_40
Lgx_41:
    s_mov_b64 exec, -1
    s_mov_b32 s26, 0
    buffer_load_dwordx4 v[160:163], v0, s[20:23], s26 offen offset:0
    buffer_load_dwordx4 v[164:167], v0, s[20:23], s26 offen offset:1024
    s_mov_b32 s27, 0
    buffer_load_dwordx4 v[168:171], v0, s[20:23], s27 offen offset:2048
    buffer_load_dwordx4 v[172:175], v0, s[20:23], s27 offen offset:3072
    s_mov_b32 s26, 4096
    buffer_load_dwordx4 v[176:179], v0, s[20:23], s26 offen offset:0
    buffer_load_dwordx4 v[180:183], v0, s[20:23], s26 offen offset:1024
    s_mov_b32 s27, 4096
    buffer_load_dwordx4 v[184:187], v0, s[20:23], s27 offen offset:2048
    buffer_load_dwordx4 v[188:191], v0, s[20:23], s27 offen offset:3072
    s_mov_b32 s26, 8192
    buffer_load_dwordx4 v[192:195], v0, s[20:23], s26 offen offset:0
    buffer_load_dwordx4 v[196:199], v0, s[20:23], s26 offen offset:1024
    s_mov_b32 s27, 8192
    buffer_load_dwordx4 v[200:203], v0, s[20:23], s27 offen offset:2048
    buffer_load_dwordx4 v[204:207], v0, s[20:23], s27 offen offset:3072
    s_mov_b32 s26, 12288
    buffer_load_dwordx4 v[208:211], v0, s[20:23], s26 offen offset:0
    buffer_load_dwordx4 v[212:215], v0, s[20:23], s26 offen offset:1024
    s_waitcnt lgkmcnt(0)
    s_mov_b32 s29, 0
Lagain_4:
    s_mul_i32 s45, s3, 7168
    s_mul_i32 s44, s6, 200704
    s_add_u32 s44, s44, s45
    s_add_u32 s44, s44, 974848
    s_lshl_b32 s47, s5, 2
    s_add_u32 s47, s47, s3
    s_min_u32 s47, s47, 13
    s_lshl_b32 s48, s47, 15
    s_add_u32 s48, s48, 516096
    s_mul_i32 s50, s4, 28672
    s_lshl_b32 s51, s47, 11
    s_add_u32 s50, s50, s51
    s_add_u32 s50, s50, 5809152
    s_mul_i32 s51, s6, 896
    s_add_u32 s51, s51, 5793792
    s_waitcnt vmcnt(12)
    v_mfma_f32_32x32x16_bf16 v[48:63], v[160:163], v[16:19], 0
    v_mfma_f32_32x32x16_bf16 v[48:63], v[164:167], v[20:23], v[48:63]
    s_nop 10
    v_mfma_f32_32x32x16_bf16 v[64:79], v[160:163], v[24:27], 0
    v_exp_f32 v48, v48
    v_exp_f32 v49, v49
    v_exp_f32 v50, v50
    v_exp_f32 v51, v51
    v_mfma_f32_32x32x16_bf16 v[64:79], v[164:167], v[28:31], v[64:79]
    v_exp_f32 v52, v52
    v_exp_f32 v53, v53
    v_exp_f32 v54, v54
    v_exp_f32 v55, v55
    v_cvt_pk_bf16_f32 v80, v48, v49
    v_cvt_pk_bf16_f32 v81, v50, v51
    v_exp_f32 v56, v56
    v_exp_f32 v57, v57
    v_exp_f32 v58, v58
    v_exp_f32 v59, v59
    v_cvt_pk_bf16_f32 v82, v52, v53
    v_cvt_pk_bf16_f32 v83, v54, v55
    s_add_u32 s49, s48, 0
    buffer_load_dwordx4 a[224:227], v0, s[8:11], s49 offen offset:0
    v_exp_f32 v60, v60
    v_exp_f32 v61, v61
    v_exp_f32 v62, v62
    v_exp_f32 v63, v63
    v_cvt_pk_bf16_f32 v84, v56, v57
    v_cvt_pk_bf16_f32 v85, v58, v59
    v_cvt_pk_bf16_f32 v86, v60, v61
    v_cvt_pk_bf16_f32 v87, v62, v63
    v_mfma_f32_32x32x16_bf16 v[48:63], v[160:163], v[32:35], 0
    v_exp_f32 v64, v64
    v_exp_f32 v65, v65
    v_exp_f32 v66, v66
    v_exp_f32 v67, v67
    v_mfma_f32_32x32x16_bf16 v[48:63], v[164:167], v[36:39], v[48:63]
    v_exp_f32 v68, v68
    v_exp_f32 v69, v69
    v_exp_f32 v70, v70
    v_exp_f32 v71, v71
    v_cvt_pk_bf16_f32 v88, v64, v65
    v_cvt_pk_bf16_f32 v89, v66, v67
    s_waitcnt vmcnt(11)
    v_mfma_f32_32x32x16_bf16 v[96:111], v[168:171], v[80:83], 0
    s_mov_b32 s27, 12288
    buffer_load_dwordx4 v[216:219], v0, s[20:23], s27 offen offset:2048
    buffer_load_dwordx4 v[220:223], v0, s[20:23], s27 offen offset:3072
    v_exp_f32 v72, v72
    v_exp_f32 v73, v73
    v_exp_f32 v74, v74
    v_exp_f32 v75, v75
    v_cvt_pk_bf16_f32 v90, v68, v69
    v_cvt_pk_bf16_f32 v91, v70, v71
    v_mfma_f32_32x32x16_bf16 v[96:111], v[172:175], v[84:87], v[96:111]
    buffer_load_dwordx4 a[228:231], v0, s[8:11], s49 offen offset:1024
    v_exp_f32 v76, v76
    v_exp_f32 v77, v77
    v_exp_f32 v78, v78
    v_exp_f32 v79, v79
    v_cvt_pk_bf16_f32 v92, v72, v73
    v_cvt_pk_bf16_f32 v93, v74, v75
    v_cvt_pk_bf16_f32 v94, v76, v77
    v_cvt_pk_bf16_f32 v95, v78, v79
    v_mfma_f32_32x32x16_bf16 v[64:79], v[160:163], v[40:43], 0
    v_exp_f32 v48, v48
    v_exp_f32 v49, v49
    v_exp_f32 v50, v50
    v_exp_f32 v51, v51
    v_mfma_f32_32x32x16_bf16 v[64:79], v[164:167], v[44:47], v[64:79]
    v_exp_f32 v52, v52
    v_exp_f32 v53, v53
    v_exp_f32 v54, v54
    v_exp_f32 v55, v55
    v_cvt_pk_bf16_f32 v80, v48, v49
    v_cvt_pk_bf16_f32 v81, v50, v51
    v_mfma_f32_32x32x16_bf16 v[112:127], v[168:171], v[88:91], 0
    v_exp_f32 v56, v56
    v_exp_f32 v57, v57
    v_exp_f32 v58, v58
    v_exp_f32 v59, v59
    v_cvt_pk_bf16_f32 v82, v52, v53
    v_cvt_pk_bf16_f32 v83, v54, v55
    v_mfma_f32_32x32x16_bf16 v[112:127], v[172:175], v[92:95], v[112:127]
    buffer_load_dwordx4 a[232:235], v0, s[8:11], s49 offen offset:2048
    v_exp_f32 v60, v60
    v_exp_f32 v61, v61
    v_exp_f32 v62, v62
    v_exp_f32 v63, v63
    v_cvt_pk_bf16_f32 v84, v56, v57
    v_cvt_pk_bf16_f32 v85, v58, v59
    v_cvt_pk_bf16_f32 v86, v60, v61
    v_cvt_pk_bf16_f32 v87, v62, v63
    s_waitcnt vmcnt(13)
    v_mfma_f32_32x32x16_bf16 v[48:63], v[176:179], v[16:19], 0
    v_exp_f32 v64, v64
    v_exp_f32 v65, v65
    v_exp_f32 v66, v66
    v_exp_f32 v67, v67
    v_mfma_f32_32x32x16_bf16 v[48:63], v[180:183], v[20:23], v[48:63]
    s_mov_b32 s26, 16384
    buffer_load_dwordx4 v[160:163], v0, s[20:23], s26 offen offset:0
    buffer_load_dwordx4 v[164:167], v0, s[20:23], s26 offen offset:1024
    v_exp_f32 v68, v68
    v_exp_f32 v69, v69
    v_exp_f32 v70, v70
    v_exp_f32 v71, v71
    v_cvt_pk_bf16_f32 v88, v64, v65
    v_cvt_pk_bf16_f32 v89, v66, v67
    v_mfma_f32_32x32x16_bf16 v[128:143], v[168:171], v[80:83], 0
    v_exp_f32 v72, v72
    v_exp_f32 v73, v73
    v_exp_f32 v74, v74
    v_exp_f32 v75, v75
    v_cvt_pk_bf16_f32 v90, v68, v69
    v_cvt_pk_bf16_f32 v91, v70, v71
    v_mfma_f32_32x32x16_bf16 v[128:143], v[172:175], v[84:87], v[128:143]
    buffer_load_dwordx4 a[236:239], v0, s[8:11], s49 offen offset:3072
    v_exp_f32 v76, v76
    v_exp_f32 v77, v77
    v_exp_f32 v78, v78
    v_exp_f32 v79, v79
    v_cvt_pk_bf16_f32 v92, v72, v73
    v_cvt_pk_bf16_f32 v93, v74, v75
    v_cvt_pk_bf16_f32 v94, v76, v77
    v_cvt_pk_bf16_f32 v95, v78, v79
    v_mfma_f32_32x32x16_bf16 v[64:79], v[176:179], v[24:27], 0
    v_exp_f32 v48, v48
    v_exp_f32 v49, v49
    v_exp_f32 v50, v50
    v_exp_f32 v51, v51
    v_mfma_f32_32x32x16_bf16 v[64:79], v[180:183], v[28:31], v[64:79]
    v_exp_f32 v52, v52
    v_exp_f32 v53, v53
    v_exp_f32 v54, v54
    v_exp_f32 v55, v55
    v_cvt_pk_bf16_f32 v80, v48, v49
    v_cvt_pk_bf16_f32 v81, v50, v51
    v_mfma_f32_32x32x16_bf16 v[144:159], v[168:171], v[88:91], 0
    v_exp_f32 v56, v56
    v_exp_f32 v57, v57
    v_exp_f32 v58, v58
    v_exp_f32 v59, v59
    v_cvt_pk_bf16_f32 v82, v52, v53
    v_cvt_pk_bf16_f32 v83, v54, v55
    v_mfma_f32_32x32x16_bf16 v[144:159], v[172:175], v[92:95], v[144:159]
    s_add_u32 s49, s48, 4096
    buffer_load_dwordx4 a[240:243], v0, s[8:11], s49 offen offset:0
    v_exp_f32 v60, v60
    v_exp_f32 v61, v61
    v_exp_f32 v62, v62
    v_exp_f32 v63, v63
    v_cvt_pk_bf16_f32 v84, v56, v57
    v_cvt_pk_bf16_f32 v85, v58, v59
    v_cvt_pk_bf16_f32 v86, v60, v61
    v_cvt_pk_bf16_f32 v87, v62, v63
    v_mfma_f32_32x32x16_bf16 v[48:63], v[176:179], v[32:35], 0
    v_exp_f32 v64, v64
    v_exp_f32 v65, v65
    v_exp_f32 v66, v66
    v_exp_f32 v67, v67
    v_mfma_f32_32x32x16_bf16 v[48:63], v[180:183], v[36:39], v[48:63]
    v_exp_f32 v68, v68
    v_exp_f32 v69, v69
    v_exp_f32 v70, v70
    v_exp_f32 v71, v71
    v_cvt_pk_bf16_f32 v88, v64, v65
    v_cvt_pk_bf16_f32 v89, v66, v67
    s_waitcnt vmcnt(15)
    v_mfma_f32_32x32x16_bf16 v[96:111], v[184:187], v[80:83], v[96:111]
    s_mov_b32 s27, 16384
    buffer_load_dwordx4 v[168:171], v0, s[20:23], s27 offen offset:2048
    buffer_load_dwordx4 v[172:175], v0, s[20:23], s27 offen offset:3072
    v_exp_f32 v72, v72
    v_exp_f32 v73, v73
    v_exp_f32 v74, v74
    v_exp_f32 v75, v75
    v_cvt_pk_bf16_f32 v90, v68, v69
    v_cvt_pk_bf16_f32 v91, v70, v71
    v_mfma_f32_32x32x16_bf16 v[96:111], v[188:191], v[84:87], v[96:111]
    buffer_load_dwordx4 a[244:247], v0, s[8:11], s49 offen offset:1024
    v_exp_f32 v76, v76
    v_exp_f32 v77, v77
    v_exp_f32 v78, v78
    v_exp_f32 v79, v79
    v_cvt_pk_bf16_f32 v92, v72, v73
    v_cvt_pk_bf16_f32 v93, v74, v75
    v_cvt_pk_bf16_f32 v94, v76, v77
    v_cvt_pk_bf16_f32 v95, v78, v79
    v_mfma_f32_32x32x16_bf16 v[64:79], v[176:179], v[40:43], 0
    v_exp_f32 v48, v48
    v_exp_f32 v49, v49
    v_exp_f32 v50, v50
    v_exp_f32 v51, v51
    v_mfma_f32_32x32x16_bf16 v[64:79], v[180:183], v[44:47], v[64:79]
    v_exp_f32 v52, v52
    v_exp_f32 v53, v53
    v_exp_f32 v54, v54
    v_exp_f32 v55, v55
    v_cvt_pk_bf16_f32 v80, v48, v49
    v_cvt_pk_bf16_f32 v81, v50, v51
    v_mfma_f32_32x32x16_bf16 v[112:127], v[184:187], v[88:91], v[112:127]
    v_exp_f32 v56, v56
    v_exp_f32 v57, v57
    v_exp_f32 v58, v58
    v_exp_f32 v59, v59
    v_cvt_pk_bf16_f32 v82, v52, v53
    v_cvt_pk_bf16_f32 v83, v54, v55
    v_mfma_f32_32x32x16_bf16 v[112:127], v[188:191], v[92:95], v[112:127]
    buffer_load_dwordx4 a[248:251], v0, s[8:11], s49 offen offset:2048
    v_exp_f32 v60, v60
    v_exp_f32 v61, v61
    v_exp_f32 v62, v62
    v_exp_f32 v63, v63
    v_cvt_pk_bf16_f32 v84, v56, v57
    v_cvt_pk_bf16_f32 v85, v58, v59
    v_cvt_pk_bf16_f32 v86, v60, v61
    v_cvt_pk_bf16_f32 v87, v62, v63
    s_waitcnt vmcnt(17)
    v_mfma_f32_32x32x16_bf16 v[48:63], v[192:195], v[16:19], 0
    v_exp_f32 v64, v64
    v_exp_f32 v65, v65
    v_exp_f32 v66, v66
    v_exp_f32 v67, v67
    v_mfma_f32_32x32x16_bf16 v[48:63], v[196:199], v[20:23], v[48:63]
    s_mov_b32 s26, 20480
    buffer_load_dwordx4 v[176:179], v0, s[20:23], s26 offen offset:0
    buffer_load_dwordx4 v[180:183], v0, s[20:23], s26 offen offset:1024
    v_exp_f32 v68, v68
    v_exp_f32 v69, v69
    v_exp_f32 v70, v70
    v_exp_f32 v71, v71
    v_cvt_pk_bf16_f32 v88, v64, v65
    v_cvt_pk_bf16_f32 v89, v66, v67
    v_mfma_f32_32x32x16_bf16 v[128:143], v[184:187], v[80:83], v[128:143]
    v_exp_f32 v72, v72
    v_exp_f32 v73, v73
    v_exp_f32 v74, v74
    v_exp_f32 v75, v75
    v_cvt_pk_bf16_f32 v90, v68, v69
    v_cvt_pk_bf16_f32 v91, v70, v71
    v_mfma_f32_32x32x16_bf16 v[128:143], v[188:191], v[84:87], v[128:143]
    buffer_load_dwordx4 a[252:255], v0, s[8:11], s49 offen offset:3072
    v_exp_f32 v76, v76
    v_exp_f32 v77, v77
    v_exp_f32 v78, v78
    v_exp_f32 v79, v79
    v_cvt_pk_bf16_f32 v92, v72, v73
    v_cvt_pk_bf16_f32 v93, v74, v75
    v_cvt_pk_bf16_f32 v94, v76, v77
    v_cvt_pk_bf16_f32 v95, v78, v79
    v_mfma_f32_32x32x16_bf16 v[64:79], v[192:195], v[24:27], 0
    v_exp_f32 v48, v48
    v_exp_f32 v49, v49
    v_exp_f32 v50, v50
    v_exp_f32 v51, v51
    v_mfma_f32_32x32x16_bf16 v[64:79], v[196:199], v[28:31], v[64:79]
    v_exp_f32 v52, v52
    v_exp_f32 v53, v53
    v_exp_f32 v54, v54
    v_exp_f32 v55, v55
    v_cvt_pk_bf16_f32 v80, v48, v49
    v_cvt_pk_bf16_f32 v81, v50, v51
    v_mfma_f32_32x32x16_bf16 v[144:159], v[184:187], v[88:91], v[144:159]
    v_exp_f32 v56, v56
    v_exp_f32 v57, v57
    v_exp_f32 v58, v58
    v_exp_f32 v59, v59
    v_cvt_pk_bf16_f32 v82, v52, v53
    v_cvt_pk_bf16_f32 v83, v54, v55
    v_mfma_f32_32x32x16_bf16 v[144:159], v[188:191], v[92:95], v[144:159]
    s_add_u32 s49, s48, 8192
    buffer_load_dwordx4 v[232:235], v0, s[8:11], s49 offen offset:0
    v_exp_f32 v60, v60
    v_exp_f32 v61, v61
    v_exp_f32 v62, v62
    v_exp_f32 v63, v63
    v_cvt_pk_bf16_f32 v84, v56, v57
    v_cvt_pk_bf16_f32 v85, v58, v59
    v_cvt_pk_bf16_f32 v86, v60, v61
    v_cvt_pk_bf16_f32 v87, v62, v63
    v_mfma_f32_32x32x16_bf16 v[48:63], v[192:195], v[32:35], 0
    v_exp_f32 v64, v64
    v_exp_f32 v65, v65
    v_exp_f32 v66, v66
    v_exp_f32 v67, v67
    v_mfma_f32_32x32x16_bf16 v[48:63], v[196:199], v[36:39], v[48:63]
    v_exp_f32 v68, v68
    v_exp_f32 v69, v69
    v_exp_f32 v70, v70
    v_exp_f32 v71, v71
    v_cvt_pk_bf16_f32 v88, v64, v65
    v_cvt_pk_bf16_f32 v89, v66, v67
    s_waitcnt vmcnt(19)
    v_mfma_f32_32x32x16_bf16 v[96:111], v[200:203], v[80:83], v[96:111]
    s_mov_b32 s27, 20480
    buffer_load_dwordx4 v[184:187], v0, s[20:23], s27 offen offset:2048
    buffer_load_dwordx4 v[188:191], v0, s[20:23], s27 offen offset:3072
    v_exp_f32 v72, v72
    v_exp_f32 v73, v73
    v_exp_f32 v74, v74
    v_exp_f32 v75, v75
    v_cvt_pk_bf16_f32 v90, v68, v69
    v_cvt_pk_bf16_f32 v91, v70, v71
    v_mfma_f32_32x32x16_bf16 v[96:111], v[204:207], v[84:87], v[96:111]
    buffer_load_dwordx4 v[236:239], v0, s[8:11], s49 offen offset:1024
    v_exp_f32 v76, v76
    v_exp_f32 v77, v77
    v_exp_f32 v78, v78
    v_exp_f32 v79, v79
    v_cvt_pk_bf16_f32 v92, v72, v73
    v_cvt_pk_bf16_f32 v93, v74, v75
    v_cvt_pk_bf16_f32 v94, v76, v77
    v_cvt_pk_bf16_f32 v95, v78, v79
    v_mfma_f32_32x32x16_bf16 v[64:79], v[192:195], v[40:43], 0
    v_exp_f32 v48, v48
    v_exp_f32 v49, v49
    v_exp_f32 v50, v50
    v_exp_f32 v51, v51
    v_mfma_f32_32x32x16_bf16 v[64:79], v[196:199], v[44:47], v[64:79]
    v_exp_f32 v52, v52
    v_exp_f32 v53, v53
    v_exp_f32 v54, v54
    v_exp_f32 v55, v55
    v_cvt_pk_bf16_f32 v80, v48, v49
    v_cvt_pk_bf16_f32 v81, v50, v51
    v_mfma_f32_32x32x16_bf16 v[112:127], v[200:203], v[88:91], v[112:127]
    v_exp_f32 v56, v56
    v_exp_f32 v57, v57
    v_exp_f32 v58, v58
    v_exp_f32 v59, v59
    v_cvt_pk_bf16_f32 v82, v52, v53
    v_cvt_pk_bf16_f32 v83, v54, v55
    v_mfma_f32_32x32x16_bf16 v[112:127], v[204:207], v[92:95], v[112:127]
    buffer_load_dwordx4 v[240:243], v0, s[8:11], s49 offen offset:2048
    v_exp_f32 v60, v60
    v_exp_f32 v61, v61
    v_exp_f32 v62, v62
    v_exp_f32 v63, v63
    v_cvt_pk_bf16_f32 v84, v56, v57
    v_cvt_pk_bf16_f32 v85, v58, v59
    v_cvt_pk_bf16_f32 v86, v60, v61
    v_cvt_pk_bf16_f32 v87, v62, v63
    s_waitcnt vmcnt(21)
    v_mfma_f32_32x32x16_bf16 v[48:63], v[208:211], v[16:19], 0
    v_exp_f32 v64, v64
    v_exp_f32 v65, v65
    v_exp_f32 v66, v66
    v_exp_f32 v67, v67
    v_mfma_f32_32x32x16_bf16 v[48:63], v[212:215], v[20:23], v[48:63]
    s_mov_b32 s26, 24576
    buffer_load_dwordx4 v[192:195], v0, s[20:23], s26 offen offset:0
    buffer_load_dwordx4 v[196:199], v0, s[20:23], s26 offen offset:1024
    v_exp_f32 v68, v68
    v_exp_f32 v69, v69
    v_exp_f32 v70, v70
    v_exp_f32 v71, v71
    v_cvt_pk_bf16_f32 v88, v64, v65
    v_cvt_pk_bf16_f32 v89, v66, v67
    v_mfma_f32_32x32x16_bf16 v[128:143], v[200:203], v[80:83], v[128:143]
    v_exp_f32 v72, v72
    v_exp_f32 v73, v73
    v_exp_f32 v74, v74
    v_exp_f32 v75, v75
    v_cvt_pk_bf16_f32 v90, v68, v69
    v_cvt_pk_bf16_f32 v91, v70, v71
    v_mfma_f32_32x32x16_bf16 v[128:143], v[204:207], v[84:87], v[128:143]
    buffer_load_dwordx4 v[244:247], v0, s[8:11], s49 offen offset:3072
    v_exp_f32 v76, v76
    v_exp_f32 v77, v77
    v_exp_f32 v78, v78
    v_exp_f32 v79, v79
    v_cvt_pk_bf16_f32 v92, v72, v73
    v_cvt_pk_bf16_f32 v93, v74, v75
    v_cvt_pk_bf16_f32 v94, v76, v77
    v_cvt_pk_bf16_f32 v95, v78, v79
    v_mfma_f32_32x32x16_bf16 v[64:79], v[208:211], v[24:27], 0
    v_exp_f32 v48, v48
    v_exp_f32 v49, v49
    v_exp_f32 v50, v50
    v_exp_f32 v51, v51
    v_mfma_f32_32x32x16_bf16 v[64:79], v[212:215], v[28:31], v[64:79]
    v_exp_f32 v52, v52
    v_exp_f32 v53, v53
    v_exp_f32 v54, v54
    v_exp_f32 v55, v55
    v_cvt_pk_bf16_f32 v80, v48, v49
    v_cvt_pk_bf16_f32 v81, v50, v51
    v_mfma_f32_32x32x16_bf16 v[144:159], v[200:203], v[88:91], v[144:159]
    v_exp_f32 v56, v56
    v_exp_f32 v57, v57
    v_exp_f32 v58, v58
    v_exp_f32 v59, v59
    v_cvt_pk_bf16_f32 v82, v52, v53
    v_cvt_pk_bf16_f32 v83, v54, v55
    v_mfma_f32_32x32x16_bf16 v[144:159], v[204:207], v[92:95], v[144:159]
    s_add_u32 s49, s48, 12288
    buffer_load_dwordx4 v[248:251], v0, s[8:11], s49 offen offset:0
    v_exp_f32 v60, v60
    v_exp_f32 v61, v61
    v_exp_f32 v62, v62
    v_exp_f32 v63, v63
    v_cvt_pk_bf16_f32 v84, v56, v57
    v_cvt_pk_bf16_f32 v85, v58, v59
    v_cvt_pk_bf16_f32 v86, v60, v61
    v_cvt_pk_bf16_f32 v87, v62, v63
    v_mfma_f32_32x32x16_bf16 v[48:63], v[208:211], v[32:35], 0
    v_exp_f32 v64, v64
    v_exp_f32 v65, v65
    v_exp_f32 v66, v66
    v_exp_f32 v67, v67
    v_mfma_f32_32x32x16_bf16 v[48:63], v[212:215], v[36:39], v[48:63]
    v_exp_f32 v68, v68
    v_exp_f32 v69, v69
    v_exp_f32 v70, v70
    v_exp_f32 v71, v71
    v_cvt_pk_bf16_f32 v88, v64, v65
    v_cvt_pk_bf16_f32 v89, v66, v67
    s_waitcnt vmcnt(22)
    v_mfma_f32_32x32x16_bf16 v[96:111], v[216:219], v[80:83], v[96:111]
    s_mov_b32 s27, 24576
    buffer_load_dwordx4 v[200:203], v0, s[20:23], s27 offen offset:2048
    buffer_load_dwordx4 v[204:207], v0, s[20:23], s27 offen offset:3072
    v_exp_f32 v72, v72
    v_exp_f32 v73, v73
    v_exp_f32 v74, v74
    v_exp_f32 v75, v75
    v_cvt_pk_bf16_f32 v90, v68, v69
    v_cvt_pk_bf16_f32 v91, v70, v71
    v_mfma_f32_32x32x16_bf16 v[96:111], v[220:223], v[84:87], v[96:111]
    buffer_load_dwordx4 v[252:255], v0, s[8:11], s49 offen offset:1024
    v_exp_f32 v76, v76
    v_exp_f32 v77, v77
    v_exp_f32 v78, v78
    v_exp_f32 v79, v79
    v_cvt_pk_bf16_f32 v92, v72, v73
    v_cvt_pk_bf16_f32 v93, v74, v75
    v_cvt_pk_bf16_f32 v94, v76, v77
    v_cvt_pk_bf16_f32 v95, v78, v79
    v_mfma_f32_32x32x16_bf16 v[64:79], v[208:211], v[40:43], 0
    v_exp_f32 v48, v48
    v_exp_f32 v49, v49
    v_exp_f32 v50, v50
    v_exp_f32 v51, v51
    v_mfma_f32_32x32x16_bf16 v[64:79], v[212:215], v[44:47], v[64:79]
    v_exp_f32 v52, v52
    v_exp_f32 v53, v53
    v_exp_f32 v54, v54
    v_exp_f32 v55, v55
    v_cvt_pk_bf16_f32 v80, v48, v49
    v_cvt_pk_bf16_f32 v81, v50, v51
    v_mfma_f32_32x32x16_bf16 v[112:127], v[216:219], v[88:91], v[112:127]
    v_exp_f32 v56, v56
    v_exp_f32 v57, v57
    v_exp_f32 v58, v58
    v_exp_f32 v59, v59
    v_cvt_pk_bf16_f32 v82, v52, v53
    v_cvt_pk_bf16_f32 v83, v54, v55
    v_mfma_f32_32x32x16_bf16 v[112:127], v[220:223], v[92:95], v[112:127]
    buffer_load_dwordx4 v[224:227], v0, s[8:11], s50 offen offset:0 sc1
    v_exp_f32 v60, v60
    v_exp_f32 v61, v61
    v_exp_f32 v62, v62
    v_exp_f32 v63, v63
    v_cvt_pk_bf16_f32 v84, v56, v57
    v_cvt_pk_bf16_f32 v85, v58, v59
    v_cvt_pk_bf16_f32 v86, v60, v61
    v_cvt_pk_bf16_f32 v87, v62, v63
    s_waitcnt vmcnt(22)
    v_mfma_f32_32x32x16_bf16 v[48:63], v[160:163], v[16:19], 0
    v_exp_f32 v64, v64
    v_exp_f32 v65, v65
    v_exp_f32 v66, v66
    v_exp_f32 v67, v67
    v_mfma_f32_32x32x16_bf16 v[48:63], v[164:167], v[20:23], v[48:63]
    s_mov_b32 s26, 28672
    buffer_load_dwordx4 v[208:211], v0, s[20:23], s26 offen offset:0
    buffer_load_dwordx4 v[212:215], v0, s[20:23], s26 offen offset:1024
    v_exp_f32 v68, v68
    v_exp_f32 v69, v69
    v_exp_f32 v70, v70
    v_exp_f32 v71, v71
    v_cvt_pk_bf16_f32 v88, v64, v65
    v_cvt_pk_bf16_f32 v89, v66, v67
    v_mfma_f32_32x32x16_bf16 v[128:143], v[216:219], v[80:83], v[128:143]
    v_exp_f32 v72, v72
    v_exp_f32 v73, v73
    v_exp_f32 v74, v74
    v_exp_f32 v75, v75
    v_cvt_pk_bf16_f32 v90, v68, v69
    v_cvt_pk_bf16_f32 v91, v70, v71
    v_mfma_f32_32x32x16_bf16 v[128:143], v[220:223], v[84:87], v[128:143]
    buffer_load_dwordx4 v[228:231], v0, s[8:11], s50 offen offset:1024 sc1
    v_exp_f32 v76, v76
    v_exp_f32 v77, v77
    v_exp_f32 v78, v78
    v_exp_f32 v79, v79
    v_cvt_pk_bf16_f32 v92, v72, v73
    v_cvt_pk_bf16_f32 v93, v74, v75
    v_cvt_pk_bf16_f32 v94, v76, v77
    v_cvt_pk_bf16_f32 v95, v78, v79
    v_mfma_f32_32x32x16_bf16 v[64:79], v[160:163], v[24:27], 0
    v_exp_f32 v48, v48
    v_exp_f32 v49, v49
    v_exp_f32 v50, v50
    v_exp_f32 v51, v51
    v_mfma_f32_32x32x16_bf16 v[64:79], v[164:167], v[28:31], v[64:79]
    v_exp_f32 v52, v52
    v_exp_f32 v53, v53
    v_exp_f32 v54, v54
    v_exp_f32 v55, v55
    v_cvt_pk_bf16_f32 v80, v48, v49
    v_cvt_pk_bf16_f32 v81, v50, v51
    v_mfma_f32_32x32x16_bf16 v[144:159], v[216:219], v[88:91], v[144:159]
    v_exp_f32 v56, v56
    v_exp_f32 v57, v57
    v_exp_f32 v58, v58
    v_exp_f32 v59, v59
    v_cvt_pk_bf16_f32 v82, v52, v53
    v_cvt_pk_bf16_f32 v83, v54, v55
    v_mfma_f32_32x32x16_bf16 v[144:159], v[220:223], v[92:95], v[144:159]
    v_exp_f32 v60, v60
    v_exp_f32 v61, v61
    v_exp_f32 v62, v62
    v_exp_f32 v63, v63
    v_cvt_pk_bf16_f32 v84, v56, v57
    v_cvt_pk_bf16_f32 v85, v58, v59
    v_cvt_pk_bf16_f32 v86, v60, v61
    v_cvt_pk_bf16_f32 v87, v62, v63
    v_mfma_f32_32x32x16_bf16 v[48:63], v[160:163], v[32:35], 0
    v_exp_f32 v64, v64
    v_exp_f32 v65, v65
    v_exp_f32 v66, v66
    v_exp_f32 v67, v67
    v_mfma_f32_32x32x16_bf16 v[48:63], v[164:167], v[36:39], v[48:63]
    v_exp_f32 v68, v68
    v_exp_f32 v69, v69
    v_exp_f32 v70, v70
    v_exp_f32 v71, v71
    v_cvt_pk_bf16_f32 v88, v64, v65
    v_cvt_pk_bf16_f32 v89, v66, v67
    s_waitcnt vmcnt(21)
    v_mfma_f32_32x32x16_bf16 v[96:111], v[168:171], v[80:83], v[96:111]
    s_mov_b32 s27, 28672
    buffer_load_dwordx4 v[216:219], v0, s[20:23], s27 offen offset:2048
    buffer_load_dwordx4 v[220:223], v0, s[20:23], s27 offen offset:3072
    v_exp_f32 v72, v72
    v_exp_f32 v73, v73
    v_exp_f32 v74, v74
    v_exp_f32 v75, v75
    v_cvt_pk_bf16_f32 v90, v68, v69
    v_cvt_pk_bf16_f32 v91, v70, v71
    v_mfma_f32_32x32x16_bf16 v[96:111], v[172:175], v[84:87], v[96:111]
    v_exp_f32 v76, v76
    v_exp_f32 v77, v77
    v_exp_f32 v78, v78
    v_exp_f32 v79, v79
    v_cvt_pk_bf16_f32 v92, v72, v73
    v_cvt_pk_bf16_f32 v93, v74, v75
    v_cvt_pk_bf16_f32 v94, v76, v77
    v_cvt_pk_bf16_f32 v95, v78, v79
    v_mfma_f32_32x32x16_bf16 v[64:79], v[160:163], v[40:43], 0
    v_exp_f32 v48, v48
    v_exp_f32 v49, v49
    v_exp_f32 v50, v50
    v_exp_f32 v51, v51
    v_mfma_f32_32x32x16_bf16 v[64:79], v[164:167], v[44:47], v[64:79]
    v_exp_f32 v52, v52
    v_exp_f32 v53, v53
    v_exp_f32 v54, v54
    v_exp_f32 v55, v55
    v_cvt_pk_bf16_f32 v80, v48, v49
    v_cvt_pk_bf16_f32 v81, v50, v51
    v_mfma_f32_32x32x16_bf16 v[112:127], v[168:171], v[88:91], v[112:127]
    v_exp_f32 v56, v56
    v_exp_f32 v57, v57
    v_exp_f32 v58, v58
    v_exp_f32 v59, v59
    v_cvt_pk_bf16_f32 v82, v52, v53
    v_cvt_pk_bf16_f32 v83, v54, v55
    v_mfma_f32_32x32x16_bf16 v[112:127], v[172:175], v[92:95], v[112:127]
    v_exp_f32 v60, v60
    v_exp_f32 v61, v61
    v_exp_f32 v62, v62
    v_exp_f32 v63, v63
    v_cvt_pk_bf16_f32 v84, v56, v57
    v_cvt_pk_bf16_f32 v85, v58, v59
    v_cvt_pk_bf16_f32 v86, v60, v61
    v_cvt_pk_bf16_f32 v87, v62, v63
    s_waitcnt vmcnt(19)
    v_mfma_f32_32x32x16_bf16 v[48:63], v[176:179], v[16:19], 0
    v_exp_f32 v64, v64
    v_exp_f32 v65, v65
    v_exp_f32 v66, v66
    v_exp_f32 v67, v67
    v_mfma_f32_32x32x16_bf16 v[48:63], v[180:183], v[20:23], v[48:63]
    s_mov_b32 s26, 32768
    buffer_load_dwordx4 v[160:163], v0, s[20:23], s26 offen offset:0
    buffer_load_dwordx4 v[164:167], v0, s[20:23], s26 offen offset:1024
    v_exp_f32 v68, v68
    v_exp_f32 v69, v69
    v_exp_f32 v70, v70
    v_exp_f32 v71, v71
    v_cvt_pk_bf16_f32 v88, v64, v65
    v_cvt_pk_bf16_f32 v89, v66, v67
    v_mfma_f32_32x32x16_bf16 v[128:143], v[168:171], v[80:83], v[128:143]
    v_exp_f32 v72, v72
    v_exp_f32 v73, v73
    v_exp_f32 v74, v74
    v_exp_f32 v75, v75
    v_cvt_pk_bf16_f32 v90, v68, v69
    v_cvt_pk_bf16_f32 v91, v70, v71
    v_mfma_f32_32x32x16_bf16 v[128:143], v[172:175], v[84:87], v[128:143]
    v_exp_f32 v76, v76
    v_exp_f32 v77, v77
    v_exp_f32 v78, v78
    v_exp_f32 v79, v79
    v_cvt_pk_bf16_f32 v92, v72, v73
    v_cvt_pk_bf16_f32 v93, v74, v75
    v_cvt_pk_bf16_f32 v94, v76, v77
    v_cvt_pk_bf16_f32 v95, v78, v79
    v_mfma_f32_32x32x16_bf16 v[64:79], v[176:179], v[24:27], 0
    v_exp_f32 v48, v48
    v_exp_f32 v49, v49
    v_exp_f32 v50, v50
    v_exp_f32 v51, v51
    v_mfma_f32_32x32x16_bf16 v[64:79], v[180:183], v[28:31], v[64:79]
    v_exp_f32 v52, v52
    v_exp_f32 v53, v53
    v_exp_f32 v54, v54
    v_exp_f32 v55, v55
    v_cvt_pk_bf16_f32 v80, v48, v49
    v_cvt_pk_bf16_f32 v81, v50, v51
    v_mfma_f32_32x32x16_bf16 v[144:159], v[168:171], v[88:91], v[144:159]
    v_exp_f32 v56, v56
    v_exp_f32 v57, v57
    v_exp_f32 v58, v58
    v_exp_f32 v59, v59
    v_cvt_pk_bf16_f32 v82, v52, v53
    v_cvt_pk_bf16_f32 v83, v54, v55
    v_mfma_f32_32x32x16_bf16 v[144:159], v[172:175], v[92:95], v[144:159]
    v_exp_f32 v60, v60
    v_exp_f32 v61, v61
    v_exp_f32 v62, v62
    v_exp_f32 v63, v63
    v_cvt_pk_bf16_f32 v84, v56, v57
    v_cvt_pk_bf16_f32 v85, v58, v59
    v_cvt_pk_bf16_f32 v86, v60, v61
    v_cvt_pk_bf16_f32 v87, v62, v63
    v_mfma_f32_32x32x16_bf16 v[48:63], v[176:179], v[32:35], 0
    v_exp_f32 v64, v64
    v_exp_f32 v65, v65
    v_exp_f32 v66, v66
    v_exp_f32 v67, v67
    v_mfma_f32_32x32x16_bf16 v[48:63], v[180:183], v[36:39], v[48:63]
    v_exp_f32 v68, v68
    v_exp_f32 v69, v69
    v_exp_f32 v70, v70
    v_exp_f32 v71, v71
    v_cvt_pk_bf16_f32 v88, v64, v65
    v_cvt_pk_bf16_f32 v89, v66, v67
    s_waitcnt vmcnt(17)
    v_mfma_f32_32x32x16_bf16 v[96:111], v[184:187], v[80:83], v[96:111]
    s_mov_b32 s27, 32768
    buffer_load_dwordx4 v[168:171], v0, s[20:23], s27 offen offset:2048
    buffer_load_dwordx4 v[172:175], v0, s[20:23], s27 offen offset:3072
    v_exp_f32 v72, v72
    v_exp_f32 v73, v73
    v_exp_f32 v74, v74
    v_exp_f32 v75, v75
    v_cvt_pk_bf16_f32 v90, v68, v69
    v_cvt_pk_bf16_f32 v91, v70, v71
    v_mfma_f32_32x32x16_bf16 v[96:111], v[188:191], v[84:87], v[96:111]
    v_exp_f32 v76, v76
    v_exp_f32 v77, v77
    v_exp_f32 v78, v78
    v_exp_f32 v79, v79
    v_cvt_pk_bf16_f32 v92, v72, v73
    v_cvt_pk_bf16_f32 v93, v74, v75
    v_cvt_pk_bf16_f32 v94, v76, v77
    v_cvt_pk_bf16_f32 v95, v78, v79
    v_mfma_f32_32x32x16_bf16 v[64:79], v[176:179], v[40:43], 0
    v_exp_f32 v48, v48
    v_exp_f32 v49, v49
    v_exp_f32 v50, v50
    v_exp_f32 v51, v51
    v_mfma_f32_32x32x16_bf16 v[64:79], v[180:183], v[44:47], v[64:79]
    v_exp_f32 v52, v52
    v_exp_f32 v53, v53
    v_exp_f32 v54, v54
    v_exp_f32 v55, v55
    v_cvt_pk_bf16_f32 v80, v48, v49
    v_cvt_pk_bf16_f32 v81, v50, v51
    v_mfma_f32_32x32x16_bf16 v[112:127], v[184:187], v[88:91], v[112:127]
    v_exp_f32 v56, v56
    v_exp_f32 v57, v57
    v_exp_f32 v58, v58
    v_exp_f32 v59, v59
    v_cvt_pk_bf16_f32 v82, v52, v53
    v_cvt_pk_bf16_f32 v83, v54, v55
    v_mfma_f32_32x32x16_bf16 v[112:127], v[188:191], v[92:95], v[112:127]
    v_exp_f32 v60, v60
    v_exp_f32 v61, v61
    v_exp_f32 v62, v62
    v_exp_f32 v63, v63
    v_cvt_pk_bf16_f32 v84, v56, v57
    v_cvt_pk_bf16_f32 v85, v58, v59
    v_cvt_pk_bf16_f32 v86, v60, v61
    v_cvt_pk_bf16_f32 v87, v62, v63
    s_waitcnt vmcnt(15)
    v_mfma_f32_32x32x16_bf16 v[48:63], v[192:195], v[16:19], 0
    v_exp_f32 v64, v64
    v_exp_f32 v65, v65
    v_exp_f32 v66, v66
    v_exp_f32 v67, v67
    v_mfma_f32_32x32x16_bf16 v[48:63], v[196:199], v[20:23], v[48:63]
    s_mov_b32 s26, 36864
    buffer_load_dwordx4 v[176:179], v0, s[20:23], s26 offen offset:0
    buffer_load_dwordx4 v[180:183], v0, s[20:23], s26 offen offset:1024
    v_exp_f32 v68, v68
    v_exp_f32 v69, v69
    v_exp_f32 v70, v70
    v_exp_f32 v71, v71
    v_cvt_pk_bf16_f32 v88, v64, v65
    v_cvt_pk_bf16_f32 v89, v66, v67
    v_mfma_f32_32x32x16_bf16 v[128:143], v[184:187], v[80:83], v[128:143]
    v_exp_f32 v72, v72
    v_exp_f32 v73, v73
    v_exp_f32 v74, v74
    v_exp_f32 v75, v75
    v_cvt_pk_bf16_f32 v90, v68, v69
    v_cvt_pk_bf16_f32 v91, v70, v71
    v_mfma_f32_32x32x16_bf16 v[128:143], v[188:191], v[84:87], v[128:143]
    v_exp_f32 v76, v76
    v_exp_f32 v77, v77
    v_exp_f32 v78, v78
    v_exp_f32 v79, v79
    v_cvt_pk_bf16_f32 v92, v72, v73
    v_cvt_pk_bf16_f32 v93, v74, v75
    v_cvt_pk_bf16_f32 v94, v76, v77
    v_cvt_pk_bf16_f32 v95, v78, v79
    v_mfma_f32_32x32x16_bf16 v[64:79], v[192:195], v[24:27], 0
    v_exp_f32 v48, v48
    v_exp_f32 v49, v49
    v_exp_f32 v50, v50
    v_exp_f32 v51, v51
    v_mfma_f32_32x32x16_bf16 v[64:79], v[196:199], v[28:31], v[64:79]
    v_exp_f32 v52, v52
    v_exp_f32 v53, v53
    v_exp_f32 v54, v54
    v_exp_f32 v55, v55
    v_cvt_pk_bf16_f32 v80, v48, v49
    v_cvt_pk_bf16_f32 v81, v50, v51
    v_mfma_f32_32x32x16_bf16 v[144:159], v[184:187], v[88:91], v[144:159]
    v_exp_f32 v56, v56
    v_exp_f32 v57, v57
    v_exp_f32 v58, v58
    v_exp_f32 v59, v59
    v_cvt_pk_bf16_f32 v82, v52, v53
    v_cvt_pk_bf16_f32 v83, v54, v55
    v_mfma_f32_32x32x16_bf16 v[144:159], v[188:191], v[92:95], v[144:159]
    v_exp_f32 v60, v60
    v_exp_f32 v61, v61
    v_exp_f32 v62, v62
    v_exp_f32 v63, v63
    v_cvt_pk_bf16_f32 v84, v56, v57
    v_cvt_pk_bf16_f32 v85, v58, v59
    v_cvt_pk_bf16_f32 v86, v60, v61
    v_cvt_pk_bf16_f32 v87, v62, v63
    v_mfma_f32_32x32x16_bf16 v[48:63], v[192:195], v[32:35], 0
    v_exp_f32 v64, v64
    v_exp_f32 v65, v65
    v_exp_f32 v66, v66
    v_exp_f32 v67, v67
    v_mfma_f32_32x32x16_bf16 v[48:63], v[196:199], v[36:39], v[48:63]
    v_exp_f32 v68, v68
    v_exp_f32 v69, v69
    v_exp_f32 v70, v70
    v_exp_f32 v71, v71
    v_cvt_pk_bf16_f32 v88, v64, v65
    v_cvt_pk_bf16_f32 v89, v66, v67
    s_waitcnt vmcnt(13)
    v_mfma_f32_32x32x16_bf16 v[96:111], v[200:203], v[80:83], v[96:111]
    s_mov_b32 s27, 36864
    buffer_load_dwordx4 v[184:187], v0, s[20:23], s27 offen offset:2048
    buffer_load_dwordx4 v[188:191], v0, s[20:23], s27 offen offset:3072
    v_exp_f32 v72, v72
    v_exp_f32 v73, v73
    v_exp_f32 v74, v74
    v_exp_f32 v75, v75
    v_cvt_pk_bf16_f32 v90, v68, v69
    v_cvt_pk_bf16_f32 v91, v70, v71
    v_mfma_f32_32x32x16_bf16 v[96:111], v[204:207], v[84:87], v[96:111]
    v_exp_f32 v76, v76
    v_exp_f32 v77, v77
    v_exp_f32 v78, v78
    v_exp_f32 v79, v79
    v_cvt_pk_bf16_f32 v92, v72, v73
    v_cvt_pk_bf16_f32 v93, v74, v75
    v_cvt_pk_bf16_f32 v94, v76, v77
    v_cvt_pk_bf16_f32 v95, v78, v79
    v_mfma_f32_32x32x16_bf16 v[64:79], v[192:195], v[40:43], 0
    v_exp_f32 v48, v48
    v_exp_f32 v49, v49
    v_exp_f32 v50, v50
    v_exp_f32 v51, v51
    v_mfma_f32_32x32x16_bf16 v[64:79], v[196:199], v[44:47], v[64:79]
    v_exp_f32 v52, v52
    v_exp_f32 v53, v53
    v_exp_f32 v54, v54
    v_exp_f32 v55, v55
    v_cvt_pk_bf16_f32 v80, v48, v49
    v_cvt_pk_bf16_f32 v81, v50, v51
    v_mfma_f32_32x32x16_bf16 v[112:127], v[200:203], v[88:91], v[112:127]
    v_exp_f32 v56, v56
    v_exp_f32 v57, v57
    v_exp_f32 v58, v58
    v_exp_f32 v59, v59
    v_cvt_pk_bf16_f32 v82, v52, v53
    v_cvt_pk_bf16_f32 v83, v54, v55
    v_mfma_f32_32x32x16_bf16 v[112:127], v[204:207], v[92:95], v[112:127]
    v_exp_f32 v60, v60
    v_exp_f32 v61, v61
    v_exp_f32 v62, v62
    v_exp_f32 v63, v63
    v_cvt_pk_bf16_f32 v84, v56, v57
    v_cvt_pk_bf16_f32 v85, v58, v59
    v_cvt_pk_bf16_f32 v86, v60, v61
    v_cvt_pk_bf16_f32 v87, v62, v63
    s_waitcnt vmcnt(11)
    v_mfma_f32_32x32x16_bf16 v[48:63], v[208:211], v[16:19], 0
    v_exp_f32 v64, v64
    v_exp_f32 v65, v65
    v_exp_f32 v66, v66
    v_exp_f32 v67, v67
    v_mfma_f32_32x32x16_bf16 v[48:63], v[212:215], v[20:23], v[48:63]
    s_mov_b32 s26, 40960
    buffer_load_dwordx4 v[192:195], v0, s[20:23], s26 offen offset:0
    buffer_load_dwordx4 v[196:199], v0, s[20:23], s26 offen offset:1024
    v_exp_f32 v68, v68
    v_exp_f32 v69, v69
    v_exp_f32 v70, v70
    v_exp_f32 v71, v71
    v_cvt_pk_bf16_f32 v88, v64, v65
    v_cvt_pk_bf16_f32 v89, v66, v67
    v_mfma_f32_32x32x16_bf16 v[128:143], v[200:203], v[80:83], v[128:143]
    v_exp_f32 v72, v72
    v_exp_f32 v73, v73
    v_exp_f32 v74, v74
    v_exp_f32 v75, v75
    v_cvt_pk_bf16_f32 v90, v68, v69
    v_cvt_pk_bf16_f32 v91, v70, v71
    v_mfma_f32_32x32x16_bf16 v[128:143], v[204:207], v[84:87], v[128:143]
    v_exp_f32 v76, v76
    v_exp_f32 v77, v77
    v_exp_f32 v78, v78
    v_exp_f32 v79, v79
    v_cvt_pk_bf16_f32 v92, v72, v73
    v_cvt_pk_bf16_f32 v93, v74, v75
    v_cvt_pk_bf16_f32 v94, v76, v77
    v_cvt_pk_bf16_f32 v95, v78, v79
    v_mfma_f32_32x32x16_bf16 v[64:79], v[208:211], v[24:27], 0
    v_exp_f32 v48, v48
    v_exp_f32 v49, v49
    v_exp_f32 v50, v50
    v_exp_f32 v51, v51
    v_mfma_f32_32x32x16_bf16 v[64:79], v[212:215], v[28:31], v[64:79]
    v_exp_f32 v52, v52
    v_exp_f32 v53, v53
    v_exp_f32 v54, v54
    v_exp_f32 v55, v55
    v_cvt_pk_bf16_f32 v80, v48, v49
    v_cvt_pk_bf16_f32 v81, v50, v51
    v_mfma_f32_32x32x16_bf16 v[144:159], v[200:203], v[88:91], v[144:159]
    v_exp_f32 v56, v56
    v_exp_f32 v57, v57
    v_exp_f32 v58, v58
    v_exp_f32 v59, v59
    v_cvt_pk_bf16_f32 v82, v52, v53
    v_cvt_pk_bf16_f32 v83, v54, v55
    v_mfma_f32_32x32x16_bf16 v[144:159], v[204:207], v[92:95], v[144:159]
    v_exp_f32 v60, v60
    v_exp_f32 v61, v61
    v_exp_f32 v62, v62
    v_exp_f32 v63, v63
    v_cvt_pk_bf16_f32 v84, v56, v57
    v_cvt_pk_bf16_f32 v85, v58, v59
    v_cvt_pk_bf16_f32 v86, v60, v61
    v_cvt_pk_bf16_f32 v87, v62, v63
    v_mfma_f32_32x32x16_bf16 v[48:63], v[208:211], v[32:35], 0
    v_exp_f32 v64, v64
    v_exp_f32 v65, v65
    v_exp_f32 v66, v66
    v_exp_f32 v67, v67
    v_mfma_f32_32x32x16_bf16 v[48:63], v[212:215], v[36:39], v[48:63]
    v_exp_f32 v68, v68
    v_exp_f32 v69, v69
    v_exp_f32 v70, v70
    v_exp_f32 v71, v71
    v_cvt_pk_bf16_f32 v88, v64, v65
    v_cvt_pk_bf16_f32 v89, v66, v67
    s_waitcnt vmcnt(10)
    v_mfma_f32_32x32x16_bf16 v[96:111], v[216:219], v[80:83], v[96:111]
    s_mov_b32 s27, 40960
    buffer_load_dwordx4 v[200:203], v0, s[20:23], s27 offen offset:2048
    buffer_load_dwordx4 v[204:207], v0, s[20:23], s27 offen offset:3072
    v_exp_f32 v72, v72
    v_exp_f32 v73, v73
    v_exp_f32 v74, v74
    v_exp_f32 v75, v75
    v_cvt_pk_bf16_f32 v90, v68, v69
    v_cvt_pk_bf16_f32 v91, v70, v71
    v_mfma_f32_32x32x16_bf16 v[96:111], v[220:223], v[84:87], v[96:111]
    v_exp_f32 v76, v76
    v_exp_f32 v77, v77
    v_exp_f32 v78, v78
    v_exp_f32 v79, v79
    v_cvt_pk_bf16_f32 v92, v72, v73
    v_cvt_pk_bf16_f32 v93, v74, v75
    v_cvt_pk_bf16_f32 v94, v76, v77
    v_cvt_pk_bf16_f32 v95, v78, v79
    v_mfma_f32_32x32x16_bf16 v[64:79], v[208:211], v[40:43], 0
    v_exp_f32 v48, v48
    v_exp_f32 v49, v49
    v_exp_f32 v50, v50
    v_exp_f32 v51, v51
    v_mfma_f32_32x32x16_bf16 v[64:79], v[212:215], v[44:47], v[64:79]
    v_exp_f32 v52, v52
    v_exp_f32 v53, v53
    v_exp_f32 v54, v54
    v_exp_f32 v55, v55
    v_cvt_pk_bf16_f32 v80, v48, v49
    v_cvt_pk_bf16_f32 v81, v50, v51
    v_mfma_f32_32x32x16_bf16 v[112:127], v[216:219], v[88:91], v[112:127]
    v_exp_f32 v56, v56
    v_exp_f32 v57, v57
    v_exp_f32 v58, v58
    v_exp_f32 v59, v59
    v_cvt_pk_bf16_f32 v82, v52, v53
    v_cvt_pk_bf16_f32 v83, v54, v55
    v_mfma_f32_32x32x16_bf16 v[112:127], v[220:223], v[92:95], v[112:127]
    v_exp_f32 v60, v60
    v_exp_f32 v61, v61
    v_exp_f32 v62, v62
    v_exp_f32 v63, v63
    v_cvt_pk_bf16_f32 v84, v56, v57
    v_cvt_pk_bf16_f32 v85, v58, v59
    v_cvt_pk_bf16_f32 v86, v60, v61
    v_cvt_pk_bf16_f32 v87, v62, v63
    s_waitcnt vmcnt(10)
    v_mfma_f32_32x32x16_bf16 v[48:63], v[160:163], v[16:19], 0
    v_exp_f32 v64, v64
    v_exp_f32 v65, v65
    v_exp_f32 v66, v66
    v_exp_f32 v67, v67
    v_mfma_f32_32x32x16_bf16 v[48:63], v[164:167], v[20:23], v[48:63]
    s_mov_b32 s26, 45056
    buffer_load_dwordx4 v[208:211], v0, s[20:23], s26 offen offset:0
    buffer_load_dwordx4 v[212:215], v0, s[20:23], s26 offen offset:1024
    v_exp_f32 v68, v68
    v_exp_f32 v69, v69
    v_exp_f32 v70, v70
    v_exp_f32 v71, v71
    v_cvt_pk_bf16_f32 v88, v64, v65
    v_cvt_pk_bf16_f32 v89, v66, v67
    v_mfma_f32_32x32x16_bf16 v[128:143], v[216:219], v[80:83], v[128:143]
    v_exp_f32 v72, v72
    v_exp_f32 v73, v73
    v_exp_f32 v74, v74
    v_exp_f32 v75, v75
    v_cvt_pk_bf16_f32 v90, v68, v69
    v_cvt_pk_bf16_f32 v91, v70, v71
    v_mfma_f32_32x32x16_bf16 v[128:143], v[220:223], v[84:87], v[128:143]
    v_exp_f32 v76, v76
    v_exp_f32 v77, v77
    v_exp_f32 v78, v78
    v_exp_f32 v79, v79
    v_cvt_pk_bf16_f32 v92, v72, v73
    v_cvt_pk_bf16_f32 v93, v74, v75
    v_cvt_pk_bf16_f32 v94, v76, v77
    v_cvt_pk_bf16_f32 v95, v78, v79
    v_mfma_f32_32x32x16_bf16 v[64:79], v[160:163], v[24:27], 0
    v_exp_f32 v48, v48
    v_exp_f32 v49, v49
    v_exp_f32 v50, v50
    v_exp_f32 v51, v51
    v_mfma_f32_32x32x16_bf16 v[64:79], v[164:167], v[28:31], v[64:79]
    v_exp_f32 v52, v52
    v_exp_f32 v53, v53
    v_exp_f32 v54, v54
    v_exp_f32 v55, v55
    v_cvt_pk_bf16_f32 v80, v48, v49
    v_cvt_pk_bf16_f32 v81, v50, v51
    v_mfma_f32_32x32x16_bf16 v[144:159], v[216:219], v[88:91], v[144:159]
    v_exp_f32 v56, v56
    v_exp_f32 v57, v57
    v_exp_f32 v58, v58
    v_exp_f32 v59, v59
    v_cvt_pk_bf16_f32 v82, v52, v53
    v_cvt_pk_bf16_f32 v83, v54, v55
    v_mfma_f32_32x32x16_bf16 v[144:159], v[220:223], v[92:95], v[144:159]
    v_exp_f32 v60, v60
    v_exp_f32 v61, v61
    v_exp_f32 v62, v62
    v_exp_f32 v63, v63
    v_cvt_pk_bf16_f32 v84, v56, v57
    v_cvt_pk_bf16_f32 v85, v58, v59
    v_cvt_pk_bf16_f32 v86, v60, v61
    v_cvt_pk_bf16_f32 v87, v62, v63
    v_mfma_f32_32x32x16_bf16 v[48:63], v[160:163], v[32:35], 0
    v_exp_f32 v64, v64
    v_exp_f32 v65, v65
    v_exp_f32 v66, v66
    v_exp_f32 v67, v67
    v_mfma_f32_32x32x16_bf16 v[48:63], v[164:167], v[36:39], v[48:63]
    v_exp_f32 v68, v68
    v_exp_f32 v69, v69
    v_exp_f32 v70, v70
    v_exp_f32 v71, v71
    v_cvt_pk_bf16_f32 v88, v64, v65
    v_cvt_pk_bf16_f32 v89, v66, v67
    s_waitcnt vmcnt(10)
    v_mfma_f32_32x32x16_bf16 v[96:111], v[168:171], v[80:83], v[96:111]
    s_mov_b32 s27, 45056
    buffer_load_dwordx4 v[216:219], v0, s[20:23], s27 offen offset:2048
    buffer_load_dwordx4 v[220:223], v0, s[20:23], s27 offen offset:3072
    v_exp_f32 v72, v72
    v_exp_f32 v73, v73
    v_exp_f32 v74, v74
    v_exp_f32 v75, v75
    v_cvt_pk_bf16_f32 v90, v68, v69
    v_cvt_pk_bf16_f32 v91, v70, v71
    v_mfma_f32_32x32x16_bf16 v[96:111], v[172:175], v[84:87], v[96:111]
    v_exp_f32 v76, v76
    v_exp_f32 v77, v77
    v_exp_f32 v78, v78
    v_exp_f32 v79, v79
    v_cvt_pk_bf16_f32 v92, v72, v73
    v_cvt_pk_bf16_f32 v93, v74, v75
    v_cvt_pk_bf16_f32 v94, v76, v77
    v_cvt_pk_bf16_f32 v95, v78, v79
    v_mfma_f32_32x32x16_bf16 v[64:79], v[160:163], v[40:43], 0
    v_exp_f32 v48, v48
    v_exp_f32 v49, v49
    v_exp_f32 v50, v50
    v_exp_f32 v51, v51
    v_mfma_f32_32x32x16_bf16 v[64:79], v[164:167], v[44:47], v[64:79]
    v_exp_f32 v52, v52
    v_exp_f32 v53, v53
    v_exp_f32 v54, v54
    v_exp_f32 v55, v55
    v_cvt_pk_bf16_f32 v80, v48, v49
    v_cvt_pk_bf16_f32 v81, v50, v51
    v_mfma_f32_32x32x16_bf16 v[112:127], v[168:171], v[88:91], v[112:127]
    v_exp_f32 v56, v56
    v_exp_f32 v57, v57
    v_exp_f32 v58, v58
    v_exp_f32 v59, v59
    v_cvt_pk_bf16_f32 v82, v52, v53
    v_cvt_pk_bf16_f32 v83, v54, v55
    v_mfma_f32_32x32x16_bf16 v[112:127], v[172:175], v[92:95], v[112:127]
    v_exp_f32 v60, v60
    v_exp_f32 v61, v61
    v_exp_f32 v62, v62
    v_exp_f32 v63, v63
    v_cvt_pk_bf16_f32 v84, v56, v57
    v_cvt_pk_bf16_f32 v85, v58, v59
    v_cvt_pk_bf16_f32 v86, v60, v61
    v_cvt_pk_bf16_f32 v87, v62, v63
    s_waitcnt vmcnt(10)
    v_mfma_f32_32x32x16_bf16 v[48:63], v[176:179], v[16:19], 0
    v_exp_f32 v64, v64
    v_exp_f32 v65, v65
    v_exp_f32 v66, v66
    v_exp_f32 v67, v67
    v_mfma_f32_32x32x16_bf16 v[48:63], v[180:183], v[20:23], v[48:63]
    s_mov_b32 s26, 49152
    buffer_load_dwordx4 v[160:163], v0, s[20:23], s26 offen offset:0
    buffer_load_dwordx4 v[164:167], v0, s[20:23], s26 offen offset:1024
    v_exp_f32 v68, v68
    v_exp_f32 v69, v69
    v_exp_f32 v70, v70
    v_exp_f32 v71, v71
    v_cvt_pk_bf16_f32 v88, v64, v65
    v_cvt_pk_bf16_f32 v89, v66, v67
    v_mfma_f32_32x32x16_bf16 v[128:143], v[168:171], v[80:83], v[128:143]
    v_exp_f32 v72, v72
    v_exp_f32 v73, v73
    v_exp_f32 v74, v74
    v_exp_f32 v75, v75
    v_cvt_pk_bf16_f32 v90, v68, v69
    v_cvt_pk_bf16_f32 v91, v70, v71
    v_mfma_f32_32x32x16_bf16 v[128:143], v[172:175], v[84:87], v[128:143]
    v_exp_f32 v76, v76
    v_exp_f32 v77, v77
    v_exp_f32 v78, v78
    v_exp_f32 v79, v79
    v_cvt_pk_bf16_f32 v92, v72, v73
    v_cvt_pk_bf16_f32 v93, v74, v75
    v_cvt_pk_bf16_f32 v94, v76, v77
    v_cvt_pk_bf16_f32 v95, v78, v79
    v_mfma_f32_32x32x16_bf16 v[64:79], v[176:179], v[24:27], 0
    v_exp_f32 v48, v48
    v_exp_f32 v49, v49
    v_exp_f32 v50, v50
    v_exp_f32 v51, v51
    v_mfma_f32_32x32x16_bf16 v[64:79], v[180:183], v[28:31], v[64:79]
    v_exp_f32 v52, v52
    v_exp_f32 v53, v53
    v_exp_f32 v54, v54
    v_exp_f32 v55, v55
    v_cvt_pk_bf16_f32 v80, v48, v49
    v_cvt_pk_bf16_f32 v81, v50, v51
    v_mfma_f32_32x32x16_bf16 v[144:159], v[168:171], v[88:91], v[144:159]
    v_exp_f32 v56, v56
    v_exp_f32 v57, v57
    v_exp_f32 v58, v58
    v_exp_f32 v59, v59
    v_cvt_pk_bf16_f32 v82, v52, v53
    v_cvt_pk_bf16_f32 v83, v54, v55
    v_mfma_f32_32x32x16_bf16 v[144:159], v[172:175], v[92:95], v[144:159]
    v_exp_f32 v60, v60
    v_exp_f32 v61, v61
    v_exp_f32 v62, v62
    v_exp_f32 v63, v63
    v_cvt_pk_bf16_f32 v84, v56, v57
    v_cvt_pk_bf16_f32 v85, v58, v59
    v_cvt_pk_bf16_f32 v86, v60, v61
    v_cvt_pk_bf16_f32 v87, v62, v63
    v_mfma_f32_32x32x16_bf16 v[48:63], v[176:179], v[32:35], 0
    v_exp_f32 v64, v64
    v_exp_f32 v65, v65
    v_exp_f32 v66, v66
    v_exp_f32 v67, v67
    v_mfma_f32_32x32x16_bf16 v[48:63], v[180:183], v[36:39], v[48:63]
    v_exp_f32 v68, v68
    v_exp_f32 v69, v69
    v_exp_f32 v70, v70
    v_exp_f32 v71, v71
    v_cvt_pk_bf16_f32 v88, v64, v65
    v_cvt_pk_bf16_f32 v89, v66, v67
    s_waitcnt vmcnt(10)
    v_mfma_f32_32x32x16_bf16 v[96:111], v[184:187], v[80:83], v[96:111]
    s_mov_b32 s27, 49152
    buffer_load_dwordx4 v[168:171], v0, s[20:23], s27 offen offset:2048
    buffer_load_dwordx4 v[172:175], v0, s[20:23], s27 offen offset:3072
    v_exp_f32 v72, v72
    v_exp_f32 v73, v73
    v_exp_f32 v74, v74
    v_exp_f32 v75, v75
    v_cvt_pk_bf16_f32 v90, v68, v69
    v_cvt_pk_bf16_f32 v91, v70, v71
    v_mfma_f32_32x32x16_bf16 v[96:111], v[188:191], v[84:87], v[96:111]
    v_exp_f32 v76, v76
    v_exp_f32 v77, v77
    v_exp_f32 v78, v78
    v_exp_f32 v79, v79
    v_cvt_pk_bf16_f32 v92, v72, v73
    v_cvt_pk_bf16_f32 v93, v74, v75
    v_cvt_pk_bf16_f32 v94, v76, v77
    v_cvt_pk_bf16_f32 v95, v78, v79
    v_mfma_f32_32x32x16_bf16 v[64:79], v[176:179], v[40:43], 0
    v_exp_f32 v48, v48
    v_exp_f32 v49, v49
    v_exp_f32 v50, v50
    v_exp_f32 v51, v51
    v_mfma_f32_32x32x16_bf16 v[64:79], v[180:183], v[44:47], v[64:79]
    v_exp_f32 v52, v52
    v_exp_f32 v53, v53
    v_exp_f32 v54, v54
    v_exp_f32 v55, v55
    v_cvt_pk_bf16_f32 v80, v48, v49
    v_cvt_pk_bf16_f32 v81, v50, v51
    v_mfma_f32_32x32x16_bf16 v[112:127], v[184:187], v[88:91], v[112:127]
    v_exp_f32 v56, v56
    v_exp_f32 v57, v57
    v_exp_f32 v58, v58
    v_exp_f32 v59, v59
    v_cvt_pk_bf16_f32 v82, v52, v53
    v_cvt_pk_bf16_f32 v83, v54, v55
    v_mfma_f32_32x32x16_bf16 v[112:127], v[188:191], v[92:95], v[112:127]
    v_exp_f32 v60, v60
    v_exp_f32 v61, v61
    v_exp_f32 v62, v62
    v_exp_f32 v63, v63
    v_cvt_pk_bf16_f32 v84, v56, v57
    v_cvt_pk_bf16_f32 v85, v58, v59
    v_cvt_pk_bf16_f32 v86, v60, v61
    v_cvt_pk_bf16_f32 v87, v62, v63
    s_waitcnt vmcnt(10)
    v_mfma_f32_32x32x16_bf16 v[48:63], v[192:195], v[16:19], 0
    v_exp_f32 v64, v64
    v_exp_f32 v65, v65
    v_exp_f32 v66, v66
    v_exp_f32 v67, v67
    v_mfma_f32_32x32x16_bf16 v[48:63], v[196:199], v[20:23], v[48:63]
    s_mov_b32 s26, 53248
    buffer_load_dwordx4 v[176:179], v0, s[20:23], s26 offen offset:0
    buffer_load_dwordx4 v[180:183], v0, s[20:23], s26 offen offset:1024
    v_exp_f32 v68, v68
    v_exp_f32 v69, v69
    v_exp_f32 v70, v70
    v_exp_f32 v71, v71
    v_cvt_pk_bf16_f32 v88, v64, v65
    v_cvt_pk_bf16_f32 v89, v66, v67
    v_mfma_f32_32x32x16_bf16 v[128:143], v[184:187], v[80:83], v[128:143]
    v_exp_f32 v72, v72
    v_exp_f32 v73, v73
    v_exp_f32 v74, v74
    v_exp_f32 v75, v75
    v_cvt_pk_bf16_f32 v90, v68, v69
    v_cvt_pk_bf16_f32 v91, v70, v71
    v_mfma_f32_32x32x16_bf16 v[128:143], v[188:191], v[84:87], v[128:143]
    v_exp_f32 v76, v76
    v_exp_f32 v77, v77
    v_exp_f32 v78, v78
    v_exp_f32 v79, v79
    v_cvt_pk_bf16_f32 v92, v72, v73
    v_cvt_pk_bf16_f32 v93, v74, v75
    v_cvt_pk_bf16_f32 v94, v76, v77
    v_cvt_pk_bf16_f32 v95, v78, v79
    v_mfma_f32_32x32x16_bf16 v[64:79], v[192:195], v[24:27], 0
    v_exp_f32 v48, v48
    v_exp_f32 v49, v49
    v_exp_f32 v50, v50
    v_exp_f32 v51, v51
    v_mfma_f32_32x32x16_bf16 v[64:79], v[196:199], v[28:31], v[64:79]
    v_exp_f32 v52, v52
    v_exp_f32 v53, v53
    v_exp_f32 v54, v54
    v_exp_f32 v55, v55
    v_cvt_pk_bf16_f32 v80, v48, v49
    v_cvt_pk_bf16_f32 v81, v50, v51
    v_mfma_f32_32x32x16_bf16 v[144:159], v[184:187], v[88:91], v[144:159]
    v_exp_f32 v56, v56
    v_exp_f32 v57, v57
    v_exp_f32 v58, v58
    v_exp_f32 v59, v59
    v_cvt_pk_bf16_f32 v82, v52, v53
    v_cvt_pk_bf16_f32 v83, v54, v55
    v_mfma_f32_32x32x16_bf16 v[144:159], v[188:191], v[92:95], v[144:159]
    v_exp_f32 v60, v60
    v_exp_f32 v61, v61
    v_exp_f32 v62, v62
    v_exp_f32 v63, v63
    v_cvt_pk_bf16_f32 v84, v56, v57
    v_cvt_pk_bf16_f32 v85, v58, v59
    v_cvt_pk_bf16_f32 v86, v60, v61
    v_cvt_pk_bf16_f32 v87, v62, v63
    v_mfma_f32_32x32x16_bf16 v[48:63], v[192:195], v[32:35], 0
    v_exp_f32 v64, v64
    v_exp_f32 v65, v65
    v_exp_f32 v66, v66
    v_exp_f32 v67, v67
    v_mfma_f32_32x32x16_bf16 v[48:63], v[196:199], v[36:39], v[48:63]
    v_exp_f32 v68, v68
    v_exp_f32 v69, v69
    v_exp_f32 v70, v70
    v_exp_f32 v71, v71
    v_cvt_pk_bf16_f32 v88, v64, v65
    v_cvt_pk_bf16_f32 v89, v66, v67
    s_waitcnt vmcnt(10)
    v_mfma_f32_32x32x16_bf16 v[96:111], v[200:203], v[80:83], v[96:111]
    s_mov_b32 s27, 53248
    buffer_load_dwordx4 v[184:187], v0, s[20:23], s27 offen offset:2048
    buffer_load_dwordx4 v[188:191], v0, s[20:23], s27 offen offset:3072
    v_exp_f32 v72, v72
    v_exp_f32 v73, v73
    v_exp_f32 v74, v74
    v_exp_f32 v75, v75
    v_cvt_pk_bf16_f32 v90, v68, v69
    v_cvt_pk_bf16_f32 v91, v70, v71
    v_mfma_f32_32x32x16_bf16 v[96:111], v[204:207], v[84:87], v[96:111]
    v_exp_f32 v76, v76
    v_exp_f32 v77, v77
    v_exp_f32 v78, v78
    v_exp_f32 v79, v79
    v_cvt_pk_bf16_f32 v92, v72, v73
    v_cvt_pk_bf16_f32 v93, v74, v75
    v_cvt_pk_bf16_f32 v94, v76, v77
    v_cvt_pk_bf16_f32 v95, v78, v79
    v_mfma_f32_32x32x16_bf16 v[64:79], v[192:195], v[40:43], 0
    v_exp_f32 v48, v48
    v_exp_f32 v49, v49
    v_exp_f32 v50, v50
    v_exp_f32 v51, v51
    v_mfma_f32_32x32x16_bf16 v[64:79], v[196:199], v[44:47], v[64:79]
    v_exp_f32 v52, v52
    v_exp_f32 v53, v53
    v_exp_f32 v54, v54
    v_exp_f32 v55, v55
    v_cvt_pk_bf16_f32 v80, v48, v49
    v_cvt_pk_bf16_f32 v81, v50, v51
    v_mfma_f32_32x32x16_bf16 v[112:127], v[200:203], v[88:91], v[112:127]
    v_exp_f32 v56, v56
    v_exp_f32 v57, v57
    v_exp_f32 v58, v58
    v_exp_f32 v59, v59
    v_cvt_pk_bf16_f32 v82, v52, v53
    v_cvt_pk_bf16_f32 v83, v54, v55
    v_mfma_f32_32x32x16_bf16 v[112:127], v[204:207], v[92:95], v[112:127]
    v_exp_f32 v60, v60
    v_exp_f32 v61, v61
    v_exp_f32 v62, v62
    v_exp_f32 v63, v63
    v_cvt_pk_bf16_f32 v84, v56, v57
    v_cvt_pk_bf16_f32 v85, v58, v59
    v_cvt_pk_bf16_f32 v86, v60, v61
    v_cvt_pk_bf16_f32 v87, v62, v63
    s_waitcnt vmcnt(10)
    v_mfma_f32_32x32x16_bf16 v[48:63], v[208:211], v[16:19], 0
    v_exp_f32 v64, v64
    v_exp_f32 v65, v65
    v_exp_f32 v66, v66
    v_exp_f32 v67, v67
    v_mfma_f32_32x32x16_bf16 v[48:63], v[212:215], v[20:23], v[48:63]
    s_mov_b32 s26, 57344
    buffer_load_dwordx4 v[192:195], v0, s[20:23], s26 offen offset:0
    buffer_load_dwordx4 v[196:199], v0, s[20:23], s26 offen offset:1024
    v_exp_f32 v68, v68
    v_exp_f32 v69, v69
    v_exp_f32 v70, v70
    v_exp_f32 v71, v71
    v_cvt_pk_bf16_f32 v88, v64, v65
    v_cvt_pk_bf16_f32 v89, v66, v67
    v_mfma_f32_32x32x16_bf16 v[128:143], v[200:203], v[80:83], v[128:143]
    v_exp_f32 v72, v72
    v_exp_f32 v73, v73
    v_exp_f32 v74, v74
    v_exp_f32 v75, v75
    v_cvt_pk_bf16_f32 v90, v68, v69
    v_cvt_pk_bf16_f32 v91, v70, v71
    v_mfma_f32_32x32x16_bf16 v[128:143], v[204:207], v[84:87], v[128:143]
    v_exp_f32 v76, v76
    v_exp_f32 v77, v77
    v_exp_f32 v78, v78
    v_exp_f32 v79, v79
    v_cvt_pk_bf16_f32 v92, v72, v73
    v_cvt_pk_bf16_f32 v93, v74, v75
    v_cvt_pk_bf16_f32 v94, v76, v77
    v_cvt_pk_bf16_f32 v95, v78, v79
    v_mfma_f32_32x32x16_bf16 v[64:79], v[208:211], v[24:27], 0
    v_exp_f32 v48, v48
    v_exp_f32 v49, v49
    v_exp_f32 v50, v50
    v_exp_f32 v51, v51
    v_mfma_f32_32x32x16_bf16 v[64:79], v[212:215], v[28:31], v[64:79]
    v_exp_f32 v52, v52
    v_exp_f32 v53, v53
    v_exp_f32 v54, v54
    v_exp_f32 v55, v55
    v_cvt_pk_bf16_f32 v80, v48, v49
    v_cvt_pk_bf16_f32 v81, v50, v51
    v_mfma_f32_32x32x16_bf16 v[144:159], v[200:203], v[88:91], v[144:159]
    v_exp_f32 v56, v56
    v_exp_f32 v57, v57
    v_exp_f32 v58, v58
    v_exp_f32 v59, v59
    v_cvt_pk_bf16_f32 v82, v52, v53
    v_cvt_pk_bf16_f32 v83, v54, v55
    v_mfma_f32_32x32x16_bf16 v[144:159], v[204:207], v[92:95], v[144:159]
    v_exp_f32 v60, v60
    v_exp_f32 v61, v61
    v_exp_f32 v62, v62
    v_exp_f32 v63, v63
    v_cvt_pk_bf16_f32 v84, v56, v57
    v_cvt_pk_bf16_f32 v85, v58, v59
    v_cvt_pk_bf16_f32 v86, v60, v61
    v_cvt_pk_bf16_f32 v87, v62, v63
    v_mfma_f32_32x32x16_bf16 v[48:63], v[208:211], v[32:35], 0
    v_exp_f32 v64, v64
    v_exp_f32 v65, v65
    v_exp_f32 v66, v66
    v_exp_f32 v67, v67
    v_mfma_f32_32x32x16_bf16 v[48:63], v[212:215], v[36:39], v[48:63]
    v_exp_f32 v68, v68
    v_exp_f32 v69, v69
    v_exp_f32 v70, v70
    v_exp_f32 v71, v71
    v_cvt_pk_bf16_f32 v88, v64, v65
    v_cvt_pk_bf16_f32 v89, v66, v67
    s_waitcnt vmcnt(10)
    v_mfma_f32_32x32x16_bf16 v[96:111], v[216:219], v[80:83], v[96:111]
    s_mov_b32 s27, 57344
    buffer_load_dwordx4 v[200:203], v0, s[20:23], s27 offen offset:2048
    buffer_load_dwordx4 v[204:207], v0, s[20:23], s27 offen offset:3072
    v_exp_f32 v72, v72
    v_exp_f32 v73, v73
    v_exp_f32 v74, v74
    v_exp_f32 v75, v75
    v_cvt_pk_bf16_f32 v90, v68, v69
    v_cvt_pk_bf16_f32 v91, v70, v71
    v_mfma_f32_32x32x16_bf16 v[96:111], v[220:223], v[84:87], v[96:111]
    v_exp_f32 v76, v76
    v_exp_f32 v77, v77
    v_exp_f32 v78, v78
    v_exp_f32 v79, v79
    v_cvt_pk_bf16_f32 v92, v72, v73
    v_cvt_pk_bf16_f32 v93, v74, v75
    v_cvt_pk_bf16_f32 v94, v76, v77
    v_cvt_pk_bf16_f32 v95, v78, v79
    v_mfma_f32_32x32x16_bf16 v[64:79], v[208:211], v[40:43], 0
    v_exp_f32 v48, v48
    v_exp_f32 v49, v49
    v_exp_f32 v50, v50
    v_exp_f32 v51, v51
    v_mfma_f32_32x32x16_bf16 v[64:79], v[212:215], v[44:47], v[64:79]
    v_exp_f32 v52, v52
    v_exp_f32 v53, v53
    v_exp_f32 v54, v54
    v_exp_f32 v55, v55
    v_cvt_pk_bf16_f32 v80, v48, v49
    v_cvt_pk_bf16_f32 v81, v50, v51
    v_mfma_f32_32x32x16_bf16 v[112:127], v[216:219], v[88:91], v[112:127]
    v_exp_f32 v56, v56
    v_exp_f32 v57, v57
    v_exp_f32 v58, v58
    v_exp_f32 v59, v59
    v_cvt_pk_bf16_f32 v82, v52, v53
    v_cvt_pk_bf16_f32 v83, v54, v55
    v_mfma_f32_32x32x16_bf16 v[112:127], v[220:223], v[92:95], v[112:127]
    v_exp_f32 v60, v60
    v_exp_f32 v61, v61
    v_exp_f32 v62, v62
    v_exp_f32 v63, v63
    v_cvt_pk_bf16_f32 v84, v56, v57
    v_cvt_pk_bf16_f32 v85, v58, v59
    v_cvt_pk_bf16_f32 v86, v60, v61
    v_cvt_pk_bf16_f32 v87, v62, v63
    s_waitcnt vmcnt(10)
    v_mfma_f32_32x32x16_bf16 v[48:63], v[160:163], v[16:19], 0
    v_exp_f32 v64, v64
    v_exp_f32 v65, v65
    v_exp_f32 v66, v66
    v_exp_f32 v67, v67
    v_mfma_f32_32x32x16_bf16 v[48:63], v[164:167], v[20:23], v[48:63]
    s_mov_b32 s26, 61440
    buffer_load_dwordx4 v[208:211], v0, s[20:23], s26 offen offset:0
    buffer_load_dwordx4 v[212:215], v0, s[20:23], s26 offen offset:1024
    v_exp_f32 v68, v68
    v_exp_f32 v69, v69
    v_exp_f32 v70, v70
    v_exp_f32 v71, v71
    v_cvt_pk_bf16_f32 v88, v64, v65
    v_cvt_pk_bf16_f32 v89, v66, v67
    v_mfma_f32_32x32x16_bf16 v[128:143], v[216:219], v[80:83], v[128:143]
    v_exp_f32 v72, v72
    v_exp_f32 v73, v73
    v_exp_f32 v74, v74
    v_exp_f32 v75, v75
    v_cvt_pk_bf16_f32 v90, v68, v69
    v_cvt_pk_bf16_f32 v91, v70, v71
    v_mfma_f32_32x32x16_bf16 v[128:143], v[220:223], v[84:87], v[128:143]
    v_exp_f32 v76, v76
    v_exp_f32 v77, v77
    v_exp_f32 v78, v78
    v_exp_f32 v79, v79
    v_cvt_pk_bf16_f32 v92, v72, v73
    v_cvt_pk_bf16_f32 v93, v74, v75
    v_cvt_pk_bf16_f32 v94, v76, v77
    v_cvt_pk_bf16_f32 v95, v78, v79
    v_mfma_f32_32x32x16_bf16 v[64:79], v[160:163], v[24:27], 0
    v_exp_f32 v48, v48
    v_exp_f32 v49, v49
    v_exp_f32 v50, v50
    v_exp_f32 v51, v51
    v_mfma_f32_32x32x16_bf16 v[64:79], v[164:167], v[28:31], v[64:79]
    v_exp_f32 v52, v52
    v_exp_f32 v53, v53
    v_exp_f32 v54, v54
    v_exp_f32 v55, v55
    v_cvt_pk_bf16_f32 v80, v48, v49
    v_cvt_pk_bf16_f32 v81, v50, v51
    v_mfma_f32_32x32x16_bf16 v[144:159], v[216:219], v[88:91], v[144:159]
    v_exp_f32 v56, v56
    v_exp_f32 v57, v57
    v_exp_f32 v58, v58
    v_exp_f32 v59, v59
    v_cvt_pk_bf16_f32 v82, v52, v53
    v_cvt_pk_bf16_f32 v83, v54, v55
    v_mfma_f32_32x32x16_bf16 v[144:159], v[220:223], v[92:95], v[144:159]
    v_exp_f32 v60, v60
    v_exp_f32 v61, v61
    v_exp_f32 v62, v62
    v_exp_f32 v63, v63
    v_cvt_pk_bf16_f32 v84, v56, v57
    v_cvt_pk_bf16_f32 v85, v58, v59
    v_cvt_pk_bf16_f32 v86, v60, v61
    v_cvt_pk_bf16_f32 v87, v62, v63
    v_mfma_f32_32x32x16_bf16 v[48:63], v[160:163], v[32:35], 0
    v_exp_f32 v64, v64
    v_exp_f32 v65, v65
    v_exp_f32 v66, v66
    v_exp_f32 v67, v67
    v_mfma_f32_32x32x16_bf16 v[48:63], v[164:167], v[36:39], v[48:63]
    v_exp_f32 v68, v68
    v_exp_f32 v69, v69
    v_exp_f32 v70, v70
    v_exp_f32 v71, v71
    v_cvt_pk_bf16_f32 v88, v64, v65
    v_cvt_pk_bf16_f32 v89, v66, v67
    s_waitcnt vmcnt(10)
    v_mfma_f32_32x32x16_bf16 v[96:111], v[168:171], v[80:83], v[96:111]
    s_mov_b32 s27, 61440
    buffer_load_dwordx4 v[216:219], v0, s[20:23], s27 offen offset:2048
    buffer_load_dwordx4 v[220:223], v0, s[20:23], s27 offen offset:3072
    v_exp_f32 v72, v72
    v_exp_f32 v73, v73
    v_exp_f32 v74, v74
    v_exp_f32 v75, v75
    v_cvt_pk_bf16_f32 v90, v68, v69
    v_cvt_pk_bf16_f32 v91, v70, v71
    v_mfma_f32_32x32x16_bf16 v[96:111], v[172:175], v[84:87], v[96:111]
    v_exp_f32 v76, v76
    v_exp_f32 v77, v77
    v_exp_f32 v78, v78
    v_exp_f32 v79, v79
    v_cvt_pk_bf16_f32 v92, v72, v73
    v_cvt_pk_bf16_f32 v93, v74, v75
    v_cvt_pk_bf16_f32 v94, v76, v77
    v_cvt_pk_bf16_f32 v95, v78, v79
    v_mfma_f32_32x32x16_bf16 v[64:79], v[160:163], v[40:43], 0
    v_exp_f32 v48, v48
    v_exp_f32 v49, v49
    v_exp_f32 v50, v50
    v_exp_f32 v51, v51
    v_mfma_f32_32x32x16_bf16 v[64:79], v[164:167], v[44:47], v[64:79]
    v_exp_f32 v52, v52
    v_exp_f32 v53, v53
    v_exp_f32 v54, v54
    v_exp_f32 v55, v55
    v_cvt_pk_bf16_f32 v80, v48, v49
    v_cvt_pk_bf16_f32 v81, v50, v51
    v_mfma_f32_32x32x16_bf16 v[112:127], v[168:171], v[88:91], v[112:127]
    v_exp_f32 v56, v56
    v_exp_f32 v57, v57
    v_exp_f32 v58, v58
    v_exp_f32 v59, v59
    v_cvt_pk_bf16_f32 v82, v52, v53
    v_cvt_pk_bf16_f32 v83, v54, v55
    v_mfma_f32_32x32x16_bf16 v[112:127], v[172:175], v[92:95], v[112:127]
    v_exp_f32 v60, v60
    v_exp_f32 v61, v61
    v_exp_f32 v62, v62
    v_exp_f32 v63, v63
    v_cvt_pk_bf16_f32 v84, v56, v57
    v_cvt_pk_bf16_f32 v85, v58, v59
    v_cvt_pk_bf16_f32 v86, v60, v61
    v_cvt_pk_bf16_f32 v87, v62, v63
    s_waitcnt vmcnt(10)
    v_mfma_f32_32x32x16_bf16 v[48:63], v[176:179], v[16:19], 0
    v_exp_f32 v64, v64
    v_exp_f32 v65, v65
    v_exp_f32 v66, v66
    v_exp_f32 v67, v67
    v_mfma_f32_32x32x16_bf16 v[48:63], v[180:183], v[20:23], v[48:63]
    s_add_u32 s49, s48, 12288
    buffer_load_dwordx4 v[160:163], v0, s[8:11], s49 offen offset:2048
    v_exp_f32 v68, v68
    v_exp_f32 v69, v69
    v_exp_f32 v70, v70
    v_exp_f32 v71, v71
    v_cvt_pk_bf16_f32 v88, v64, v65
    v_cvt_pk_bf16_f32 v89, v66, v67
    v_mfma_f32_32x32x16_bf16 v[128:143], v[168:171], v[80:83], v[128:143]
    buffer_load_dwordx4 v[164:167], v0, s[8:11], s49 offen offset:3072
    v_exp_f32 v72, v72
    v_exp_f32 v73, v73
    v_exp_f32 v74, v74
    v_exp_f32 v75, v75
    v_cvt_pk_bf16_f32 v90, v68, v69
    v_cvt_pk_bf16_f32 v91, v70, v71
    v_mfma_f32_32x32x16_bf16 v[128:143], v[172:175], v[84:87], v[128:143]
    v_exp_f32 v76, v76
    v_exp_f32 v77, v77
    v_exp_f32 v78, v78
    v_exp_f32 v79, v79
    v_cvt_pk_bf16_f32 v92, v72, v73
    v_cvt_pk_bf16_f32 v93, v74, v75
    v_cvt_pk_bf16_f32 v94, v76, v77
    v_cvt_pk_bf16_f32 v95, v78, v79
    v_mfma_f32_32x32x16_bf16 v[64:79], v[176:179], v[24:27], 0
    v_exp_f32 v48, v48
    v_exp_f32 v49, v49
    v_exp_f32 v50, v50
    v_exp_f32 v51, v51
    v_mfma_f32_32x32x16_bf16 v[64:79], v[180:183], v[28:31], v[64:79]
    v_exp_f32 v52, v52
    v_exp_f32 v53, v53
    v_exp_f32 v54, v54
    v_exp_f32 v55, v55
    v_cvt_pk_bf16_f32 v80, v48, v49
    v_cvt_pk_bf16_f32 v81, v50, v51
    v_mfma_f32_32x32x16_bf16 v[144:159], v[168:171], v[88:91], v[144:159]
    v_exp_f32 v56, v56
    v_exp_f32 v57, v57
    v_exp_f32 v58, v58
    v_exp_f32 v59, v59
    v_cvt_pk_bf16_f32 v82, v52, v53
    v_cvt_pk_bf16_f32 v83, v54, v55
    v_mfma_f32_32x32x16_bf16 v[144:159], v[172:175], v[92:95], v[144:159]
    v_exp_f32 v60, v60
    v_exp_f32 v61, v61
    v_exp_f32 v62, v62
    v_exp_f32 v63, v63
    v_cvt_pk_bf16_f32 v84, v56, v57
    v_cvt_pk_bf16_f32 v85, v58, v59
    v_cvt_pk_bf16_f32 v86, v60, v61
    v_cvt_pk_bf16_f32 v87, v62, v63
    v_mfma_f32_32x32x16_bf16 v[48:63], v[176:179], v[32:35], 0
    v_exp_f32 v64, v64
    v_exp_f32 v65, v65
    v_exp_f32 v66, v66
    v_exp_f32 v67, v67
    v_mfma_f32_32x32x16_bf16 v[48:63], v[180:183], v[36:39], v[48:63]
    s_add_u32 s49, s48, 16384
    buffer_load_dwordx4 v[168:171], v0, s[8:11], s49 offen offset:0
    v_exp_f32 v68, v68
    v_exp_f32 v69, v69
    v_exp_f32 v70, v70
    v_exp_f32 v71, v71
    v_cvt_pk_bf16_f32 v88, v64, v65
    v_cvt_pk_bf16_f32 v89, v66, v67
    s_waitcnt vmcnt(11)
    v_mfma_f32_32x32x16_bf16 v[96:111], v[184:187], v[80:83], v[96:111]
    buffer_load_dwordx4 v[172:175], v0, s[8:11], s49 offen offset:1024
    v_exp_f32 v72, v72
    v_exp_f32 v73, v73
    v_exp_f32 v74, v74
    v_exp_f32 v75, v75
    v_cvt_pk_bf16_f32 v90, v68, v69
    v_cvt_pk_bf16_f32 v91, v70, v71
    v_mfma_f32_32x32x16_bf16 v[96:111], v[188:191], v[84:87], v[96:111]
    v_exp_f32 v76, v76
    v_exp_f32 v77, v77
    v_exp_f32 v78, v78
    v_exp_f32 v79, v79
    v_cvt_pk_bf16_f32 v92, v72, v73
    v_cvt_pk_bf16_f32 v93, v74, v75
    v_cvt_pk_bf16_f32 v94, v76, v77
    v_cvt_pk_bf16_f32 v95, v78, v79
    v_mfma_f32_32x32x16_bf16 v[64:79], v[176:179], v[40:43], 0
    v_exp_f32 v48, v48
    v_exp_f32 v49, v49
    v_exp_f32 v50, v50
    v_exp_f32 v51, v51
    v_mfma_f32_32x32x16_bf16 v[64:79], v[180:183], v[44:47], v[64:79]
    v_exp_f32 v52, v52
    v_exp_f32 v53, v53
    v_exp_f32 v54, v54
    v_exp_f32 v55, v55
    v_cvt_pk_bf16_f32 v80, v48, v49
    v_cvt_pk_bf16_f32 v81, v50, v51
    v_mfma_f32_32x32x16_bf16 v[112:127], v[184:187], v[88:91], v[112:127]
    v_exp_f32 v56, v56
    v_exp_f32 v57, v57
    v_exp_f32 v58, v58
    v_exp_f32 v59, v59
    v_cvt_pk_bf16_f32 v82, v52, v53
    v_cvt_pk_bf16_f32 v83, v54, v55
    v_mfma_f32_32x32x16_bf16 v[112:127], v[188:191], v[92:95], v[112:127]
    v_exp_f32 v60, v60
    v_exp_f32 v61, v61
    v_exp_f32 v62, v62
    v_exp_f32 v63, v63
    v_cvt_pk_bf16_f32 v84, v56, v57
    v_cvt_pk_bf16_f32 v85, v58, v59
    v_cvt_pk_bf16_f32 v86, v60, v61
    v_cvt_pk_bf16_f32 v87, v62, v63
    s_waitcnt vmcnt(10)
    v_mfma_f32_32x32x16_bf16 v[48:63], v[192:195], v[16:19], 0
    v_exp_f32 v64, v64
    v_exp_f32 v65, v65
    v_exp_f32 v66, v66
    v_exp_f32 v67, v67
    v_mfma_f32_32x32x16_bf16 v[48:63], v[196:199], v[20:23], v[48:63]
    buffer_load_dwordx4 v[176:179], v0, s[8:11], s49 offen offset:2048
    v_exp_f32 v68, v68
    v_exp_f32 v69, v69
    v_exp_f32 v70, v70
    v_exp_f32 v71, v71
    v_cvt_pk_bf16_f32 v88, v64, v65
    v_cvt_pk_bf16_f32 v89, v66, v67
    v_mfma_f32_32x32x16_bf16 v[128:143], v[184:187], v[80:83], v[128:143]
    buffer_load_dwordx4 v[180:183], v0, s[8:11], s49 offen offset:3072
    v_exp_f32 v72, v72
    v_exp_f32 v73, v73
    v_exp_f32 v74, v74
    v_exp_f32 v75, v75
    v_cvt_pk_bf16_f32 v90, v68, v69
    v_cvt_pk_bf16_f32 v91, v70, v71
    v_mfma_f32_32x32x16_bf16 v[128:143], v[188:191], v[84:87], v[128:143]
    v_exp_f32 v76, v76
    v_exp_f32 v77, v77
    v_exp_f32 v78, v78
    v_exp_f32 v79, v79
    v_cvt_pk_bf16_f32 v92, v72, v73
    v_cvt_pk_bf16_f32 v93, v74, v75
    v_cvt_pk_bf16_f32 v94, v76, v77
    v_cvt_pk_bf16_f32 v95, v78, v79
    v_mfma_f32_32x32x16_bf16 v[64:79], v[192:195], v[24:27], 0
    v_exp_f32 v48, v48
    v_exp_f32 v49, v49
    v_exp_f32 v50, v50
    v_exp_f32 v51, v51
    v_mfma_f32_32x32x16_bf16 v[64:79], v[196:199], v[28:31], v[64:79]
    v_exp_f32 v52, v52
    v_exp_f32 v53, v53
    v_exp_f32 v54, v54
    v_exp_f32 v55, v55
    v_cvt_pk_bf16_f32 v80, v48, v49
    v_cvt_pk_bf16_f32 v81, v50, v51
    v_mfma_f32_32x32x16_bf16 v[144:159], v[184:187], v[88:91], v[144:159]
    v_exp_f32 v56, v56
    v_exp_f32 v57, v57
    v_exp_f32 v58, v58
    v_exp_f32 v59, v59
    v_cvt_pk_bf16_f32 v82, v52, v53
    v_cvt_pk_bf16_f32 v83, v54, v55
    v_mfma_f32_32x32x16_bf16 v[144:159], v[188:191], v[92:95], v[144:159]
    v_exp_f32 v60, v60
    v_exp_f32 v61, v61
    v_exp_f32 v62, v62
    v_exp_f32 v63, v63
    v_cvt_pk_bf16_f32 v84, v56, v57
    v_cvt_pk_bf16_f32 v85, v58, v59
    v_cvt_pk_bf16_f32 v86, v60, v61
    v_cvt_pk_bf16_f32 v87, v62, v63
    v_mfma_f32_32x32x16_bf16 v[48:63], v[192:195], v[32:35], 0
    v_exp_f32 v64, v64
    v_exp_f32 v65, v65
    v_exp_f32 v66, v66
    v_exp_f32 v67, v67
    v_mfma_f32_32x32x16_bf16 v[48:63], v[196:199], v[36:39], v[48:63]
    s_add_u32 s49, s48, 20480
    buffer_load_dwordx4 v[184:187], v0, s[8:11], s49 offen offset:0
    v_exp_f32 v68, v68
    v_exp_f32 v69, v69
    v_exp_f32 v70, v70
    v_exp_f32 v71, v71
    v_cvt_pk_bf16_f32 v88, v64, v65
    v_cvt_pk_bf16_f32 v89, v66, v67
    s_waitcnt vmcnt(11)
    v_mfma_f32_32x32x16_bf16 v[96:111], v[200:203], v[80:83], v[96:111]
    buffer_load_dwordx4 v[188:191], v0, s[8:11], s49 offen offset:1024
    v_exp_f32 v72, v72
    v_exp_f32 v73, v73
    v_exp_f32 v74, v74
    v_exp_f32 v75, v75
    v_cvt_pk_bf16_f32 v90, v68, v69
    v_cvt_pk_bf16_f32 v91, v70, v71
    v_mfma_f32_32x32x16_bf16 v[96:111], v[204:207], v[84:87], v[96:111]
    v_exp_f32 v76, v76
    v_exp_f32 v77, v77
    v_exp_f32 v78, v78
    v_exp_f32 v79, v79
    v_cvt_pk_bf16_f32 v92, v72, v73
    v_cvt_pk_bf16_f32 v93, v74, v75
    v_cvt_pk_bf16_f32 v94, v76, v77
    v_cvt_pk_bf16_f32 v95, v78, v79
    v_mfma_f32_32x32x16_bf16 v[64:79], v[192:195], v[40:43], 0
    v_exp_f32 v48, v48
    v_exp_f32 v49, v49
    v_exp_f32 v50, v50
    v_exp_f32 v51, v51
    v_mfma_f32_32x32x16_bf16 v[64:79], v[196:199], v[44:47], v[64:79]
    v_exp_f32 v52, v52
    v_exp_f32 v53, v53
    v_exp_f32 v54, v54
    v_exp_f32 v55, v55
    v_cvt_pk_bf16_f32 v80, v48, v49
    v_cvt_pk_bf16_f32 v81, v50, v51
    v_mfma_f32_32x32x16_bf16 v[112:127], v[200:203], v[88:91], v[112:127]
    v_exp_f32 v56, v56
    v_exp_f32 v57, v57
    v_exp_f32 v58, v58
    v_exp_f32 v59, v59
    v_cvt_pk_bf16_f32 v82, v52, v53
    v_cvt_pk_bf16_f32 v83, v54, v55
    v_mfma_f32_32x32x16_bf16 v[112:127], v[204:207], v[92:95], v[112:127]
    v_exp_f32 v60, v60
    v_exp_f32 v61, v61
    v_exp_f32 v62, v62
    v_exp_f32 v63, v63
    v_cvt_pk_bf16_f32 v84, v56, v57
    v_cvt_pk_bf16_f32 v85, v58, v59
    v_cvt_pk_bf16_f32 v86, v60, v61
    v_cvt_pk_bf16_f32 v87, v62, v63
    s_waitcnt vmcnt(10)
    v_mfma_f32_32x32x16_bf16 v[48:63], v[208:211], v[16:19], 0
    v_exp_f32 v64, v64
    v_exp_f32 v65, v65
    v_exp_f32 v66, v66
    v_exp_f32 v67, v67
    v_mfma_f32_32x32x16_bf16 v[48:63], v[212:215], v[20:23], v[48:63]
    buffer_load_dwordx4 v[192:195], v0, s[8:11], s49 offen offset:2048
    v_exp_f32 v68, v68
    v_exp_f32 v69, v69
    v_exp_f32 v70, v70
    v_exp_f32 v71, v71
    v_cvt_pk_bf16_f32 v88, v64, v65
    v_cvt_pk_bf16_f32 v89, v66, v67
    v_mfma_f32_32x32x16_bf16 v[128:143], v[200:203], v[80:83], v[128:143]
    buffer_load_dwordx4 v[196:199], v0, s[8:11], s49 offen offset:3072
    v_exp_f32 v72, v72
    v_exp_f32 v73, v73
    v_exp_f32 v74, v74
    v_exp_f32 v75, v75
    v_cvt_pk_bf16_f32 v90, v68, v69
    v_cvt_pk_bf16_f32 v91, v70, v71
    v_mfma_f32_32x32x16_bf16 v[128:143], v[204:207], v[84:87], v[128:143]
    v_exp_f32 v76, v76
    v_exp_f32 v77, v77
    v_exp_f32 v78, v78
    v_exp_f32 v79, v79
    v_cvt_pk_bf16_f32 v92, v72, v73
    v_cvt_pk_bf16_f32 v93, v74, v75
    v_cvt_pk_bf16_f32 v94, v76, v77
    v_cvt_pk_bf16_f32 v95, v78, v79
    v_mfma_f32_32x32x16_bf16 v[64:79], v[208:211], v[24:27], 0
    v_exp_f32 v48, v48
    v_exp_f32 v49, v49
    v_exp_f32 v50, v50
    v_exp_f32 v51, v51
    v_mfma_f32_32x32x16_bf16 v[64:79], v[212:215], v[28:31], v[64:79]
    v_exp_f32 v52, v52
    v_exp_f32 v53, v53
    v_exp_f32 v54, v54
    v_exp_f32 v55, v55
    v_cvt_pk_bf16_f32 v80, v48, v49
    v_cvt_pk_bf16_f32 v81, v50, v51
    v_mfma_f32_32x32x16_bf16 v[144:159], v[200:203], v[88:91], v[144:159]
    v_exp_f32 v56, v56
    v_exp_f32 v57, v57
    v_exp_f32 v58, v58
    v_exp_f32 v59, v59
    v_cvt_pk_bf16_f32 v82, v52, v53
    v_cvt_pk_bf16_f32 v83, v54, v55
    v_mfma_f32_32x32x16_bf16 v[144:159], v[204:207], v[92:95], v[144:159]
    v_exp_f32 v60, v60
    v_exp_f32 v61, v61
    v_exp_f32 v62, v62
    v_exp_f32 v63, v63
    v_cvt_pk_bf16_f32 v84, v56, v57
    v_cvt_pk_bf16_f32 v85, v58, v59
    v_cvt_pk_bf16_f32 v86, v60, v61
    v_cvt_pk_bf16_f32 v87, v62, v63
    v_mfma_f32_32x32x16_bf16 v[48:63], v[208:211], v[32:35], 0
    v_exp_f32 v64, v64
    v_exp_f32 v65, v65
    v_exp_f32 v66, v66
    v_exp_f32 v67, v67
    v_mfma_f32_32x32x16_bf16 v[48:63], v[212:215], v[36:39], v[48:63]
    s_add_u32 s49, s48, 24576
    buffer_load_dwordx4 v[200:203], v0, s[8:11], s49 offen offset:0
    v_exp_f32 v68, v68
    v_exp_f32 v69, v69
    v_exp_f32 v70, v70
    v_exp_f32 v71, v71
    v_cvt_pk_bf16_f32 v88, v64, v65
    v_cvt_pk_bf16_f32 v89, v66, v67
    s_waitcnt vmcnt(11)
    v_mfma_f32_32x32x16_bf16 v[96:111], v[216:219], v[80:83], v[96:111]
    buffer_load_dwordx4 v[204:207], v0, s[8:11], s49 offen offset:1024
    v_exp_f32 v72, v72
    v_exp_f32 v73, v73
    v_exp_f32 v74, v74
    v_exp_f32 v75, v75
    v_cvt_pk_bf16_f32 v90, v68, v69
    v_cvt_pk_bf16_f32 v91, v70, v71
    v_mfma_f32_32x32x16_bf16 v[96:111], v[220:223], v[84:87], v[96:111]
    v_exp_f32 v76, v76
    v_exp_f32 v77, v77
    v_exp_f32 v78, v78
    v_exp_f32 v79, v79
    v_cvt_pk_bf16_f32 v92, v72, v73
    v_cvt_pk_bf16_f32 v93, v74, v75
    v_cvt_pk_bf16_f32 v94, v76, v77
    v_cvt_pk_bf16_f32 v95, v78, v79
    v_mfma_f32_32x32x16_bf16 v[64:79], v[208:211], v[40:43], 0
    v_exp_f32 v48, v48
    v_exp_f32 v49, v49
    v_exp_f32 v50, v50
    v_exp_f32 v51, v51
    v_mfma_f32_32x32x16_bf16 v[64:79], v[212:215], v[44:47], v[64:79]
    v_exp_f32 v52, v52
    v_exp_f32 v53, v53
    v_exp_f32 v54, v54
    v_exp_f32 v55, v55
    v_cvt_pk_bf16_f32 v80, v48, v49
    v_cvt_pk_bf16_f32 v81, v50, v51
    v_mfma_f32_32x32x16_bf16 v[112:127], v[216:219], v[88:91], v[112:127]
    v_exp_f32 v56, v56
    v_exp_f32 v57, v57
    v_exp_f32 v58, v58
    v_exp_f32 v59, v59
    v_cvt_pk_bf16_f32 v82, v52, v53
    v_cvt_pk_bf16_f32 v83, v54, v55
    v_mfma_f32_32x32x16_bf16 v[112:127], v[220:223], v[92:95], v[112:127]
    v_exp_f32 v60, v60
    v_exp_f32 v61, v61
    v_exp_f32 v62, v62
    v_exp_f32 v63, v63
    v_cvt_pk_bf16_f32 v84, v56, v57
    v_cvt_pk_bf16_f32 v85, v58, v59
    v_cvt_pk_bf16_f32 v86, v60, v61
    v_cvt_pk_bf16_f32 v87, v62, v63
    v_exp_f32 v64, v64
    v_exp_f32 v65, v65
    v_exp_f32 v66, v66
    v_exp_f32 v67, v67
    buffer_load_dwordx4 v[208:211], v0, s[8:11], s49 offen offset:2048
    v_exp_f32 v68, v68
    v_exp_f32 v69, v69
    v_exp_f32 v70, v70
    v_exp_f32 v71, v71
    v_cvt_pk_bf16_f32 v88, v64, v65
    v_cvt_pk_bf16_f32 v89, v66, v67
    v_mfma_f32_32x32x16_bf16 v[128:143], v[216:219], v[80:83], v[128:143]
    buffer_load_dwordx4 v[212:215], v0, s[8:11], s49 offen offset:3072
    v_exp_f32 v72, v72
    v_exp_f32 v73, v73
    v_exp_f32 v74, v74
    v_exp_f32 v75, v75
    v_cvt_pk_bf16_f32 v90, v68, v69
    v_cvt_pk_bf16_f32 v91, v70, v71
    v_mfma_f32_32x32x16_bf16 v[128:143], v[220:223], v[84:87], v[128:143]
    v_exp_f32 v76, v76
    v_exp_f32 v77, v77
    v_exp_f32 v78, v78
    v_exp_f32 v79, v79
    v_cvt_pk_bf16_f32 v92, v72, v73
    v_cvt_pk_bf16_f32 v93, v74, v75
    v_cvt_pk_bf16_f32 v94, v76, v77
    v_cvt_pk_bf16_f32 v95, v78, v79
    s_nop 0
    v_mfma_f32_32x32x16_bf16 v[144:159], v[216:219], v[88:91], v[144:159]
    v_mfma_f32_32x32x16_bf16 v[144:159], v[220:223], v[92:95], v[144:159]
Lfirst_7:
    s_add_u32 s30, s3, 1
    s_and_b32 s30, s30, 3
    s_mul_i32 s30, s30, 12288
    v_add_u32 v5, s30, v0
    s_add_u32 s30, s3, 2
    s_and_b32 s30, s30, 3
    s_mul_i32 s30, s30, 12288
    v_add_u32 v6, s30, v0
    s_add_u32 s30, s3, 3
    s_and_b32 s30, s30, 3
    s_mul_i32 s30, s30, 12288
    v_add_u32 v7, s30, v0
    s_add_u32 s30, s3, 0
    s_and_b32 s30, s30, 3
    s_mul_i32 s30, s30, 12288
    v_add_u32 v8, s30, v0
    s_add_u32 s49, s48, 28672
    buffer_load_dwordx4 v[216:219], v0, s[8:11], s49 offen offset:0
    buffer_load_dwordx4 v[220:223], v0, s[8:11], s49 offen offset:1024
    buffer_load_dwordx4 v[88:91], v0, s[8:11], s49 offen offset:2048
    buffer_load_dwordx4 v[92:95], v0, s[8:11], s49 offen offset:3072
    ds_write_b128 v5, v[112:115] offset:0
    ds_write_b128 v5, v[116:119] offset:1024
    ds_write_b128 v5, v[120:123] offset:2048
    ds_write_b128 v5, v[124:127] offset:3072
    ds_write_b128 v6, v[128:131] offset:4096
    ds_write_b128 v6, v[132:135] offset:5120
    ds_write_b128 v6, v[136:139] offset:6144
    ds_write_b128 v6, v[140:143] offset:7168
    s_nop 7
    ds_write_b128 v7, v[144:147] offset:8192
    ds_write_b128 v7, v[148:151] offset:9216
    ds_write_b128 v7, v[152:155] offset:10240
    ds_write_b128 v7, v[156:159] offset:11264
    s_waitcnt lgkmcnt(0)
    s_barrier
    ds_read_b128 v[112:115], v8 offset:0
    ds_read_b128 v[116:119], v8 offset:1024
    ds_read_b128 v[120:123], v8 offset:2048
    ds_read_b128 v[124:127], v8 offset:3072
    ds_read_b128 v[128:131], v8 offset:4096
    ds_read_b128 v[132:135], v8 offset:5120
    ds_read_b128 v[136:139], v8 offset:6144
    ds_read_b128 v[140:143], v8 offset:7168
    ds_read_b128 v[144:147], v8 offset:8192
    ds_read_b128 v[148:151], v8 offset:9216
    ds_read_b128 v[152:155], v8 offset:10240
    ds_read_b128 v[156:159], v8 offset:11264
    s_mul_i32 s24, s4, 114688
    s_lshl_b32 s25, s5, 13
    s_add_u32 s24, s24, s25
    s_lshl_b32 s25, s3, 11
    s_add_u32 s24, s24, s25
    s_add_u32 s24, s24, 7873536
    s_waitcnt lgkmcnt(8)
    v_pk_add_f32 v[108:109], v[108:109], v[124:125]
    v_pk_add_f32 v[110:111], v[110:111], v[126:127]
    v_pk_add_f32 v[96:97], v[96:97], v[112:113]
    v_pk_add_f32 v[98:99], v[98:99], v[114:115]
    v_pk_add_f32 v[100:101], v[100:101], v[116:117]
    v_pk_add_f32 v[102:103], v[102:103], v[118:119]
    v_pk_add_f32 v[104:105], v[104:105], v[120:121]
    v_pk_add_f32 v[106:107], v[106:107], v[122:123]
    s_waitcnt lgkmcnt(4)
    v_pk_add_f32 v[108:109], v[108:109], v[140:141]
    v_pk_add_f32 v[110:111], v[110:111], v[142:143]
    v_pk_add_f32 v[96:97], v[96:97], v[128:129]
    v_pk_add_f32 v[98:99], v[98:99], v[130:131]
    v_pk_add_f32 v[100:101], v[100:101], v[132:133]
    v_pk_add_f32 v[102:103], v[102:103], v[134:135]
    v_pk_add_f32 v[104:105], v[104:105], v[136:137]
    v_pk_add_f32 v[106:107], v[106:107], v[138:139]
    s_waitcnt lgkmcnt(0)
    v_pk_add_f32 v[108:109], v[108:109], v[156:157]
    v_pk_add_f32 v[110:111], v[110:111], v[158:159]
    v_pk_add_f32 v[96:97], v[96:97], v[144:145]
    v_pk_add_f32 v[98:99], v[98:99], v[146:147]
    v_pk_add_f32 v[100:101], v[100:101], v[148:149]
    v_pk_add_f32 v[102:103], v[102:103], v[150:151]
    v_pk_add_f32 v[104:105], v[104:105], v[152:153]
    v_pk_add_f32 v[106:107], v[106:107], v[154:155]
    v_mov_b32 v6, v108
    v_mov_b32 v5, v108
    v_mov_b32 v8, 0
    v_mov_b32 v9, 0x21800000
    v_permlane32_swap_b32 v6, v5
    v_mov_b32 v10, 0x5d800000
    s_nop 0
    v_rcp_f32 v7, v5
    v_cmp_nge_f32 vcc, v5, v9
    v_cmp_nle_f32 s[30:31], v5, v10
    v_mul_f32 v96, v96, v7
    v_fmac_f32 v8, 0, v96
    v_mul_f32 v97, v97, v7
    v_fmac_f32 v8, 0, v97
    v_mul_f32 v98, v98, v7
    v_fmac_f32 v8, 0, v98
    v_mul_f32 v99, v99, v7
    v_fmac_f32 v8, 0, v99
    v_mul_f32 v100, v100, v7
    v_fmac_f32 v8, 0, v100
    v_mul_f32 v101, v101, v7
    v_fmac_f32 v8, 0, v101
    v_mul_f32 v102, v102, v7
    v_fmac_f32 v8, 0, v102
    v_mul_f32 v103, v103, v7
    v_fmac_f32 v8, 0, v103
    v_mul_f32 v104, v104, v7
    v_fmac_f32 v8, 0, v104
    v_mul_f32 v105, v105, v7
    v_fmac_f32 v8, 0, v105
    v_mul_f32 v106, v106, v7
    v_fmac_f32 v8, 0, v106
    v_mul_f32 v107, v107, v7
    v_fmac_f32 v8, 0, v107
    v_mul_f32 v108, v108, v7
    v_fmac_f32 v8, 0, v108
    v_mul_f32 v109, v109, v7
    v_fmac_f32 v8, 0, v109
    v_mul_f32 v110, v110, v7
    v_fmac_f32 v8, 0, v110
    v_mul_f32 v111, v111, v7
    v_fmac_f32 v8, 0, v111
    s_or_b64 s[30:31], s[30:31], vcc
    v_cmp_u_f32 vcc, v8, v8
    v_cvt_pk_bf16_f32 v80, v96, v97
    v_cvt_pk_bf16_f32 v81, v98, v99
    v_cvt_pk_bf16_f32 v82, v100, v101
    v_cvt_pk_bf16_f32 v83, v102, v103
    v_cvt_pk_bf16_f32 v84, v104, v105
    v_cvt_pk_bf16_f32 v85, v106, v107
    v_cvt_pk_bf16_f32 v86, v108, v109
    v_cvt_pk_bf16_f32 v87, v110, v111
    s_or_b64 s[30:31], s[30:31], vcc
    s_mov_b32 exec_lo, 0
    v_mov_b32 v86, 0
    v_mov_b32 v87, 0
    s_mov_b32 exec_lo, -1
    buffer_store_dwordx4 v[80:83], v0, s[8:11], s24 offen offset:0
    buffer_store_dwordx4 v[84:87], v0, s[8:11], s24 offen offset:1024
    s_cmp_lg_u64 s[30:31], 0
    s_cselect_b32 s30, 1, 0
    s_andn2_b32 s30, s30, s29
    v_mov_b32 v7, s30
    s_lshl_b32 s30, s3, 2
    s_add_u32 s30, s30, 151552
    v_mov_b32 v8, s30
    ds_write_b32 v8, v7
    s_waitcnt lgkmcnt(0)
    s_barrier
    v_mov_b32 v8, 151552
    ds_read_b128 v[8:11], v8
    s_waitcnt lgkmcnt(0)
    v_or3_b32 v8, v8, v9, v10
    v_or_b32 v8, v8, v11
    s_nop 0
    v_readfirstlane_b32 s30, v8
    s_nop 3
    s_cmp_lg_u32 s30, 0
    s_cbranch_scc1 Lretry_5
    s_waitcnt vmcnt(0)
    v_mov_b32 v14, s36
    v_mov_b32 v15, 0
    s_cmp_lg_u32 s33, 0
    s_cbranch_scc1 Lps_42
    s_mov_b64 exec, 1
    buffer_store_dword v14, v15, s[8:11], s35 offen
    s_branch Lpd_43
Lps_42:
    s_waitcnt vmcnt(0)
    buffer_wbl2 sc1
    s_waitcnt vmcnt(0)
    s_mov_b64 exec, 1
    buffer_store_dword v14, v15, s[8:11], s35 offen sc1
Lpd_43:
    s_mov_b64 exec, -1
    s_lshr_b32 s24, s6, 2
    s_lshl_b32 s24, s24, 4
    s_mov_b32 s42, 0xffff
    s_mov_b32 s43, 0
    s_lshl_b64 s[42:43], s[42:43], s24
    s_lshl_b32 s25, s3, 13
    s_mul_i32 s24, s4, 114688
    s_add_u32 s24, s24, s25
    s_add_u32 s24, s24, 7873536
    s_mov_b64 exec, s[42:43]
Lw_44:
    s_add_u32 s39, s39, 1
    s_cmp_gt_u32 s39, 1048576
    s_cbranch_scc1 Lwx_45
    buffer_load_dword v14, v13, s[8:11], s34 offen sc1
    s_waitcnt vmcnt(0)
    v_subrev_u32 v14, s36, v14
    v_cmp_lt_u32 vcc, 15, v14
    s_cbranch_vccnz Lw_44
Lwx_45:
    s_mov_b64 exec, -1
    s_cmp_eq_u32 s33, 0
    s_cbranch_scc1 Lwf_46
    buffer_inv sc1
    s_waitcnt vmcnt(0)
Lwf_46:
    s_add_u32 s36, s36, 1
    s_mov_b32 m0, s25
    s_nop 0
    buffer_load_dwordx4 v0, s[8:11], s24 offen offset:0 sc1 lds
    buffer_load_dwordx4 v0, s[8:11], s24 offen offset:1024 sc1 lds
    buffer_load_dwordx4 v0, s[8:11], s24 offen offset:2048 sc1 lds
    buffer_load_dwordx4 v0, s[8:11], s24 offen offset:3072 sc1 lds
    s_add_u32 s24, s24, 4096
    s_add_u32 s25, s25, 4096
    s_mov_b32 m0, s25
    s_nop 0
    buffer_load_dwordx4 v0, s[8:11], s24 offen offset:0 sc1 lds
    buffer_load_dwordx4 v0, s[8:11], s24 offen offset:1024 sc1 lds
    buffer_load_dwordx4 v0, s[8:11], s24 offen offset:2048 sc1 lds
    buffer_load_dwordx4 v0, s[8:11], s24 offen offset:3072 sc1 lds
    s_mul_i32 s24, s4, 3584
    s_lshl_b32 s25, s47, 8
    s_add_u32 s25, s25, s24
    s_add_u32 s25, s25, 7644160
    s_add_u32 s24, s50, 0
    v_lshlrev_b32 v16, 16, v224
    v_and_b32 v17, 0xffff0000, v224
    v_lshlrev_b32 v18, 16, v225
    v_and_b32 v19, 0xffff0000, v225
    v_lshlrev_b32 v20, 16, v226
    v_and_b32 v21, 0xffff0000, v226
    v_lshlrev_b32 v22, 16, v227
    v_and_b32 v23, 0xffff0000, v227
    v_lshlrev_b32 v24, 16, v228
    v_and_b32 v25, 0xffff0000, v228
    v_lshlrev_b32 v26, 16, v229
    v_and_b32 v27, 0xffff0000, v229
    v_lshlrev_b32 v28, 16, v230
    v_and_b32 v29, 0xffff0000, v230
    v_lshlrev_b32 v30, 16, v231
    v_and_b32 v31, 0xffff0000, v231
    s_waitcnt vmcnt(0)
    s_barrier
    s_lshl_b32 s30, s5, 2
    s_add_u32 s30, s30, s3
    s_cmp_ge_u32 s30, 14
    s_cbranch_scc1 Lidle_47
    ds_read_b128 v[48:51], v0 offset:0
    ds_read_b128 v[52:55], v0 offset:1024
    ds_read_b128 v[56:59], v0 offset:2048
    ds_read_b128 v[60:63], v0 offset:3072
    ds_read_b128 v[64:67], v0 offset:4096
    ds_read_b128 v[68:71], v0 offset:5120
    ds_read_b128 v[72:75], v0 offset:6144
    ds_read_b128 v[76:79], v0 offset:7168
    s_waitcnt lgkmcnt(7)
    v_mfma_f32_32x32x16_bf16 v[16:31], a[224:227], v[48:51], v[16:31]
    ds_read_b128 v[48:51], v0 offset:8192
    s_waitcnt lgkmcnt(7)
    v_mfma_f32_32x32x16_bf16 v[16:31], a[228:231], v[52:55], v[16:31]
    ds_read_b128 v[52:55], v0 offset:9216
    s_waitcnt lgkmcnt(7)
    v_mfma_f32_32x32x16_bf16 v[16:31], a[232:235], v[56:59], v[16:31]
    ds_read_b128 v[56:59], v0 offset:10240
    s_waitcnt lgkmcnt(7)
    v_mfma_f32_32x32x16_bf16 v[16:31], a[236:239], v[60:63], v[16:31]
    ds_read_b128 v[60:63], v0 offset:11264
    s_waitcnt lgkmcnt(7)
    v_mfma_f32_32x32x16_bf16 v[16:31], a[240:243], v[64:67], v[16:31]
    ds_read_b128 v[64:67], v0 offset:12288
    s_waitcnt lgkmcnt(7)
    v_mfma_f32_32x32x16_bf16 v[16:31], a[244:247], v[68:71], v[16:31]
    ds_read_b128 v[68:71], v0 offset:13312
    s_waitcnt lgkmcnt(7)
    v_mfma_f32_32x32x16_bf16 v[16:31], a[248:251], v[72:75], v[16:31]
    ds_read_b128 v[72:75], v0 offset:14336
    s_waitcnt lgkmcnt(7)
    v_mfma_f32_32x32x16_bf16 v[16:31], a[252:255], v[76:79], v[16:31]
    ds_read_b128 v[76:79], v0 offset:15360
    s_waitcnt lgkmcnt(7)
    v_mfma_f32_32x32x16_bf16 v[16:31], v[232:235], v[48:51], v[16:31]
    ds_read_b128 v[48:51], v0 offset:16384
    s_waitcnt lgkmcnt(7)
    v_mfma_f32_32x32x16_bf16 v[16:31], v[236:239], v[52:55], v[16:31]
    ds_read_b128 v[52:55], v0 offset:17408
    s_waitcnt lgkmcnt(7)
    v_mfma_f32_32x32x16_bf16 v[16:31], v[240:243], v[56:59], v[16:31]
    ds_read_b128 v[56:59], v0 offset:18432
    s_waitcnt lgkmcnt(7)
    v_mfma_f32_32x32x16_bf16 v[16:31], v[244:247], v[60:63], v[16:31]
    ds_read_b128 v[60:63], v0 offset:19456
    s_waitcnt lgkmcnt(7)
    v_mfma_f32_32x32x16_bf16 v[16:31], v[248:251], v[64:67], v[16:31]
    ds_read_b128 v[64:67], v0 offset:20480
    s_waitcnt lgkmcnt(7)
    v_mfma_f32_32x32x16_bf16 v[16:31], v[252:255], v[68:71], v[16:31]
    ds_read_b128 v[68:71], v0 offset:21504
    s_waitcnt lgkmcnt(7)
    v_mfma_f32_32x32x16_bf16 v[16:31], v[160:163], v[72:75], v[16:31]
    ds_read_b128 v[72:75], v0 offset:22528
    s_waitcnt lgkmcnt(7)
    v_mfma_f32_32x32x16_bf16 v[16:31], v[164:167], v[76:79], v[16:31]
    ds_read_b128 v[76:79], v0 offset:23552
    s_waitcnt lgkmcnt(7)
    v_mfma_f32_32x32x16_bf16 v[16:31], v[168:171], v[48:51], v[16:31]
    ds_read_b128 v[48:51], v0 offset:24576
    s_waitcnt lgkmcnt(7)
    v_mfma_f32_32x32x16_bf16 v[16:31], v[172:175], v[52:55], v[16:31]
    ds_read_b128 v[52:55], v0 offset:25600
    s_waitcnt lgkmcnt(7)
    v_mfma_f32_32x32x16_bf16 v[16:31], v[176:179], v[56:59], v[16:31]
    ds_read_b128 v[56:59], v0 offset:26624
    s_waitcnt lgkmcnt(7)
    v_mfma_f32_32x32x16_bf16 v[16:31], v[180:183], v[60:63], v[16:31]
    ds_read_b128 v[60:63], v0 offset:27648
    s_waitcnt lgkmcnt(7)
    v_mfma_f32_32x32x16_bf16 v[16:31], v[184:187], v[64:67], v[16:31]
    ds_read_b128 v[64:67], v0 offset:28672
    s_waitcnt lgkmcnt(7)
    v_mfma_f32_32x32x16_bf16 v[16:31], v[188:191], v[68:71], v[16:31]
    ds_read_b128 v[68:71], v0 offset:29696
    s_waitcnt lgkmcnt(7)
    v_mfma_f32_32x32x16_bf16 v[16:31], v[192:195], v[72:75], v[16:31]
    ds_read_b128 v[72:75], v0 offset:30720
    s_waitcnt lgkmcnt(7)
    v_mfma_f32_32x32x16_bf16 v[16:31], v[196:199], v[76:79], v[16:31]
    ds_read_b128 v[76:79], v0 offset:31744
    s_waitcnt lgkmcnt(7)
    v_mfma_f32_32x32x16_bf16 v[16:31], v[200:203], v[48:51], v[16:31]
    s_waitcnt lgkmcnt(6)
    v_mfma_f32_32x32x16_bf16 v[16:31], v[204:207], v[52:55], v[16:31]
    s_waitcnt lgkmcnt(5)
    v_mfma_f32_32x32x16_bf16 v[16:31], v[208:211], v[56:59], v[16:31]
    s_waitcnt lgkmcnt(4)
    v_mfma_f32_32x32x16_bf16 v[16:31], v[212:215], v[60:63], v[16:31]
    s_waitcnt lgkmcnt(3)
    v_mfma_f32_32x32x16_bf16 v[16:31], v[216:219], v[64:67], v[16:31]
    s_waitcnt lgkmcnt(2)
    v_mfma_f32_32x32x16_bf16 v[16:31], v[220:223], v[68:71], v[16:31]
    s_waitcnt lgkmcnt(1)
    v_mfma_f32_32x32x16_bf16 v[16:31], v[88:91], v[72:75], v[16:31]
    s_waitcnt lgkmcnt(0)
    v_mfma_f32_32x32x16_bf16 v[16:31], v[92:95], v[76:79], v[16:31]
    s_barrier
    s_nop 10
    v_cvt_pk_bf16_f32 v224, v16, v17
    v_cvt_pk_bf16_f32 v225, v18, v19
    v_cvt_pk_bf16_f32 v226, v20, v21
    v_cvt_pk_bf16_f32 v227, v22, v23
    v_cvt_pk_bf16_f32 v228, v24, v25
    v_cvt_pk_bf16_f32 v229, v26, v27
    v_cvt_pk_bf16_f32 v230, v28, v29
    v_cvt_pk_bf16_f32 v231, v30, v31
    buffer_store_dwordx4 v[224:227], v0, s[8:11], s24 offen offset:0
    buffer_store_dwordx4 v[228:231], v0, s[8:11], s24 offen offset:1024
    v_pk_mul_f32 v[34:35], v[16:17], v[16:17]
    v_pk_add_f32 v[32:33], v[16:17], v[18:19]
    v_pk_fma_f32 v[34:35], v[18:19], v[18:19], v[34:35]
    v_pk_add_f32 v[32:33], v[32:33], v[20:21]
    v_pk_fma_f32 v[34:35], v[20:21], v[20:21], v[34:35]
    v_pk_add_f32 v[32:33], v[32:33], v[22:23]
    v_pk_fma_f32 v[34:35], v[22:23], v[22:23], v[34:35]
    v_pk_add_f32 v[32:33], v[32:33], v[24:25]
    v_pk_fma_f32 v[34:35], v[24:25], v[24:25], v[34:35]
    v_pk_add_f32 v[32:33], v[32:33], v[26:27]
    v_pk_fma_f32 v[34:35], v[26:27], v[26:27], v[34:35]
    v_pk_add_f32 v[32:33], v[32:33], v[28:29]
    v_pk_fma_f32 v[34:35], v[28:29], v[28:29], v[34:35]
    v_pk_add_f32 v[32:33], v[32:33], v[30:31]
    v_pk_fma_f32 v[34:35], v[30:31], v[30:31], v[34:35]
    v_lshlrev_b32 v5, 3, v1
    v_add_f32 v32, v32, v33
    v_add_f32 v33, v34, v35
    v_mov_b32 v34, v32
    v_mov_b32 v35, v33
    s_nop 1
    v_permlane32_swap_b32 v34, v32
    v_permlane32_swap_b32 v35, v33
    s_nop 1
    v_add_f32 v32, v32, v34
    v_add_f32 v33, v33, v35
    s_mov_b32 exec_hi, 0
    buffer_store_dwordx2 v[32:33], v5, s[8:11], s25 offen
    s_mov_b32 exec_hi, -1
    s_waitcnt vmcnt(0)
    v_mov_b32 v14, s36
    v_mov_b32 v15, 0
    s_cmp_lg_u32 s33, 0
    s_cbranch_scc1 Lps_49
    s_mov_b64 exec, 1
    buffer_store_dword v14, v15, s[8:11], s35 offen
    s_branch Lpd_50
Lps_49:
    s_waitcnt vmcnt(0)
    buffer_wbl2 sc1
    s_waitcnt vmcnt(0)
    s_mov_b64 exec, 1
    buffer_store_dword v14, v15, s[8:11], s35 offen sc1
Lpd_50:
    s_mov_b64 exec, -1
    s_branch Ljoin_48
Lidle_47:
    s_barrier
Ljoin_48:
    s_lshl_b32 s24, s3, 4
    s_mov_b32 s42, 0x3fff
    s_mov_b32 s43, 0
    s_lshl_b64 s[42:43], s[42:43], s24
    s_add_u32 s27, s38, s3
    s_mul_i32 s24, s27, 28672
    s_add_u32 s24, s24, 5809152
    s_mul_i32 s25, s27, 3584
    s_add_u32 s25, s25, 7644160
    s_mul_i32 s27, s27, 114688
    s_mul_i32 s26, s6, 7168
    s_add_u32 s27, s27, s26
    s_add_u32 s27, s27, 7873536
    v_add_u32 v3, 0x10000, v0
    v_add_u32 v4, 0x20000, v0
    v_lshlrev_b32 v5, 4, v2
    v_add_u32 v5, 0x20000, v5
    v_mul_u32_u24 v8, 1792, v2
    v_lshl_add_u32 v8, v1, 3, v8
    s_mul_i32 s30, s37, 143360
    s_sub_u32 s52, s44, s30
    s_mul_i32 s30, s37, 640
    v_add_u32 v248, s30, v5
    v_subrev_u32 v249, s30, v5
    ds_read_b128 a[224:227], v0 offset:57344
    ds_read_b128 a[228:231], v3 offset:20480
    ds_read_b128 a[232:235], v0 offset:58368
    ds_read_b128 a[236:239], v3 offset:21504
    ds_read_b128 a[240:243], v0 offset:59392
    ds_read_b128 a[244:247], v3 offset:22528
    ds_read_b128 a[248:251], v0 offset:60416
    s_add_u32 m0, s45, 0
    s_add_u32 s46, s44, 86016
    buffer_load_dwordx4 v0, s[8:11], s46 offen offset:0 lds
    buffer_load_dwordx4 v0, s[8:11], s46 offen offset:1024 lds
    buffer_load_dwordx4 v0, s[8:11], s46 offen offset:2048 lds
    buffer_load_dwordx4 v0, s[8:11], s46 offen offset:3072 lds
    s_add_u32 m0, s45, 4096
    s_add_u32 s46, s44, 90112
    buffer_load_dwordx4 v0, s[8:11], s46 offen offset:0 lds
    buffer_load_dwordx4 v0, s[8:11], s46 offen offset:1024 lds
    buffer_load_dwordx4 v0, s[8:11], s46 offen offset:2048 lds
    s_mov_b64 exec, s[42:43]
Lw_51:
    s_add_u32 s39, s39, 1
    s_cmp_gt_u32 s39, 1048576
    s_cbranch_scc1 Lwx_52
    buffer_load_dword v14, v13, s[8:11], s34 offen sc1
    s_waitcnt vmcnt(0)
    v_subrev_u32 v14, s36, v14
    v_cmp_lt_u32 vcc, 15, v14
    s_cbranch_vccnz Lw_51
Lwx_52:
    s_mov_b64 exec, -1
    s_cmp_eq_u32 s33, 0
    s_cbranch_scc1 Lwf_53
    buffer_inv sc1
    s_waitcnt vmcnt(0)
Lwf_53:
    s_add_u32 s36, s36, 1
    buffer_load_dwordx4 v[116:119], v0, s[8:11], s24 offen offset:0 sc1
    buffer_load_dwordx4 v[120:123], v0, s[8:11], s24 offen offset:1024 sc1
    buffer_load_dwordx4 v[124:127], v0, s[8:11], s24 offen offset:2048 sc1
    buffer_load_dwordx4 v[128:131], v0, s[8:11], s24 offen offset:3072 sc1
    s_add_u32 s24, s24, 4096
    buffer_load_dwordx4 v[132:135], v0, s[8:11], s24 offen offset:0 sc1
    buffer_load_dwordx4 v[136:139], v0, s[8:11], s24 offen offset:1024 sc1
    buffer_load_dwordx4 v[140:143], v0, s[8:11], s24 offen offset:2048 sc1
    buffer_load_dwordx4 v[144:147], v0, s[8:11], s24 offen offset:3072 sc1
    s_waitcnt vmcnt(7)
    s_waitcnt lgkmcnt(5)
    v_mfma_f32_32x32x16_bf16 v[16:31], a[224:227], v[116:119], 0
    ds_read_b128 a[252:255], v3 offset:23552
    s_add_u32 s24, s24, 4096
    buffer_load_dwordx4 v[148:151], v0, s[8:11], s24 offen offset:0 sc1
    v_mfma_f32_32x32x16_bf16 v[32:47], a[228:231], v[116:119], 0
    ds_read_b128 a[224:227], v0 offset:61440
    buffer_load_dwordx2 v[100:101], v8, s[8:11], s25 offen offset:0 sc1
    s_waitcnt vmcnt(8)
    s_waitcnt lgkmcnt(5)
    v_mfma_f32_32x32x16_bf16 v[16:31], a[232:235], v[120:123], v[16:31]
    ds_read_b128 a[228:231], v3 offset:24576
    buffer_load_dwordx4 v[152:155], v0, s[8:11], s24 offen offset:1024 sc1
    v_mfma_f32_32x32x16_bf16 v[32:47], a[236:239], v[120:123], v[32:47]
    ds_read_b128 a[232:235], v0 offset:62464
    buffer_load_dwordx2 v[102:103], v8, s[8:11], s25 offen offset:256 sc1
    s_waitcnt vmcnt(9)
    s_waitcnt lgkmcnt(5)
    v_mfma_f32_32x32x16_bf16 v[16:31], a[240:243], v[124:127], v[16:31]
    ds_read_b128 a[236:239], v3 offset:25600
    buffer_load_dwordx4 v[156:159], v0, s[8:11], s24 offen offset:2048 sc1
    v_mfma_f32_32x32x16_bf16 v[32:47], a[244:247], v[124:127], v[32:47]
    ds_read_b128 a[240:243], v0 offset:63488
    buffer_load_dwordx2 v[104:105], v8, s[8:11], s25 offen offset:512 sc1
    s_waitcnt vmcnt(10)
    s_waitcnt lgkmcnt(5)
    v_mfma_f32_32x32x16_bf16 v[16:31], a[248:251], v[128:131], v[16:31]
    ds_read_b128 a[244:247], v3 offset:26624
    buffer_load_dwordx4 v[160:163], v0, s[8:11], s24 offen offset:3072 sc1
    v_mfma_f32_32x32x16_bf16 v[32:47], a[252:255], v[128:131], v[32:47]
    ds_read_b128 a[248:251], v0 offset:64512
    buffer_load_dwordx2 v[106:107], v8, s[8:11], s25 offen offset:768 sc1
    s_waitcnt vmcnt(11)
    s_waitcnt lgkmcnt(5)
    v_mfma_f32_32x32x16_bf16 v[16:31], a[224:227], v[132:135], v[16:31]
    ds_read_b128 a[252:255], v3 offset:27648
    s_add_u32 s24, s24, 4096
    buffer_load_dwordx4 v[164:167], v0, s[8:11], s24 offen offset:0 sc1
    v_mfma_f32_32x32x16_bf16 v[32:47], a[228:231], v[132:135], v[32:47]
    ds_read_b128 a[224:227], v3 offset:0
    buffer_load_dwordx2 v[108:109], v8, s[8:11], s25 offen offset:1024 sc1
    s_waitcnt vmcnt(12)
    s_waitcnt lgkmcnt(5)
    v_mfma_f32_32x32x16_bf16 v[16:31], a[232:235], v[136:139], v[16:31]
    ds_read_b128 a[228:231], v3 offset:28672
    buffer_load_dwordx4 v[168:171], v0, s[8:11], s24 offen offset:1024 sc1
    v_mfma_f32_32x32x16_bf16 v[32:47], a[236:239], v[136:139], v[32:47]
    ds_read_b128 a[232:235], v3 offset:1024
    buffer_load_dwordx2 v[110:111], v8, s[8:11], s25 offen offset:1280 sc1
    s_waitcnt vmcnt(13)
    s_waitcnt lgkmcnt(5)
    v_mfma_f32_32x32x16_bf16 v[16:31], a[240:243], v[140:143], v[16:31]
    ds_read_b128 a[236:239], v3 offset:29696
    buffer_load_dwordx4 v[172:175], v0, s[8:11], s24 offen offset:2048 sc1
    v_mfma_f32_32x32x16_bf16 v[32:47], a[244:247], v[140:143], v[32:47]
    ds_read_b128 a[240:243], v3 offset:2048
    buffer_load_dwordx2 v[112:113], v8, s[8:11], s25 offen offset:1536 sc1
    s_waitcnt vmcnt(14)
    s_waitcnt lgkmcnt(5)
    v_mfma_f32_32x32x16_bf16 v[16:31], a[248:251], v[144:147], v[16:31]
    ds_read_b128 a[244:247], v3 offset:30720
    buffer_load_dwordx4 v[176:179], v0, s[8:11], s24 offen offset:3072 sc1
    v_mfma_f32_32x32x16_bf16 v[32:47], a[252:255], v[144:147], v[32:47]
    ds_read_b128 a[248:251], v3 offset:3072
    s_waitcnt vmcnt(14)
    s_waitcnt lgkmcnt(5)
    v_mfma_f32_32x32x16_bf16 v[16:31], a[224:227], v[148:151], v[16:31]
    ds_read_b128 a[252:255], v3 offset:31744
    s_add_u32 s24, s24, 4096
    buffer_load_dwordx4 v[180:183], v0, s[8:11], s24 offen offset:0 sc1
    v_mfma_f32_32x32x16_bf16 v[32:47], a[228:231], v[148:151], v[32:47]
    ds_read_b128 a[224:227], v3 offset:4096
    s_waitcnt vmcnt(13)
    s_waitcnt lgkmcnt(5)
    v_mfma_f32_32x32x16_bf16 v[16:31], a[232:235], v[152:155], v[16:31]
    ds_read_b128 a[228:231], v3 offset:32768
    buffer_load_dwordx4 v[184:187], v0, s[8:11], s24 offen offset:1024 sc1
    v_mfma_f32_32x32x16_bf16 v[32:47], a[236:239], v[152:155], v[32:47]
    ds_read_b128 a[232:235], v3 offset:5120
    s_waitcnt vmcnt(12)
    s_waitcnt lgkmcnt(5)
    v_mfma_f32_32x32x16_bf16 v[16:31], a[240:243], v[156:159], v[16:31]
    ds_read_b128 a[236:239], v3 offset:33792
    buffer_load_dwordx4 v[188:191], v0, s[8:11], s24 offen offset:2048 sc1
    v_mfma_f32_32x32x16_bf16 v[32:47], a[244:247], v[156:159], v[32:47]
    ds_read_b128 a[240:243], v3 offset:6144
    s_waitcnt vmcnt(11)
    s_waitcnt lgkmcnt(5)
    v_mfma_f32_32x32x16_bf16 v[16:31], a[248:251], v[160:163], v[16:31]
    ds_read_b128 a[244:247], v3 offset:34816
    buffer_load_dwordx4 v[192:195], v0, s[8:11], s24 offen offset:3072 sc1
    v_mfma_f32_32x32x16_bf16 v[32:47], a[252:255], v[160:163], v[32:47]
    ds_read_b128 a[248:251], v3 offset:7168
    s_waitcnt vmcnt(10)
    s_waitcnt lgkmcnt(5)
    v_mfma_f32_32x32x16_bf16 v[16:31], a[224:227], v[164:167], v[16:31]
    ds_read_b128 a[252:255], v3 offset:35840
    s_add_u32 s24, s24, 4096
    buffer_load_dwordx4 v[196:199], v0, s[8:11], s24 offen offset:0 sc1
    v_mfma_f32_32x32x16_bf16 v[32:47], a[228:231], v[164:167], v[32:47]
    ds_read_b128 a[224:227], v3 offset:8192
    s_waitcnt vmcnt(9)
    s_waitcnt lgkmcnt(5)
    v_mfma_f32_32x32x16_bf16 v[16:31], a[232:235], v[168:171], v[16:31]
    ds_read_b128 a[228:231], v3 offset:36864
    buffer_load_dwordx4 v[200:203], v0, s[8:11], s24 offen offset:1024 sc1
    v_mfma_f32_32x32x16_bf16 v[32:47], a[236:239], v[168:171], v[32:47]
    ds_read_b128 a[232:235], v3 offset:9216
    s_waitcnt vmcnt(8)
    s_waitcnt lgkmcnt(5)
    v_mfma_f32_32x32x16_bf16 v[16:31], a[240:243], v[172:175], v[16:31]
    ds_read_b128 a[236:239], v3 offset:37888
    buffer_load_dwordx4 v[204:207], v0, s[8:11], s24 offen offset:2048 sc1
    v_mfma_f32_32x32x16_bf16 v[32:47], a[244:247], v[172:175], v[32:47]
    ds_read_b128 a[240:243], v3 offset:10240
    s_waitcnt vmcnt(7)
    s_waitcnt lgkmcnt(5)
    v_mfma_f32_32x32x16_bf16 v[16:31], a[248:251], v[176:179], v[16:31]
    ds_read_b128 a[244:247], v3 offset:38912
    buffer_load_dwordx4 v[208:211], v0, s[8:11], s24 offen offset:3072 sc1
    v_mfma_f32_32x32x16_bf16 v[32:47], a[252:255], v[176:179], v[32:47]
    ds_read_b128 a[248:251], v3 offset:11264
    s_waitcnt vmcnt(7)
    s_waitcnt lgkmcnt(5)
    v_mfma_f32_32x32x16_bf16 v[16:31], a[224:227], v[180:183], v[16:31]
    ds_read_b128 a[252:255], v3 offset:39936
    s_add_u32 s24, s24, 4096
    buffer_load_dwordx4 v[212:215], v0, s[8:11], s24 offen offset:0 sc1
    v_mfma_f32_32x32x16_bf16 v[32:47], a[228:231], v[180:183], v[32:47]
    ds_read_b128 a[224:227], v3 offset:12288
    s_waitcnt vmcnt(7)
    s_waitcnt lgkmcnt(5)
    v_mfma_f32_32x32x16_bf16 v[16:31], a[232:235], v[184:187], v[16:31]
    ds_read_b128 a[228:231], v3 offset:40960
    buffer_load_dwordx4 v[216:219], v0, s[8:11], s24 offen offset:1024 sc1
    v_mfma_f32_32x32x16_bf16 v[32:47], a[236:239], v[184:187], v[32:47]
    ds_read_b128 a[232:235], v3 offset:13312
    s_waitcnt vmcnt(7)
    s_waitcnt lgkmcnt(5)
    v_mfma_f32_32x32x16_bf16 v[16:31], a[240:243], v[188:191], v[16:31]
    ds_read_b128 a[236:239], v3 offset:41984
    buffer_load_dwordx4 v[220:223], v0, s[8:11], s24 offen offset:2048 sc1
    v_mfma_f32_32x32x16_bf16 v[32:47], a[244:247], v[188:191], v[32:47]
    ds_read_b128 a[240:243], v3 offset:14336
    s_waitcnt vmcnt(7)
    s_waitcnt lgkmcnt(5)
    v_mfma_f32_32x32x16_bf16 v[16:31], a[248:251], v[192:195], v[16:31]
    ds_read_b128 a[244:247], v3 offset:43008
    buffer_load_dwordx4 v[224:227], v0, s[8:11], s24 offen offset:3072 sc1
    v_mfma_f32_32x32x16_bf16 v[32:47], a[252:255], v[192:195], v[32:47]
    ds_read_b128 a[248:251], v3 offset:15360
    s_waitcnt vmcnt(7)
    s_waitcnt lgkmcnt(5)
    v_mfma_f32_32x32x16_bf16 v[16:31], a[224:227], v[196:199], v[16:31]
    ds_read_b128 a[252:255], v3 offset:44032
    ds_read_b128 v[80:83], v248 offset:12288
    ds_read_b128 v[84:87], v248 offset:12320
    ds_read_b128 v[88:91], v248 offset:12352
    ds_read_b128 v[92:95], v248 offset:12384
    v_mfma_f32_32x32x16_bf16 v[32:47], a[228:231], v[196:199], v[32:47]
    ds_read_b128 a[224:227], v3 offset:16384
    s_waitcnt vmcnt(6)
    s_waitcnt lgkmcnt(9)
    v_mfma_f32_32x32x16_bf16 v[16:31], a[232:235], v[200:203], v[16:31]
    ds_read_b128 a[228:231], v3 offset:45056
    v_mfma_f32_32x32x16_bf16 v[32:47], a[236:239], v[200:203], v[32:47]
    ds_read_b128 a[232:235], v3 offset:17408
    s_waitcnt vmcnt(5)
    s_waitcnt lgkmcnt(9)
    v_mfma_f32_32x32x16_bf16 v[16:31], a[240:243], v[204:207], v[16:31]
    ds_read_b128 a[236:239], v3 offset:46080
    s_waitcnt vmcnt(13)
    v_add_f32 v102, v102, v104
    v_add_f32 v103, v103, v105
    v_add_f32 v106, v106, v108
    v_add_f32 v107, v107, v109
    v_add_f32 v110, v110, v112
    v_mfma_f32_32x32x16_bf16 v[32:47], a[244:247], v[204:207], v[32:47]
    ds_read_b128 a[240:243], v3 offset:18432
    v_add_f32 v111, v111, v113
    v_add_f32 v100, v100, v102
    v_add_f32 v101, v101, v103
    v_add_f32 v106, v106, v110
    s_waitcnt vmcnt(4)
    s_waitcnt lgkmcnt(9)
    v_mfma_f32_32x32x16_bf16 v[16:31], a[248:251], v[208:211], v[16:31]
    ds_read_b128 a[244:247], v3 offset:47104
    v_add_f32 v107, v107, v111
    v_add_f32 v6, v100, v106
    v_add_f32 v7, v101, v107
    v_mov_b32 v10, v6
    v_mov_b32 v11, v7
    v_mfma_f32_32x32x16_bf16 v[32:47], a[252:255], v[208:211], v[32:47]
    ds_read_b128 a[248:251], v3 offset:19456
    s_nop 1
    v_permlane32_swap_b32 v10, v6
    v_permlane32_swap_b32 v11, v7
    s_nop 1
    s_waitcnt vmcnt(3)
    s_waitcnt lgkmcnt(5)
    v_mfma_f32_32x32x16_bf16 v[16:31], a[224:227], v[212:215], v[16:31]
    ds_read_b128 a[252:255], v3 offset:48128
    v_add_f32 v6, v6, v10
    v_add_f32 v7, v7, v11
    v_mul_f32 v6, 0x3b124925, v6
    v_mul_f32 v7, 0x3b124925, v7
    v_fma_f32 v7, -v6, v6, v7
    v_mfma_f32_32x32x16_bf16 v[32:47], a[228:231], v[212:215], v[32:47]
    ds_read_b128 a[224:227], v3 offset:49152
    v_max_f32 v7, 0, v7
    v_add_f32 v7, 0x3727c5ac, v7
    v_rsq_f32 v7, v7
    s_nop 0
    s_waitcnt vmcnt(2)
    s_waitcnt lgkmcnt(5)
    v_mfma_f32_32x32x16_bf16 v[16:31], a[232:235], v[216:219], v[16:31]
    ds_read_b128 a[228:231], v3 offset:50176
    v_mul_f32 v9, 0xbfb8aa3b, v7
    v_rcp_f32 v7, v7
    v_mfma_f32_32x32x16_bf16 v[32:47], a[236:239], v[216:219], v[32:47]
    ds_read_b128 a[232:235], v3 offset:51200
    s_waitcnt vmcnt(1)
    s_waitcnt lgkmcnt(5)
    v_mfma_f32_32x32x16_bf16 v[16:31], a[240:243], v[220:223], v[16:31]
    ds_read_b128 a[236:239], v3 offset:52224
    v_mfma_f32_32x32x16_bf16 v[32:47], a[244:247], v[220:223], v[32:47]
    ds_read_b128 a[240:243], v3 offset:53248
    s_waitcnt vmcnt(0)
    s_waitcnt lgkmcnt(5)
    v_mfma_f32_32x32x16_bf16 v[16:31], a[248:251], v[224:227], v[16:31]
    ds_read_b128 a[244:247], v3 offset:54272
    v_mfma_f32_32x32x16_bf16 v[32:47], a[252:255], v[224:227], v[32:47]
    ds_read_b128 a[248:251], v3 offset:55296
    s_waitcnt lgkmcnt(5)
    v_mfma_f32_32x32x16_bf16 v[48:63], a[224:227], v[116:119], 0
    ds_read_b128 a[252:255], v3 offset:56320
    s_barrier
    v_mfma_f32_32x32x16_bf16 v[48:63], a[228:231], v[120:123], v[48:63]
    ds_read_b128 a[224:227], v3 offset:57344
    s_add_u32 m0, s45, 28672
    s_add_u32 s46, s44, 114688
    buffer_load_dwordx4 v0, s[8:11], s46 offen offset:0 lds
    s_waitcnt lgkmcnt(5)
    v_mfma_f32_32x32x16_bf16 v[48:63], a[232:235], v[124:127], v[48:63]
    ds_read_b128 a[228:231], v3 offset:58368
    s_waitcnt lgkmcnt(15)
    v_fma_f32 v16, -v6, v80, v16
    v_fma_f32 v17, -v6, v81, v17
    v_fma_f32 v18, -v6, v82, v18
    v_fma_f32 v19, -v6, v83, v19
    v_mfma_f32_32x32x16_bf16 v[48:63], a[236:239], v[128:131], v[48:63]
    ds_read_b128 a[232:235], v3 offset:59392
    v_fma_f32 v20, -v6, v84, v20
    v_fma_f32 v21, -v6, v85, v21
    v_fma_f32 v22, -v6, v86, v22
    v_fma_f32 v23, -v6, v87, v23
    s_waitcnt lgkmcnt(5)
    v_mfma_f32_32x32x16_bf16 v[48:63], a[240:243], v[132:135], v[48:63]
    ds_read_b128 a[236:239], v3 offset:60416
    buffer_load_dwordx4 v0, s[8:11], s46 offen offset:1024 lds
    v_fma_f32 v24, -v6, v88, v24
    v_fma_f32 v25, -v6, v89, v25
    v_fma_f32 v26, -v6, v90, v26
    v_mfma_f32_32x32x16_bf16 v[48:63], a[244:247], v[136:139], v[48:63]
    ds_read_b128 a[240:243], v3 offset:61440
    v_fma_f32 v27, -v6, v91, v27
    v_fma_f32 v28, -v6, v92, v28
    v_fma_f32 v29, -v6, v93, v29
    v_fma_f32 v30, -v6, v94, v30
    s_waitcnt lgkmcnt(5)
    v_mfma_f32_32x32x16_bf16 v[48:63], a[248:251], v[140:143], v[48:63]
    ds_read_b128 a[244:247], v3 offset:62464
    v_fma_f32 v31, -v6, v95, v31
    ds_read_b128 v[80:83], v248 offset:12416
    ds_read_b128 v[84:87], v248 offset:12448
    ds_read_b128 v[88:91], v248 offset:12480
    ds_read_b128 v[92:95], v248 offset:12512
    v_mfma_f32_32x32x16_bf16 v[48:63], a[252:255], v[144:147], v[48:63]
    ds_read_b128 a[248:251], v3 offset:63488
    buffer_load_dwordx4 v0, s[8:11], s46 offen offset:2048 lds
    v_mul_f32 v16, v9, v16
    v_mul_f32 v17, v9, v17
    s_waitcnt lgkmcnt(9)
    v_mfma_f32_32x32x16_bf16 v[48:63], a[224:227], v[148:151], v[48:63]
    ds_read_b128 a[252:255], v3 offset:64512
    v_exp_f32 v16, v16
    v_mul_f32 v18, v9, v18
    v_exp_f32 v17, v17
    v_mfma_f32_32x32x16_bf16 v[48:63], a[228:231], v[152:155], v[48:63]
    ds_read_b128 a[224:227], v4 offset:0
    v_mul_f32 v19, v9, v19
    v_fma_f32 v16, v16, v7, v7
    v_exp_f32 v18, v18
    s_waitcnt lgkmcnt(9)
    v_mfma_f32_32x32x16_bf16 v[48:63], a[232:235], v[156:159], v[48:63]
    ds_read_b128 a[228:231], v4 offset:1024
    buffer_load_dwordx4 v0, s[8:11], s46 offen offset:3072 lds
    v_mul_f32 v20, v9, v20
    v_fma_f32 v17, v17, v7, v7
    v_mfma_f32_32x32x16_bf16 v[48:63], a[236:239], v[160:163], v[48:63]
    ds_read_b128 a[232:235], v4 offset:2048
    v_rcp_f32 v16, v16
    v_exp_f32 v19, v19
    s_waitcnt lgkmcnt(9)
    v_mfma_f32_32x32x16_bf16 v[48:63], a[240:243], v[164:167], v[48:63]
    ds_read_b128 a[236:239], v4 offset:3072
    v_mul_f32 v21, v9, v21
    v_fma_f32 v18, v18, v7, v7
    v_rcp_f32 v17, v17
    v_mul_f32 v24, v16, v24
    v_mfma_f32_32x32x16_bf16 v[48:63], a[244:247], v[168:171], v[48:63]
    ds_read_b128 a[240:243], v4 offset:4096
    s_add_u32 m0, s45, 32768
    s_add_u32 s46, s44, 118784
    buffer_load_dwordx4 v0, s[8:11], s46 offen offset:0 lds
    s_waitcnt lgkmcnt(5)
    v_mfma_f32_32x32x16_bf16 v[48:63], a[248:251], v[172:175], v[48:63]
    ds_read_b128 a[244:247], v4 offset:5120
    v_exp_f32 v20, v20
    v_mul_f32 v22, v9, v22
    v_fma_f32 v19, v19, v7, v7
    v_mfma_f32_32x32x16_bf16 v[48:63], a[252:255], v[176:179], v[48:63]
    ds_read_b128 a[248:251], v4 offset:6144
    v_rcp_f32 v18, v18
    v_mul_f32 v25, v17, v25
    s_waitcnt lgkmcnt(5)
    v_mfma_f32_32x32x16_bf16 v[48:63], a[224:227], v[180:183], v[48:63]
    ds_read_b128 a[252:255], v4 offset:7168
    buffer_load_dwordx4 v0, s[8:11], s46 offen offset:1024 lds
    v_exp_f32 v21, v21
    v_mul_f32 v23, v9, v23
    v_mfma_f32_32x32x16_bf16 v[48:63], a[228:231], v[184:187], v[48:63]
    ds_read_b128 a[224:227], v4 offset:8192
    v_fma_f32 v20, v20, v7, v7
    v_rcp_f32 v19, v19
    v_mul_f32 v26, v18, v26
    s_waitcnt lgkmcnt(5)
    v_mfma_f32_32x32x16_bf16 v[48:63], a[232:235], v[188:191], v[48:63]
    ds_read_b128 a[228:231], v4 offset:9216
    v_cvt_pk_bf16_f32 v96, v24, v25
    v_exp_f32 v22, v22
    v_fma_f32 v21, v21, v7, v7
    v_mfma_f32_32x32x16_bf16 v[48:63], a[236:239], v[192:195], v[48:63]
    ds_read_b128 a[232:235], v4 offset:10240
    buffer_load_dwordx4 v0, s[8:11], s46 offen offset:2048 lds
    v_rcp_f32 v20, v20
    s_waitcnt lgkmcnt(5)
    v_mfma_f32_32x32x16_bf16 v[48:63], a[240:243], v[196:199], v[48:63]
    ds_read_b128 a[236:239], v4 offset:11264
    v_mul_f32 v27, v19, v27
    v_exp_f32 v23, v23
    v_fma_f32 v22, v22, v7, v7
    v_mfma_f32_32x32x16_bf16 v[48:63], a[244:247], v[200:203], v[48:63]
    ds_read_b128 a[240:243], v0 offset:0
    v_rcp_f32 v21, v21
    v_mul_f32 v28, v20, v28
    v_cvt_pk_bf16_f32 v97, v26, v27
    s_waitcnt lgkmcnt(5)
    v_mfma_f32_32x32x16_bf16 v[48:63], a[248:251], v[204:207], v[48:63]
    ds_read_b128 a[244:247], v0 offset:1024
    s_add_u32 m0, s45, 57344
    s_add_u32 s46, s52, 143360
    buffer_load_dwordx4 v0, s[8:11], s46 offen offset:0 lds
    v_fma_f32 v23, v23, v7, v7
    v_mfma_f32_32x32x16_bf16 v[48:63], a[252:255], v[208:211], v[48:63]
    ds_read_b128 a[248:251], v0 offset:2048
    v_rcp_f32 v22, v22
    v_mul_f32 v29, v21, v29
    s_waitcnt lgkmcnt(5)
    v_mfma_f32_32x32x16_bf16 v[48:63], a[224:227], v[212:215], v[48:63]
    ds_read_b128 a[252:255], v0 offset:3072
    v_rcp_f32 v23, v23
    v_mul_f32 v30, v22, v30
    v_cvt_pk_bf16_f32 v98, v28, v29
    v_mul_f32 v31, v23, v31
    v_mfma_f32_32x32x16_bf16 v[48:63], a[228:231], v[216:219], v[48:63]
    ds_read_b128 a[224:227], v0 offset:4096
    buffer_load_dwordx4 v0, s[8:11], s46 offen offset:1024 lds
    v_cvt_pk_bf16_f32 v99, v30, v31
    s_waitcnt lgkmcnt(5)
    v_mfma_f32_32x32x16_bf16 v[48:63], a[232:235], v[220:223], v[48:63]
    ds_read_b128 a[228:231], v0 offset:5120
    buffer_store_dwordx4 v[96:99], v0, s[8:11], s27 offen offset:0
    s_add_u32 s27, s27, 1024
    s_waitcnt lgkmcnt(15)
    v_fma_f32 v32, -v6, v80, v32
    v_fma_f32 v33, -v6, v81, v33
    v_mfma_f32_32x32x16_bf16 v[48:63], a[236:239], v[224:227], v[48:63]
    ds_read_b128 a[232:235], v0 offset:6144
    v_fma_f32 v34, -v6, v82, v34
    v_fma_f32 v35, -v6, v83, v35
    v_fma_f32 v36, -v6, v84, v36
    v_fma_f32 v37, -v6, v85, v37
    s_waitcnt lgkmcnt(5)
    v_mfma_f32_32x32x16_bf16 v[64:79], a[240:243], v[116:119], 0
    ds_read_b128 a[236:239], v0 offset:7168
    buffer_load_dwordx4 v0, s[8:11], s46 offen offset:2048 lds
    v_fma_f32 v38, -v6, v86, v38
    v_fma_f32 v39, -v6, v87, v39
    v_fma_f32 v40, -v6, v88, v40
    v_mfma_f32_32x32x16_bf16 v[64:79], a[244:247], v[120:123], v[64:79]
    ds_read_b128 a[240:243], v0 offset:8192
    v_fma_f32 v41, -v6, v89, v41
    v_fma_f32 v42, -v6, v90, v42
    v_fma_f32 v43, -v6, v91, v43
    v_fma_f32 v44, -v6, v92, v44
    s_waitcnt lgkmcnt(5)
    v_mfma_f32_32x32x16_bf16 v[64:79], a[248:251], v[124:127], v[64:79]
    ds_read_b128 a[244:247], v0 offset:9216
    v_fma_f32 v45, -v6, v93, v45
    v_fma_f32 v46, -v6, v94, v46
    v_fma_f32 v47, -v6, v95, v47
    v_mfma_f32_32x32x16_bf16 v[64:79], a[252:255], v[128:131], v[64:79]
    ds_read_b128 a[248:251], v0 offset:10240
    buffer_load_dwordx4 v0, s[8:11], s46 offen offset:3072 lds
    s_waitcnt lgkmcnt(5)
    v_mfma_f32_32x32x16_bf16 v[64:79], a[224:227], v[132:135], v[64:79]
    ds_read_b128 a[252:255], v0 offset:11264
    ds_read_b128 v[80:83], v5 offset:12544
    ds_read_b128 v[84:87], v5 offset:12576
    ds_read_b128 v[88:91], v5 offset:12608
    ds_read_b128 v[92:95], v5 offset:12640
    v_mul_f32 v32, v9, v32
    v_mfma_f32_32x32x16_bf16 v[64:79], a[228:231], v[136:139], v[64:79]
    ds_read_b128 a[224:227], v0 offset:12288
    v_mul_f32 v33, v9, v33
    v_exp_f32 v32, v32
    v_mul_f32 v34, v9, v34
    s_waitcnt lgkmcnt(9)
    v_mfma_f32_32x32x16_bf16 v[64:79], a[232:235], v[140:143], v[64:79]
    ds_read_b128 a[228:231], v0 offset:13312
    s_add_u32 m0, s45, 61440
    s_add_u32 s46, s52, 147456
    buffer_load_dwordx4 v0, s[8:11], s46 offen offset:0 lds
    v_mfma_f32_32x32x16_bf16 v[64:79], a[236:239], v[144:147], v[64:79]
    ds_read_b128 a[232:235], v0 offset:14336
    v_exp_f32 v33, v33
    v_mul_f32 v35, v9, v35
    v_fma_f32 v32, v32, v7, v7
    s_waitcnt lgkmcnt(9)
    v_mfma_f32_32x32x16_bf16 v[64:79], a[240:243], v[148:151], v[64:79]
    ds_read_b128 a[236:239], v0 offset:15360
    v_exp_f32 v34, v34
    v_mul_f32 v36, v9, v36
    v_fma_f32 v33, v33, v7, v7
    v_mfma_f32_32x32x16_bf16 v[64:79], a[244:247], v[152:155], v[64:79]
    ds_read_b128 a[240:243], v0 offset:16384
    buffer_load_dwordx4 v0, s[8:11], s46 offen offset:1024 lds
    v_rcp_f32 v32, v32
    s_waitcnt lgkmcnt(9)
    v_mfma_f32_32x32x16_bf16 v[64:79], a[248:251], v[156:159], v[64:79]
    ds_read_b128 a[244:247], v0 offset:17408
    v_exp_f32 v35, v35
    v_mul_f32 v37, v9, v37
    v_fma_f32 v34, v34, v7, v7
    v_mfma_f32_32x32x16_bf16 v[64:79], a[252:255], v[160:163], v[64:79]
    ds_read_b128 a[248:251], v0 offset:18432
    v_rcp_f32 v33, v33
    v_mul_f32 v40, v32, v40
    s_waitcnt lgkmcnt(5)
    v_mfma_f32_32x32x16_bf16 v[64:79], a[224:227], v[164:167], v[64:79]
    ds_read_b128 a[252:255], v0 offset:19456
    buffer_load_dwordx4 v0, s[8:11], s46 offen offset:2048 lds
    v_exp_f32 v36, v36
    v_mul_f32 v38, v9, v38
    v_mfma_f32_32x32x16_bf16 v[64:79], a[228:231], v[168:171], v[64:79]
    ds_read_b128 a[224:227], v0 offset:20480
    v_fma_f32 v35, v35, v7, v7
    v_rcp_f32 v34, v34
    v_mul_f32 v41, v33, v41
    s_waitcnt lgkmcnt(5)
    v_mfma_f32_32x32x16_bf16 v[64:79], a[232:235], v[172:175], v[64:79]
    ds_read_b128 a[228:231], v0 offset:21504
    v_exp_f32 v37, v37
    v_mul_f32 v39, v9, v39
    v_fma_f32 v36, v36, v7, v7
    v_mfma_f32_32x32x16_bf16 v[64:79], a[236:239], v[176:179], v[64:79]
    ds_read_b128 a[232:235], v0 offset:22528
    s_add_u32 m0, s45, 86016
    s_add_u32 s46, s52, 172032
    buffer_load_dwordx4 v0, s[8:11], s46 offen offset:0 lds
    s_waitcnt lgkmcnt(5)
    v_mfma_f32_32x32x16_bf16 v[64:79], a[240:243], v[180:183], v[64:79]
    ds_read_b128 a[236:239], v0 offset:23552
    s_waitcnt vmcnt(9)
    s_barrier
    v_rcp_f32 v35, v35
    v_mul_f32 v42, v34, v42
    v_cvt_pk_bf16_f32 v96, v40, v41
    v_mfma_f32_32x32x16_bf16 v[64:79], a[244:247], v[184:187], v[64:79]
    ds_read_b128 a[240:243], v0 offset:24576
    v_exp_f32 v38, v38
    v_fma_f32 v37, v37, v7, v7
    s_waitcnt lgkmcnt(5)
    v_mfma_f32_32x32x16_bf16 v[64:79], a[248:251], v[188:191], v[64:79]
    ds_read_b128 a[244:247], v0 offset:25600
    buffer_load_dwordx4 v0, s[8:11], s46 offen offset:1024 lds
    v_rcp_f32 v36, v36
    v_mul_f32 v43, v35, v43
    v_mfma_f32_32x32x16_bf16 v[64:79], a[252:255], v[192:195], v[64:79]
    ds_read_b128 a[248:251], v0 offset:26624
    v_exp_f32 v39, v39
    v_fma_f32 v38, v38, v7, v7
    s_waitcnt lgkmcnt(5)
    v_mfma_f32_32x32x16_bf16 v[64:79], a[224:227], v[196:199], v[64:79]
    ds_read_b128 a[252:255], v0 offset:27648
    v_rcp_f32 v37, v37
    v_mul_f32 v44, v36, v44
    v_cvt_pk_bf16_f32 v97, v42, v43
    v_fma_f32 v39, v39, v7, v7
    v_mfma_f32_32x32x16_bf16 v[64:79], a[228:231], v[200:203], v[64:79]
    ds_read_b128 a[224:227], v0 offset:28672
    buffer_load_dwordx4 v0, s[8:11], s46 offen offset:2048 lds
    v_rcp_f32 v38, v38
    s_waitcnt lgkmcnt(5)
    v_mfma_f32_32x32x16_bf16 v[64:79], a[232:235], v[204:207], v[64:79]
    ds_read_b128 a[228:231], v0 offset:29696
    v_mul_f32 v45, v37, v45
    v_rcp_f32 v39, v39
    v_mul_f32 v46, v38, v46
    v_cvt_pk_bf16_f32 v98, v44, v45
    v_mfma_f32_32x32x16_bf16 v[64:79], a[236:239], v[208:211], v[64:79]
    ds_read_b128 a[232:235], v0 offset:30720
    v_mul_f32 v47, v39, v47
    v_cvt_pk_bf16_f32 v99, v46, v47
    buffer_store_dwordx4 v[96:99], v0, s[8:11], s27 offen offset:0
    s_add_u32 s27, s27, 1024
    s_waitcnt lgkmcnt(5)
    v_mfma_f32_32x32x16_bf16 v[64:79], a[240:243], v[212:215], v[64:79]
    ds_read_b128 a[236:239], v0 offset:31744
    buffer_load_dwordx4 v0, s[8:11], s46 offen offset:3072 lds
    s_waitcnt lgkmcnt(15)
    v_fma_f32 v48, -v6, v80, v48
    v_fma_f32 v49, -v6, v81, v49
    v_mfma_f32_32x32x16_bf16 v[64:79], a[244:247], v[216:219], v[64:79]
    ds_read_b128 a[240:243], v0 offset:32768
    v_fma_f32 v50, -v6, v82, v50
    v_fma_f32 v51, -v6, v83, v51
    v_fma_f32 v52, -v6, v84, v52
    v_fma_f32 v53, -v6, v85, v53
    s_waitcnt lgkmcnt(5)
    v_mfma_f32_32x32x16_bf16 v[64:79], a[248:251], v[220:223], v[64:79]
    ds_read_b128 a[244:247], v0 offset:33792
    v_fma_f32 v54, -v6, v86, v54
    v_fma_f32 v55, -v6, v87, v55
    v_fma_f32 v56, -v6, v88, v56
    v_fma_f32 v57, -v6, v89, v57
    v_fma_f32 v58, -v6, v90, v58
    v_mfma_f32_32x32x16_bf16 v[64:79], a[252:255], v[224:227], v[64:79]
    ds_read_b128 a[248:251], v0 offset:34816
    s_add_u32 m0, s45, 90112
    s_add_u32 s46, s52, 176128
    buffer_load_dwordx4 v0, s[8:11], s46 offen offset:0 lds
    s_waitcnt lgkmcnt(5)
    v_mfma_f32_32x32x16_bf16 v[16:31], a[224:227], v[116:119], 0
    ds_read_b128 a[252:255], v0 offset:35840
    v_fma_f32 v59, -v6, v91, v59
    v_fma_f32 v60, -v6, v92, v60
    v_fma_f32 v61, -v6, v93, v61
    v_fma_f32 v62, -v6, v94, v62
    v_fma_f32 v63, -v6, v95, v63
    v_mfma_f32_32x32x16_bf16 v[16:31], a[228:231], v[120:123], v[16:31]
    ds_read_b128 a[224:227], v0 offset:36864
    ds_read_b128 v[80:83], v5 offset:12672
    ds_read_b128 v[84:87], v5 offset:12704
    ds_read_b128 v[88:91], v5 offset:12736
    ds_read_b128 v[92:95], v5 offset:12768
    s_waitcnt lgkmcnt(9)
    v_mfma_f32_32x32x16_bf16 v[16:31], a[232:235], v[124:127], v[16:31]
    ds_read_b128 a[228:231], v0 offset:37888
    buffer_load_dwordx4 v0, s[8:11], s46 offen offset:1024 lds
    v_mul_f32 v48, v9, v48
    v_mul_f32 v49, v9, v49
    v_mfma_f32_32x32x16_bf16 v[16:31], a[236:239], v[128:131], v[16:31]
    ds_read_b128 a[232:235], v0 offset:38912
    v_exp_f32 v48, v48
    v_mul_f32 v50, v9, v50
    s_waitcnt lgkmcnt(9)
    v_mfma_f32_32x32x16_bf16 v[16:31], a[240:243], v[132:135], v[16:31]
    ds_read_b128 a[236:239], v0 offset:39936
    v_exp_f32 v49, v49
    v_mul_f32 v51, v9, v51
    v_fma_f32 v48, v48, v7, v7
    v_mfma_f32_32x32x16_bf16 v[16:31], a[244:247], v[136:139], v[16:31]
    ds_read_b128 a[240:243], v0 offset:40960
    buffer_load_dwordx4 v0, s[8:11], s46 offen offset:2048 lds
    v_exp_f32 v50, v50
    s_waitcnt lgkmcnt(9)
    v_mfma_f32_32x32x16_bf16 v[16:31], a[248:251], v[140:143], v[16:31]
    ds_read_b128 a[244:247], v0 offset:41984
    v_mul_f32 v52, v9, v52
    v_fma_f32 v49, v49, v7, v7
    v_rcp_f32 v48, v48
    v_mfma_f32_32x32x16_bf16 v[16:31], a[252:255], v[144:147], v[16:31]
    ds_read_b128 a[248:251], v0 offset:43008
    v_exp_f32 v51, v51
    v_mul_f32 v53, v9, v53
    v_fma_f32 v50, v50, v7, v7
    s_waitcnt lgkmcnt(5)
    v_mfma_f32_32x32x16_bf16 v[16:31], a[224:227], v[148:151], v[16:31]
    ds_read_b128 a[252:255], v0 offset:44032
    v_rcp_f32 v49, v49
    v_mul_f32 v56, v48, v56
    v_exp_f32 v52, v52
    v_mfma_f32_32x32x16_bf16 v[16:31], a[228:231], v[152:155], v[16:31]
    ds_read_b128 a[224:227], v0 offset:45056
    v_mul_f32 v54, v9, v54
    v_fma_f32 v51, v51, v7, v7
    v_rcp_f32 v50, v50
    s_waitcnt lgkmcnt(5)
    v_mfma_f32_32x32x16_bf16 v[16:31], a[232:235], v[156:159], v[16:31]
    ds_read_b128 a[228:231], v0 offset:46080
    v_mul_f32 v57, v49, v57
    v_exp_f32 v53, v53
    v_mul_f32 v55, v9, v55
    v_fma_f32 v52, v52, v7, v7
    v_mfma_f32_32x32x16_bf16 v[16:31], a[236:239], v[160:163], v[16:31]
    ds_read_b128 a[232:235], v0 offset:47104
    v_rcp_f32 v51, v51
    v_mul_f32 v58, v50, v58
    v_cvt_pk_bf16_f32 v96, v56, v57
    s_waitcnt lgkmcnt(5)
    v_mfma_f32_32x32x16_bf16 v[16:31], a[240:243], v[164:167], v[16:31]
    ds_read_b128 a[236:239], v0 offset:48128
    v_exp_f32 v54, v54
    v_fma_f32 v53, v53, v7, v7
    v_rcp_f32 v52, v52
    v_mfma_f32_32x32x16_bf16 v[16:31], a[244:247], v[168:171], v[16:31]
    ds_read_b128 a[240:243], v0 offset:49152
    v_mul_f32 v59, v51, v59
    v_exp_f32 v55, v55
    v_fma_f32 v54, v54, v7, v7
    s_waitcnt lgkmcnt(5)
    v_mfma_f32_32x32x16_bf16 v[16:31], a[248:251], v[172:175], v[16:31]
    ds_read_b128 a[244:247], v0 offset:50176
    v_rcp_f32 v53, v53
    v_mul_f32 v60, v52, v60
    v_cvt_pk_bf16_f32 v97, v58, v59
    v_fma_f32 v55, v55, v7, v7
    v_mfma_f32_32x32x16_bf16 v[16:31], a[252:255], v[176:179], v[16:31]
    ds_read_b128 a[248:251], v0 offset:51200
    v_rcp_f32 v54, v54
    v_mul_f32 v61, v53, v61
    s_waitcnt lgkmcnt(5)
    v_mfma_f32_32x32x16_bf16 v[16:31], a[224:227], v[180:183], v[16:31]
    ds_read_b128 a[252:255], v0 offset:52224
    v_rcp_f32 v55, v55
    v_mul_f32 v62, v54, v62
    v_cvt_pk_bf16_f32 v98, v60, v61
    v_mul_f32 v63, v55, v63
    v_mfma_f32_32x32x16_bf16 v[16:31], a[228:231], v[184:187], v[16:31]
    ds_read_b128 a[224:227], v0 offset:53248
    v_cvt_pk_bf16_f32 v99, v62, v63
    buffer_store_dwordx4 v[96:99], v0, s[8:11], s27 offen offset:0
    s_add_u32 s27, s27, 1024
    s_waitcnt lgkmcnt(15)
    s_waitcnt lgkmcnt(5)
    v_mfma_f32_32x32x16_bf16 v[16:31], a[232:235], v[188:191], v[16:31]
    ds_read_b128 a[228:231], v0 offset:54272
    v_fma_f32 v64, -v6, v80, v64
    v_fma_f32 v65, -v6, v81, v65
    v_fma_f32 v66, -v6, v82, v66
    v_fma_f32 v67, -v6, v83, v67
    v_fma_f32 v68, -v6, v84, v68
    v_mfma_f32_32x32x16_bf16 v[16:31], a[236:239], v[192:195], v[16:31]
    ds_read_b128 a[232:235], v0 offset:55296
    v_fma_f32 v69, -v6, v85, v69
    v_fma_f32 v70, -v6, v86, v70
    v_fma_f32 v71, -v6, v87, v71
    v_fma_f32 v72, -v6, v88, v72
    s_waitcnt lgkmcnt(5)
    v_mfma_f32_32x32x16_bf16 v[16:31], a[240:243], v[196:199], v[16:31]
    ds_read_b128 a[236:239], v0 offset:56320
    s_waitcnt vmcnt(9)
    s_barrier
    v_fma_f32 v73, -v6, v89, v73
    v_fma_f32 v74, -v6, v90, v74
    v_fma_f32 v75, -v6, v91, v75
    v_fma_f32 v76, -v6, v92, v76
    v_fma_f32 v77, -v6, v93, v77
    v_mfma_f32_32x32x16_bf16 v[16:31], a[244:247], v[200:203], v[16:31]
    ds_read_b128 a[240:243], v0 offset:57344
    v_fma_f32 v78, -v6, v94, v78
    v_fma_f32 v79, -v6, v95, v79
    s_waitcnt lgkmcnt(5)
    v_mfma_f32_32x32x16_bf16 v[16:31], a[248:251], v[204:207], v[16:31]
    ds_read_b128 a[244:247], v0 offset:58368
    ds_read_b128 v[80:83], v5 offset:12800
    ds_read_b128 v[84:87], v5 offset:12832
    ds_read_b128 v[88:91], v5 offset:12864
    ds_read_b128 v[92:95], v5 offset:12896
    v_mul_f32 v64, v9, v64
    v_mfma_f32_32x32x16_bf16 v[16:31], a[252:255], v[208:211], v[16:31]
    ds_read_b128 a[248:251], v0 offset:59392
    v_mul_f32 v65, v9, v65
    v_exp_f32 v64, v64
    v_mul_f32 v66, v9, v66
    s_waitcnt lgkmcnt(9)
    v_mfma_f32_32x32x16_bf16 v[16:31], a[224:227], v[212:215], v[16:31]
    ds_read_b128 a[252:255], v0 offset:60416
    v_exp_f32 v65, v65
    v_mul_f32 v67, v9, v67
    v_fma_f32 v64, v64, v7, v7
    v_mfma_f32_32x32x16_bf16 v[16:31], a[228:231], v[216:219], v[16:31]
    ds_read_b128 a[224:227], v0 offset:61440
    v_exp_f32 v66, v66
    v_mul_f32 v68, v9, v68
    v_fma_f32 v65, v65, v7, v7
    s_waitcnt lgkmcnt(9)
    v_mfma_f32_32x32x16_bf16 v[16:31], a[232:235], v[220:223], v[16:31]
    ds_read_b128 a[228:231], v0 offset:62464
    v_rcp_f32 v64, v64
    v_exp_f32 v67, v67
    v_mul_f32 v69, v9, v69
    v_mfma_f32_32x32x16_bf16 v[16:31], a[236:239], v[224:227], v[16:31]
    ds_read_b128 a[232:235], v0 offset:63488
    v_fma_f32 v66, v66, v7, v7
    v_rcp_f32 v65, v65
    v_mul_f32 v72, v64, v72
    s_waitcnt lgkmcnt(9)
    v_mfma_f32_32x32x16_bf16 v[32:47], a[240:243], v[116:119], 0
    ds_read_b128 a[236:239], v0 offset:64512
    v_exp_f32 v68, v68
    v_mul_f32 v70, v9, v70
    v_fma_f32 v67, v67, v7, v7
    v_mfma_f32_32x32x16_bf16 v[32:47], a[244:247], v[120:123], v[32:47]
    ds_read_b128 a[240:243], v3 offset:0
    v_rcp_f32 v66, v66
    v_mul_f32 v73, v65, v73
    s_waitcnt lgkmcnt(5)
    v_mfma_f32_32x32x16_bf16 v[32:47], a[248:251], v[124:127], v[32:47]
    ds_read_b128 a[244:247], v3 offset:1024
    v_exp_f32 v69, v69
    v_mul_f32 v71, v9, v71
    v_fma_f32 v68, v68, v7, v7
    v_mfma_f32_32x32x16_bf16 v[32:47], a[252:255], v[128:131], v[32:47]
    ds_read_b128 a[248:251], v3 offset:2048
    v_rcp_f32 v67, v67
    v_mul_f32 v74, v66, v74
    v_cvt_pk_bf16_f32 v96, v72, v73
    s_waitcnt lgkmcnt(5)
    v_mfma_f32_32x32x16_bf16 v[32:47], a[224:227], v[132:135], v[32:47]
    ds_read_b128 a[252:255], v3 offset:3072
    v_exp_f32 v70, v70
    v_fma_f32 v69, v69, v7, v7
    v_rcp_f32 v68, v68
    v_mul_f32 v75, v67, v75
    v_mfma_f32_32x32x16_bf16 v[32:47], a[228:231], v[136:139], v[32:47]
    ds_read_b128 a[224:227], v3 offset:4096
    v_exp_f32 v71, v71
    v_fma_f32 v70, v70, v7, v7
    v_rcp_f32 v69, v69
    s_waitcnt lgkmcnt(5)
    v_mfma_f32_32x32x16_bf16 v[32:47], a[232:235], v[140:143], v[32:47]
    ds_read_b128 a[228:231], v3 offset:5120
    v_mul_f32 v76, v68, v76
    v_cvt_pk_bf16_f32 v97, v74, v75
    v_fma_f32 v71, v71, v7, v7
    v_rcp_f32 v70, v70
    v_mul_f32 v77, v69, v77
    v_mfma_f32_32x32x16_bf16 v[32:47], a[236:239], v[144:147], v[32:47]
    ds_read_b128 a[232:235], v3 offset:6144
    v_rcp_f32 v71, v71
    v_mul_f32 v78, v70, v78
    v_cvt_pk_bf16_f32 v98, v76, v77
    v_mul_f32 v79, v71, v79
    s_waitcnt lgkmcnt(5)
    v_mfma_f32_32x32x16_bf16 v[32:47], a[240:243], v[148:151], v[32:47]
    ds_read_b128 a[236:239], v3 offset:7168
    v_cvt_pk_bf16_f32 v99, v78, v79
    buffer_store_dwordx4 v[96:99], v0, s[8:11], s27 offen offset:0
    s_add_u32 s27, s27, 1024
    s_waitcnt lgkmcnt(14)
    v_fma_f32 v16, -v6, v80, v16
    v_fma_f32 v17, -v6, v81, v17
    v_mfma_f32_32x32x16_bf16 v[32:47], a[244:247], v[152:155], v[32:47]
    ds_read_b128 a[240:243], v3 offset:8192
    v_fma_f32 v18, -v6, v82, v18
    v_fma_f32 v19, -v6, v83, v19
    v_fma_f32 v20, -v6, v84, v20
    v_fma_f32 v21, -v6, v85, v21
    v_fma_f32 v22, -v6, v86, v22
    s_waitcnt lgkmcnt(5)
    v_mfma_f32_32x32x16_bf16 v[32:47], a[248:251], v[156:159], v[32:47]
    ds_read_b128 a[244:247], v3 offset:9216
    v_fma_f32 v23, -v6, v87, v23
    v_fma_f32 v24, -v6, v88, v24
    v_fma_f32 v25, -v6, v89, v25
    v_fma_f32 v26, -v6, v90, v26
    v_fma_f32 v27, -v6, v91, v27
    v_fma_f32 v28, -v6, v92, v28
    v_mfma_f32_32x32x16_bf16 v[32:47], a[252:255], v[160:163], v[32:47]
    ds_read_b128 a[248:251], v3 offset:10240
    v_fma_f32 v29, -v6, v93, v29
    v_fma_f32 v30, -v6, v94, v30
    v_fma_f32 v31, -v6, v95, v31
    s_waitcnt lgkmcnt(5)
    v_mfma_f32_32x32x16_bf16 v[32:47], a[224:227], v[164:167], v[32:47]
    ds_read_b128 a[252:255], v3 offset:11264
    ds_read_b128 v[80:83], v249 offset:12928
    ds_read_b128 v[84:87], v249 offset:12960
    ds_read_b128 v[88:91], v249 offset:12992
    ds_read_b128 v[92:95], v249 offset:13024
    v_mul_f32 v16, v9, v16
    v_mul_f32 v17, v9, v17
    v_mfma_f32_32x32x16_bf16 v[32:47], a[228:231], v[168:171], v[32:47]
    ds_read_b128 a[224:227], v3 offset:12288
    v_exp_f32 v16, v16
    v_mul_f32 v18, v9, v18
    v_exp_f32 v17, v17
    s_waitcnt lgkmcnt(9)
    v_mfma_f32_32x32x16_bf16 v[32:47], a[232:235], v[172:175], v[32:47]
    ds_read_b128 a[228:231], v3 offset:13312
    v_mul_f32 v19, v9, v19
    v_fma_f32 v16, v16, v7, v7
    v_exp_f32 v18, v18
    v_mul_f32 v20, v9, v20
    v_fma_f32 v17, v17, v7, v7
    v_mfma_f32_32x32x16_bf16 v[32:47], a[236:239], v[176:179], v[32:47]
    ds_read_b128 a[232:235], v3 offset:14336
    v_rcp_f32 v16, v16
    v_exp_f32 v19, v19
    v_mul_f32 v21, v9, v21
    s_waitcnt lgkmcnt(9)
    v_mfma_f32_32x32x16_bf16 v[32:47], a[240:243], v[180:183], v[32:47]
    ds_read_b128 a[236:239], v3 offset:15360
    v_fma_f32 v18, v18, v7, v7
    v_rcp_f32 v17, v17
    v_mul_f32 v24, v16, v24
    v_exp_f32 v20, v20
    v_mfma_f32_32x32x16_bf16 v[32:47], a[244:247], v[184:187], v[32:47]
    ds_read_b128 a[240:243], v3 offset:16384
    v_mul_f32 v22, v9, v22
    v_fma_f32 v19, v19, v7, v7
    v_rcp_f32 v18, v18
    s_waitcnt lgkmcnt(9)
    v_mfma_f32_32x32x16_bf16 v[32:47], a[248:251], v[188:191], v[32:47]
    ds_read_b128 a[244:247], v3 offset:17408
    s_waitcnt vmcnt(2)
    s_barrier
    s_waitcnt vmcnt(0)
    v_mov_b32 v14, s36
    v_mov_b32 v15, 0
    s_cmp_lg_u32 s33, 0
    s_cbranch_scc1 Lps_54
    s_mov_b64 exec, 1
    buffer_store_dword v14, v15, s[8:11], s35 offen
    s_branch Lpd_55
Lps_54:
    s_waitcnt vmcnt(0)
    buffer_wbl2 sc1
    s_waitcnt vmcnt(0)
    s_mov_b64 exec, 1
    buffer_store_dword v14, v15, s[8:11], s35 offen sc1
Lpd_55:
    s_mov_b64 exec, -1
    s_add_u32 s36, s36, 1
    v_mul_f32 v25, v17, v25
    v_mfma_f32_32x32x16_bf16 v[32:47], a[252:255], v[192:195], v[32:47]
    ds_read_b128 a[248:251], v3 offset:18432
    v_exp_f32 v21, v21
    v_mul_f32 v23, v9, v23
    v_fma_f32 v20, v20, v7, v7
    s_waitcnt lgkmcnt(5)
    v_mfma_f32_32x32x16_bf16 v[32:47], a[224:227], v[196:199], v[32:47]
    ds_read_b128 a[252:255], v3 offset:19456
    v_rcp_f32 v19, v19
    v_mul_f32 v26, v18, v26
    v_cvt_pk_bf16_f32 v96, v24, v25
    v_exp_f32 v22, v22
    v_mfma_f32_32x32x16_bf16 v[32:47], a[228:231], v[200:203], v[32:47]
    ds_read_b128 a[224:227], v3 offset:20480
    s_lshl_b32 s24, s3, 4
    s_lshl_b32 s25, s40, 1
    s_add_u32 s24, s24, s25
    s_mov_b32 s42, 0x3333
    s_mov_b32 s43, 0
    s_lshl_b64 s[42:43], s[42:43], s24
    s_add_u32 s44, s38, s25
    s_lshr_b32 s45, s3, 1
    s_add_u32 s45, s45, s44
    s_and_b32 s46, s3, 1
    s_lshl_b32 s47, s41, 1
    s_add_u32 s46, s46, s47
    s_mul_i32 s47, s45, 28672
    s_lshl_b32 s48, s46, 11
    s_add_u32 s47, s47, s48
    s_add_u32 s49, s47, 5809152
    s_mul_i32 s24, s44, 114688
    s_mul_i32 s25, s3, 28672
    s_add_u32 s24, s24, s25
    s_add_u32 s24, s24, 7873536
    s_add_u32 s25, s24, 114688
    s_bitcmp1_b32 s3, 1
    s_cselect_b32 s26, s25, s24
    s_cselect_b32 s25, s24, s25
    s_mov_b32 s24, s26
    buffer_load_dword v12, v13, s[8:11], s34 offen sc1
    s_waitcnt lgkmcnt(5)
    v_mfma_f32_32x32x16_bf16 v[32:47], a[232:235], v[204:207], v[32:47]
    ds_read_b128 a[228:231], v3 offset:21504
    v_fma_f32 v21, v21, v7, v7
    v_rcp_f32 v20, v20
    v_mul_f32 v27, v19, v27
    v_exp_f32 v23, v23
    v_mfma_f32_32x32x16_bf16 v[32:47], a[236:239], v[208:211], v[32:47]
    ds_read_b128 a[232:235], v3 offset:22528
    v_fma_f32 v22, v22, v7, v7
    v_rcp_f32 v21, v21
    v_mul_f32 v28, v20, v28
    s_waitcnt lgkmcnt(5)
    v_mfma_f32_32x32x16_bf16 v[32:47], a[240:243], v[212:215], v[32:47]
    ds_read_b128 a[236:239], v3 offset:23552
    v_cvt_pk_bf16_f32 v97, v26, v27
    v_fma_f32 v23, v23, v7, v7
    v_rcp_f32 v22, v22
    v_mul_f32 v29, v21, v29
    v_mfma_f32_32x32x16_bf16 v[32:47], a[244:247], v[216:219], v[32:47]
    ds_read_b128 a[240:243], v3 offset:24576
    v_rcp_f32 v23, v23
    v_mul_f32 v30, v22, v30
    v_cvt_pk_bf16_f32 v98, v28, v29
    s_waitcnt lgkmcnt(5)
    v_mfma_f32_32x32x16_bf16 v[32:47], a[248:251], v[220:223], v[32:47]
    ds_read_b128 a[244:247], v3 offset:25600
    v_mul_f32 v31, v23, v31
    v_cvt_pk_bf16_f32 v99, v30, v31
    buffer_store_dwordx4 v[96:99], v0, s[8:11], s27 offen offset:0
    s_add_u32 s27, s27, 1024
    v_mfma_f32_32x32x16_bf16 v[32:47], a[252:255], v[224:227], v[32:47]
    ds_read_b128 a[248:251], v3 offset:26624
    s_waitcnt lgkmcnt(5)
    v_mfma_f32_32x32x16_bf16 v[232:247], a[224:227], v[116:119], 0
    ds_read_b128 a[252:255], v3 offset:27648
    v_mfma_f32_32x32x16_bf16 v[232:247], a[228:231], v[120:123], v[232:247]
    ds_read_b128 a[224:227], v3 offset:28672
    s_waitcnt lgkmcnt(5)
    v_mfma_f32_32x32x16_bf16 v[232:247], a[232:235], v[124:127], v[232:247]
    ds_read_b128 a[228:231], v3 offset:29696
    v_mfma_f32_32x32x16_bf16 v[232:247], a[236:239], v[128:131], v[232:247]
    ds_read_b128 a[232:235], v3 offset:30720
    s_sub_u32 s36, s36, 1
    s_waitcnt vmcnt(1)
    v_subrev_u32 v12, s36, v12
    v_cmp_lt_u32 vcc, 15, v12
    s_and_b64 vcc, vcc, s[42:43]
    s_or_b32 s30, vcc_lo, vcc_hi
    s_or_b32 s30, s30, s33
    s_cbranch_scc0 Lck_56
    s_mov_b64 exec, s[42:43]
Lw_57:
    s_add_u32 s39, s39, 1
    s_cmp_gt_u32 s39, 1048576
    s_cbranch_scc1 Lwx_58
    buffer_load_dword v14, v13, s[8:11], s34 offen sc1
    s_waitcnt vmcnt(0)
    v_subrev_u32 v14, s36, v14
    v_cmp_lt_u32 vcc, 15, v14
    s_cbranch_vccnz Lw_57
Lwx_58:
    s_mov_b64 exec, -1
    s_cmp_eq_u32 s33, 0
    s_cbranch_scc1 Lwf_59
    buffer_inv sc1
    s_waitcnt vmcnt(0)
Lwf_59:
Lck_56:
    s_add_u32 s36, s36, 1
    s_waitcnt lgkmcnt(5)
    v_mfma_f32_32x32x16_bf16 v[232:247], a[240:243], v[132:135], v[232:247]
    ds_read_b128 a[236:239], v3 offset:31744
    buffer_load_dwordx4 v[64:67], v0, s[8:11], s49 offen offset:0 sc1
    s_waitcnt lgkmcnt(15)
    v_fma_f32 v32, -v6, v80, v32
    v_fma_f32 v33, -v6, v81, v33
    v_fma_f32 v34, -v6, v82, v34
    v_mfma_f32_32x32x16_bf16 v[232:247], a[244:247], v[136:139], v[232:247]
    ds_read_b128 a[240:243], v3 offset:32768
    v_fma_f32 v35, -v6, v83, v35
    v_fma_f32 v36, -v6, v84, v36
    v_fma_f32 v37, -v6, v85, v37
    v_fma_f32 v38, -v6, v86, v38
    s_waitcnt lgkmcnt(5)
    v_mfma_f32_32x32x16_bf16 v[232:247], a[248:251], v[140:143], v[232:247]
    ds_read_b128 a[244:247], v3 offset:33792
    buffer_load_dwordx4 v[68:71], v0, s[8:11], s49 offen offset:1024 sc1
    v_fma_f32 v39, -v6, v87, v39
    v_fma_f32 v40, -v6, v88, v40
    v_fma_f32 v41, -v6, v89, v41
    v_mfma_f32_32x32x16_bf16 v[232:247], a[252:255], v[144:147], v[232:247]
    ds_read_b128 a[248:251], v3 offset:34816
    v_fma_f32 v42, -v6, v90, v42
    v_fma_f32 v43, -v6, v91, v43
    v_fma_f32 v44, -v6, v92, v44
    v_fma_f32 v45, -v6, v93, v45
    s_waitcnt lgkmcnt(5)
    v_mfma_f32_32x32x16_bf16 v[232:247], a[224:227], v[148:151], v[232:247]
    ds_read_b128 a[252:255], v3 offset:35840
    s_add_u32 s28, s24, 0
    buffer_load_dwordx4 v[100:103], v0, s[8:11], s28 offen offset:0 sc1
    v_fma_f32 v46, -v6, v94, v46
    v_fma_f32 v47, -v6, v95, v47
    v_mfma_f32_32x32x16_bf16 v[232:247], a[228:231], v[152:155], v[232:247]
    ds_read_b128 a[224:227], v3 offset:36864
    ds_read_b128 v[80:83], v249 offset:13056
    ds_read_b128 v[84:87], v249 offset:13088
    ds_read_b128 v[88:91], v249 offset:13120
    ds_read_b128 v[92:95], v249 offset:13152
    s_waitcnt lgkmcnt(9)
    v_mfma_f32_32x32x16_bf16 v[232:247], a[232:235], v[156:159], v[232:247]
    ds_read_b128 a[228:231], v3 offset:37888
    s_add_u32 s29, s25, 0
    buffer_load_dwordx4 v[104:107], v0, s[8:11], s29 offen offset:0 sc1
    v_mul_f32 v32, v9, v32
    v_mul_f32 v33, v9, v33
    v_mfma_f32_32x32x16_bf16 v[232:247], a[236:239], v[160:163], v[232:247]
    ds_read_b128 a[232:235], v3 offset:38912
    v_exp_f32 v32, v32
    v_mul_f32 v34, v9, v34
    s_waitcnt lgkmcnt(9)
    v_mfma_f32_32x32x16_bf16 v[232:247], a[240:243], v[164:167], v[232:247]
    ds_read_b128 a[236:239], v3 offset:39936
    buffer_load_dwordx4 v[108:111], v0, s[8:11], s28 offen offset:1024 sc1
    v_exp_f32 v33, v33
    v_mul_f32 v35, v9, v35
    v_mfma_f32_32x32x16_bf16 v[232:247], a[244:247], v[168:171], v[232:247]
    ds_read_b128 a[240:243], v3 offset:40960
    v_fma_f32 v32, v32, v7, v7
    v_exp_f32 v34, v34
    v_mul_f32 v36, v9, v36
    s_waitcnt lgkmcnt(9)
    v_mfma_f32_32x32x16_bf16 v[232:247], a[248:251], v[172:175], v[232:247]
    ds_read_b128 a[244:247], v3 offset:41984
    buffer_load_dwordx4 v[112:115], v0, s[8:11], s29 offen offset:1024 sc1
    v_fma_f32 v33, v33, v7, v7
    v_rcp_f32 v32, v32
    v_mfma_f32_32x32x16_bf16 v[232:247], a[252:255], v[176:179], v[232:247]
    ds_read_b128 a[248:251], v3 offset:43008
    v_exp_f32 v35, v35
    v_mul_f32 v37, v9, v37
    v_fma_f32 v34, v34, v7, v7
    s_waitcnt lgkmcnt(5)
    v_mfma_f32_32x32x16_bf16 v[232:247], a[224:227], v[180:183], v[232:247]
    ds_read_b128 a[252:255], v3 offset:44032
    buffer_load_dwordx4 v[116:119], v0, s[8:11], s28 offen offset:2048 sc1
    v_rcp_f32 v33, v33
    v_mul_f32 v40, v32, v40
    v_mfma_f32_32x32x16_bf16 v[232:247], a[228:231], v[184:187], v[232:247]
    ds_read_b128 a[224:227], v3 offset:45056
    v_exp_f32 v36, v36
    v_mul_f32 v38, v9, v38
    v_fma_f32 v35, v35, v7, v7
    s_waitcnt lgkmcnt(5)
    v_mfma_f32_32x32x16_bf16 v[232:247], a[232:235], v[188:191], v[232:247]
    ds_read_b128 a[228:231], v3 offset:46080
    buffer_load_dwordx4 v[120:123], v0, s[8:11], s29 offen offset:2048 sc1
    v_rcp_f32 v34, v34
    v_mul_f32 v41, v33, v41
    v_mfma_f32_32x32x16_bf16 v[232:247], a[236:239], v[192:195], v[232:247]
    ds_read_b128 a[232:235], v3 offset:47104
    v_exp_f32 v37, v37
    v_mul_f32 v39, v9, v39
    v_fma_f32 v36, v36, v7, v7
    s_waitcnt lgkmcnt(5)
    v_mfma_f32_32x32x16_bf16 v[232:247], a[240:243], v[196:199], v[232:247]
    ds_read_b128 a[236:239], v3 offset:48128
    buffer_load_dwordx4 v[124:127], v0, s[8:11], s28 offen offset:3072 sc1
    v_rcp_f32 v35, v35
    v_mul_f32 v42, v34, v42
    v_cvt_pk_bf16_f32 v96, v40, v41
    v_mfma_f32_32x32x16_bf16 v[232:247], a[244:247], v[200:203], v[232:247]
    v_exp_f32 v38, v38
    v_fma_f32 v37, v37, v7, v7
    s_waitcnt lgkmcnt(4)
    v_mfma_f32_32x32x16_bf16 v[232:247], a[248:251], v[204:207], v[232:247]
    buffer_load_dwordx4 v[128:131], v0, s[8:11], s29 offen offset:3072 sc1
    v_rcp_f32 v36, v36
    v_mul_f32 v43, v35, v43
    v_mfma_f32_32x32x16_bf16 v[232:247], a[252:255], v[208:211], v[232:247]
    v_exp_f32 v39, v39
    v_fma_f32 v38, v38, v7, v7
    v_rcp_f32 v37, v37
    s_waitcnt lgkmcnt(2)
    v_mfma_f32_32x32x16_bf16 v[232:247], a[224:227], v[212:215], v[232:247]
    s_add_u32 s28, s24, 7168
    buffer_load_dwordx4 v[132:135], v0, s[8:11], s28 offen offset:0 sc1
    v_mul_f32 v44, v36, v44
    v_cvt_pk_bf16_f32 v97, v42, v43
    v_fma_f32 v39, v39, v7, v7
    v_mfma_f32_32x32x16_bf16 v[232:247], a[228:231], v[216:219], v[232:247]
    v_rcp_f32 v38, v38
    v_mul_f32 v45, v37, v45
    v_rcp_f32 v39, v39
    s_waitcnt lgkmcnt(0)
    v_mfma_f32_32x32x16_bf16 v[232:247], a[232:235], v[220:223], v[232:247]
    s_add_u32 s29, s25, 7168
    buffer_load_dwordx4 v[136:139], v0, s[8:11], s29 offen offset:0 sc1
    v_mul_f32 v46, v38, v46
    v_cvt_pk_bf16_f32 v98, v44, v45
    v_mul_f32 v47, v39, v47
    v_mfma_f32_32x32x16_bf16 v[232:247], a[236:239], v[224:227], v[232:247]
    v_cvt_pk_bf16_f32 v99, v46, v47
    buffer_store_dwordx4 v[96:99], v0, s[8:11], s27 offen offset:0
    s_add_u32 s27, s27, 1024
    s_waitcnt lgkmcnt(11)
    s_cmp_lg_u32 s37, 0
    s_cbranch_scc1 Ldown_60
    s_cmp_lt_u32 s6, 14
    s_cbranch_scc1 Lgo_64
    s_nop 10
    v_fma_f32 v232, -v6, v80, v232
    v_fma_f32 v233, -v6, v81, v233
    v_fma_f32 v234, -v6, v82, v234
    v_fma_f32 v235, -v6, v83, v235
    v_fma_f32 v236, -v6, v84, v236
    v_fma_f32 v237, -v6, v85, v237
    v_fma_f32 v238, -v6, v86, v238
    v_fma_f32 v239, -v6, v87, v239
    v_fma_f32 v240, -v6, v88, v240
    v_fma_f32 v241, -v6, v89, v241
    v_fma_f32 v242, -v6, v90, v242
    v_fma_f32 v243, -v6, v91, v243
    v_fma_f32 v244, -v6, v92, v244
    v_fma_f32 v245, -v6, v93, v245
    v_fma_f32 v246, -v6, v94, v246
    v_fma_f32 v247, -v6, v95, v247
    v_mul_f32 v232, v9, v232
    v_mul_f32 v233, v9, v233
    v_exp_f32 v232, v232
    v_mul_f32 v234, v9, v234
    v_exp_f32 v233, v233
    v_mul_f32 v235, v9, v235
    v_fma_f32 v232, v232, v7, v7
    v_exp_f32 v234, v234
    v_mul_f32 v236, v9, v236
    v_fma_f32 v233, v233, v7, v7
    v_rcp_f32 v232, v232
    v_exp_f32 v235, v235
    v_mul_f32 v237, v9, v237
    v_fma_f32 v234, v234, v7, v7
    v_rcp_f32 v233, v233
    v_mul_f32 v240, v232, v240
    v_exp_f32 v236, v236
    v_mul_f32 v238, v9, v238
    v_fma_f32 v235, v235, v7, v7
    v_rcp_f32 v234, v234
    v_mul_f32 v241, v233, v241
    v_exp_f32 v237, v237
    v_mul_f32 v239, v9, v239
    v_fma_f32 v236, v236, v7, v7
    v_rcp_f32 v235, v235
    v_mul_f32 v242, v234, v242
    v_cvt_pk_bf16_f32 v96, v240, v241
    v_exp_f32 v238, v238
    v_fma_f32 v237, v237, v7, v7
    v_rcp_f32 v236, v236
    v_mul_f32 v243, v235, v243
    v_exp_f32 v239, v239
    v_fma_f32 v238, v238, v7, v7
    v_rcp_f32 v237, v237
    v_mul_f32 v244, v236, v244
    v_cvt_pk_bf16_f32 v97, v242, v243
    v_fma_f32 v239, v239, v7, v7
    v_rcp_f32 v238, v238
    v_mul_f32 v245, v237, v245
    v_rcp_f32 v239, v239
    v_mul_f32 v246, v238, v246
    v_cvt_pk_bf16_f32 v98, v244, v245
    v_mul_f32 v247, v239, v247
    v_cvt_pk_bf16_f32 v99, v246, v247
    buffer_store_dwordx4 v[96:99], v0, s[8:11], s27 offen offset:0
    s_add_u32 s36, s36, 1
    s_waitcnt vmcnt(0)
    v_mov_b32 v14, s36
    v_mov_b32 v15, 0
    s_cmp_lg_u32 s33, 0
    s_cbranch_scc1 Lps_65
    s_mov_b64 exec, 1
    buffer_store_dword v14, v15, s[8:11], s35 offen
    s_branch Lpd_66
Lps_65:
    s_waitcnt vmcnt(0)
    buffer_wbl2 sc1
    s_waitcnt vmcnt(0)
    s_mov_b64 exec, 1
    buffer_store_dword v14, v15, s[8:11], s35 offen sc1
Lpd_66:
    s_mov_b64 exec, -1
    s_add_u32 s36, s36, 1
    s_branch Lskip_61
Lgo_64:
    s_waitcnt vmcnt(11)
    v_lshlrev_b32 v16, 16, v64
    v_and_b32 v17, 0xffff0000, v64
    v_lshlrev_b32 v18, 16, v65
    v_and_b32 v19, 0xffff0000, v65
    v_lshlrev_b32 v20, 16, v66
    v_and_b32 v21, 0xffff0000, v66
    v_lshlrev_b32 v22, 16, v67
    v_and_b32 v23, 0xffff0000, v67
    v_lshlrev_b32 v24, 16, v68
    v_and_b32 v25, 0xffff0000, v68
    v_lshlrev_b32 v26, 16, v69
    v_and_b32 v27, 0xffff0000, v69
    v_lshlrev_b32 v28, 16, v70
    v_and_b32 v29, 0xffff0000, v70
    v_lshlrev_b32 v30, 16, v71
    v_and_b32 v31, 0xffff0000, v71
    s_waitcnt vmcnt(10)
    v_mfma_f32_32x32x16_bf16 v[16:31], a[0:3], v[100:103], v[16:31]
    v_fma_f32 v232, -v6, v80, v232
    v_fma_f32 v233, -v6, v81, v233
    v_fma_f32 v234, -v6, v82, v234
    v_fma_f32 v235, -v6, v83, v235
    v_fma_f32 v236, -v6, v84, v236
    v_mfma_f32_32x32x16_bf16 v[32:47], a[4:7], v[100:103], 0
    v_fma_f32 v237, -v6, v85, v237
    v_fma_f32 v238, -v6, v86, v238
    v_fma_f32 v239, -v6, v87, v239
    v_fma_f32 v240, -v6, v88, v240
    s_waitcnt vmcnt(0)
    v_mov_b32 v14, s36
    v_mov_b32 v15, 0
    s_cmp_lg_u32 s33, 0
    s_cbranch_scc1 Lps_67
    s_mov_b64 exec, 1
    buffer_store_dword v14, v15, s[8:11], s35 offen
    s_branch Lpd_68
Lps_67:
    s_waitcnt vmcnt(0)
    buffer_wbl2 sc1
    s_waitcnt vmcnt(0)
    s_mov_b64 exec, 1
    buffer_store_dword v14, v15, s[8:11], s35 offen sc1
Lpd_68:
    s_mov_b64 exec, -1
    s_add_u32 s36, s36, 1
    buffer_load_dwordx4 v[140:143], v0, s[8:11], s28 offen offset:1024 sc1
    s_waitcnt vmcnt(11)
    v_mfma_f32_32x32x16_bf16 v[48:63], a[0:3], v[104:107], 0
    v_fma_f32 v241, -v6, v89, v241
    v_fma_f32 v242, -v6, v90, v242
    v_fma_f32 v243, -v6, v91, v243
    v_fma_f32 v244, -v6, v92, v244
    v_fma_f32 v245, -v6, v93, v245
    v_mfma_f32_32x32x16_bf16 v[64:79], a[4:7], v[104:107], 0
    v_fma_f32 v246, -v6, v94, v246
    v_fma_f32 v247, -v6, v95, v247
    v_mul_f32 v232, v9, v232
    v_mul_f32 v233, v9, v233
    buffer_load_dwordx4 v[144:147], v0, s[8:11], s29 offen offset:1024 sc1
    s_waitcnt vmcnt(11)
    v_mfma_f32_32x32x16_bf16 v[16:31], a[8:11], v[108:111], v[16:31]
    v_exp_f32 v232, v232
    v_mul_f32 v234, v9, v234
    v_exp_f32 v233, v233
    v_mfma_f32_32x32x16_bf16 v[32:47], a[12:15], v[108:111], v[32:47]
    v_mul_f32 v235, v9, v235
    v_fma_f32 v232, v232, v7, v7
    v_exp_f32 v234, v234
    buffer_load_dwordx4 v[148:151], v0, s[8:11], s28 offen offset:2048 sc1
    s_waitcnt vmcnt(11)
    v_mfma_f32_32x32x16_bf16 v[48:63], a[8:11], v[112:115], v[48:63]
    v_mul_f32 v236, v9, v236
    v_fma_f32 v233, v233, v7, v7
    v_rcp_f32 v232, v232
    v_mfma_f32_32x32x16_bf16 v[64:79], a[12:15], v[112:115], v[64:79]
    v_exp_f32 v235, v235
    v_mul_f32 v237, v9, v237
    v_fma_f32 v234, v234, v7, v7
    buffer_load_dwordx4 v[152:155], v0, s[8:11], s29 offen offset:2048 sc1
    s_waitcnt vmcnt(11)
    v_mfma_f32_32x32x16_bf16 v[16:31], a[16:19], v[116:119], v[16:31]
    v_rcp_f32 v233, v233
    v_mul_f32 v240, v232, v240
    v_exp_f32 v236, v236
    v_mfma_f32_32x32x16_bf16 v[32:47], a[20:23], v[116:119], v[32:47]
    v_mul_f32 v238, v9, v238
    v_fma_f32 v235, v235, v7, v7
    v_rcp_f32 v234, v234
    buffer_load_dwordx4 v[156:159], v0, s[8:11], s28 offen offset:3072 sc1
    s_waitcnt vmcnt(11)
    v_mfma_f32_32x32x16_bf16 v[48:63], a[16:19], v[120:123], v[48:63]
    v_mul_f32 v241, v233, v241
    v_exp_f32 v237, v237
    v_mul_f32 v239, v9, v239
    v_fma_f32 v236, v236, v7, v7
    v_mfma_f32_32x32x16_bf16 v[64:79], a[20:23], v[120:123], v[64:79]
    v_rcp_f32 v235, v235
    v_mul_f32 v242, v234, v242
    v_cvt_pk_bf16_f32 v96, v240, v241
    buffer_load_dwordx4 v[160:163], v0, s[8:11], s29 offen offset:3072 sc1
    s_waitcnt vmcnt(11)
    v_mfma_f32_32x32x16_bf16 v[16:31], a[24:27], v[124:127], v[16:31]
    v_exp_f32 v238, v238
    v_fma_f32 v237, v237, v7, v7
    v_rcp_f32 v236, v236
    v_mfma_f32_32x32x16_bf16 v[32:47], a[28:31], v[124:127], v[32:47]
    v_mul_f32 v243, v235, v243
    v_exp_f32 v239, v239
    v_fma_f32 v238, v238, v7, v7
    s_add_u32 s28, s24, 14336
    buffer_load_dwordx4 v[164:167], v0, s[8:11], s28 offen offset:0 sc1
    s_waitcnt vmcnt(11)
    v_mfma_f32_32x32x16_bf16 v[48:63], a[24:27], v[128:131], v[48:63]
    v_rcp_f32 v237, v237
    v_mul_f32 v244, v236, v244
    v_cvt_pk_bf16_f32 v97, v242, v243
    v_fma_f32 v239, v239, v7, v7
    v_mfma_f32_32x32x16_bf16 v[64:79], a[28:31], v[128:131], v[64:79]
    v_rcp_f32 v238, v238
    v_mul_f32 v245, v237, v245
    s_add_u32 s29, s25, 14336
    buffer_load_dwordx4 v[168:171], v0, s[8:11], s29 offen offset:0 sc1
    s_waitcnt vmcnt(11)
    v_mfma_f32_32x32x16_bf16 v[16:31], a[56:59], v[132:135], v[16:31]
    v_rcp_f32 v239, v239
    v_mul_f32 v246, v238, v246
    v_cvt_pk_bf16_f32 v98, v244, v245
    v_mul_f32 v247, v239, v247
    v_mfma_f32_32x32x16_bf16 v[32:47], a[60:63], v[132:135], v[32:47]
    v_cvt_pk_bf16_f32 v99, v246, v247
    buffer_store_dwordx4 v[96:99], v0, s[8:11], s27 offen offset:0
    buffer_load_dwordx4 v[172:175], v0, s[8:11], s28 offen offset:1024 sc1
    s_waitcnt vmcnt(12)
    v_mfma_f32_32x32x16_bf16 v[48:63], a[56:59], v[136:139], v[48:63]
    v_mfma_f32_32x32x16_bf16 v[64:79], a[60:63], v[136:139], v[64:79]
    buffer_load_dwordx4 v[176:179], v0, s[8:11], s29 offen offset:1024 sc1
    s_waitcnt vmcnt(10)
    v_mfma_f32_32x32x16_bf16 v[16:31], a[64:67], v[140:143], v[16:31]
    v_mfma_f32_32x32x16_bf16 v[32:47], a[68:71], v[140:143], v[32:47]
    buffer_load_dwordx4 v[180:183], v0, s[8:11], s28 offen offset:2048 sc1
    s_waitcnt vmcnt(10)
    v_mfma_f32_32x32x16_bf16 v[48:63], a[64:67], v[144:147], v[48:63]
    v_mfma_f32_32x32x16_bf16 v[64:79], a[68:71], v[144:147], v[64:79]
    buffer_load_dwordx4 v[184:187], v0, s[8:11], s29 offen offset:2048 sc1
    s_waitcnt vmcnt(10)
    v_mfma_f32_32x32x16_bf16 v[16:31], a[72:75], v[148:151], v[16:31]
    v_mfma_f32_32x32x16_bf16 v[32:47], a[76:79], v[148:151], v[32:47]
    s_waitcnt vmcnt(4)
    v_mov_b32 v14, s36
    v_mov_b32 v15, 0
    s_cmp_lg_u32 s33, 0
    s_cbranch_scc1 Lps_69
    s_mov_b64 exec, 1
    buffer_store_dword v14, v15, s[8:11], s35 offen
    s_branch Lpd_70
Lps_69:
    s_waitcnt vmcnt(0)
    buffer_wbl2 sc1
    s_waitcnt vmcnt(0)
    s_mov_b64 exec, 1
    buffer_store_dword v14, v15, s[8:11], s35 offen sc1
Lpd_70:
    s_mov_b64 exec, -1
    buffer_load_dwordx4 v[188:191], v0, s[8:11], s28 offen offset:3072 sc1
    s_waitcnt vmcnt(11)
    v_mfma_f32_32x32x16_bf16 v[48:63], a[72:75], v[152:155], v[48:63]
    v_mfma_f32_32x32x16_bf16 v[64:79], a[76:79], v[152:155], v[64:79]
    buffer_load_dwordx4 v[192:195], v0, s[8:11], s29 offen offset:3072 sc1
    s_waitcnt vmcnt(11)
    v_mfma_f32_32x32x16_bf16 v[16:31], a[80:83], v[156:159], v[16:31]
    v_mfma_f32_32x32x16_bf16 v[32:47], a[84:87], v[156:159], v[32:47]
    s_add_u32 s28, s24, 21504
    buffer_load_dwordx4 v[196:199], v0, s[8:11], s28 offen offset:0 sc1
    s_waitcnt vmcnt(11)
    v_mfma_f32_32x32x16_bf16 v[48:63], a[80:83], v[160:163], v[48:63]
    v_mfma_f32_32x32x16_bf16 v[64:79], a[84:87], v[160:163], v[64:79]
    s_add_u32 s29, s25, 21504
    buffer_load_dwordx4 v[200:203], v0, s[8:11], s29 offen offset:0 sc1
    s_waitcnt vmcnt(11)
    v_mfma_f32_32x32x16_bf16 v[16:31], a[112:115], v[164:167], v[16:31]
    v_mfma_f32_32x32x16_bf16 v[32:47], a[116:119], v[164:167], v[32:47]
    buffer_load_dword v12, v13, s[8:11], s34 offen sc1
    buffer_load_dwordx4 v[204:207], v0, s[8:11], s28 offen offset:1024 sc1
    s_waitcnt vmcnt(12)
    v_mfma_f32_32x32x16_bf16 v[48:63], a[112:115], v[168:171], v[48:63]
    v_mfma_f32_32x32x16_bf16 v[64:79], a[116:119], v[168:171], v[64:79]
    buffer_load_dwordx4 v[208:211], v0, s[8:11], s29 offen offset:1024 sc1
    s_waitcnt vmcnt(11)
    v_mfma_f32_32x32x16_bf16 v[16:31], a[120:123], v[172:175], v[16:31]
    v_mfma_f32_32x32x16_bf16 v[32:47], a[124:127], v[172:175], v[32:47]
    buffer_load_dwordx4 v[212:215], v0, s[8:11], s28 offen offset:2048 sc1
    s_waitcnt vmcnt(11)
    v_mfma_f32_32x32x16_bf16 v[48:63], a[120:123], v[176:179], v[48:63]
    v_mfma_f32_32x32x16_bf16 v[64:79], a[124:127], v[176:179], v[64:79]
    buffer_load_dwordx4 v[216:219], v0, s[8:11], s29 offen offset:2048 sc1
    s_waitcnt vmcnt(11)
    v_mfma_f32_32x32x16_bf16 v[16:31], a[128:131], v[180:183], v[16:31]
    v_mfma_f32_32x32x16_bf16 v[32:47], a[132:135], v[180:183], v[32:47]
    buffer_load_dwordx4 v[220:223], v0, s[8:11], s28 offen offset:3072 sc1
    s_waitcnt vmcnt(11)
    v_mfma_f32_32x32x16_bf16 v[48:63], a[128:131], v[184:187], v[48:63]
    v_mfma_f32_32x32x16_bf16 v[64:79], a[132:135], v[184:187], v[64:79]
    buffer_load_dwordx4 v[224:227], v0, s[8:11], s29 offen offset:3072 sc1
    s_waitcnt vmcnt(10)
    v_mfma_f32_32x32x16_bf16 v[16:31], a[136:139], v[188:191], v[16:31]
    v_mfma_f32_32x32x16_bf16 v[32:47], a[140:143], v[188:191], v[32:47]
    s_sub_u32 s36, s36, 1
    s_waitcnt vmcnt(6)
    v_subrev_u32 v12, s36, v12
    v_cmp_lt_u32 vcc, 15, v12
    s_and_b64 vcc, vcc, s[42:43]
    s_or_b32 s30, vcc_lo, vcc_hi
    s_or_b32 s30, s30, s33
    s_cbranch_scc0 Lck_71
    s_mov_b64 exec, s[42:43]
Lw_72:
    s_add_u32 s39, s39, 1
    s_cmp_gt_u32 s39, 1048576
    s_cbranch_scc1 Lwx_73
    buffer_load_dword v14, v13, s[8:11], s34 offen sc1
    s_waitcnt vmcnt(0)
    v_subrev_u32 v14, s36, v14
    v_cmp_lt_u32 vcc, 15, v14
    s_cbranch_vccnz Lw_72
Lwx_73:
    s_mov_b64 exec, -1
    s_cmp_eq_u32 s33, 0
    s_cbranch_scc1 Lwf_74
    buffer_inv sc1
    s_waitcnt vmcnt(0)
Lwf_74:
Lck_71:
    s_add_u32 s36, s36, 1
    s_add_u32 s28, s24, 4096
    buffer_load_dwordx4 v[100:103], v0, s[8:11], s28 offen offset:0 sc1
    s_waitcnt vmcnt(10)
    v_mfma_f32_32x32x16_bf16 v[48:63], a[136:139], v[192:195], v[48:63]
    v_mfma_f32_32x32x16_bf16 v[64:79], a[140:143], v[192:195], v[64:79]
    s_add_u32 s29, s25, 4096
    buffer_load_dwordx4 v[104:107], v0, s[8:11], s29 offen offset:0 sc1
    s_waitcnt vmcnt(10)
    v_mfma_f32_32x32x16_bf16 v[16:31], a[168:171], v[196:199], v[16:31]
    v_mfma_f32_32x32x16_bf16 v[32:47], a[172:175], v[196:199], v[32:47]
    buffer_load_dwordx4 v[108:111], v0, s[8:11], s28 offen offset:1024 sc1
    s_waitcnt vmcnt(10)
    v_mfma_f32_32x32x16_bf16 v[48:63], a[168:171], v[200:203], v[48:63]
    v_mfma_f32_32x32x16_bf16 v[64:79], a[172:175], v[200:203], v[64:79]
    buffer_load_dwordx4 v[112:115], v0, s[8:11], s29 offen offset:1024 sc1
    s_waitcnt vmcnt(9)
    v_mfma_f32_32x32x16_bf16 v[16:31], a[176:179], v[204:207], v[16:31]
    v_mfma_f32_32x32x16_bf16 v[32:47], a[180:183], v[204:207], v[32:47]
    s_add_u32 s28, s24, 11264
    buffer_load_dwordx4 v[116:119], v0, s[8:11], s28 offen offset:0 sc1
    s_waitcnt vmcnt(9)
    v_mfma_f32_32x32x16_bf16 v[48:63], a[176:179], v[208:211], v[48:63]
    v_mfma_f32_32x32x16_bf16 v[64:79], a[180:183], v[208:211], v[64:79]
    s_add_u32 s29, s25, 11264
    buffer_load_dwordx4 v[120:123], v0, s[8:11], s29 offen offset:0 sc1
    s_waitcnt vmcnt(9)
    v_mfma_f32_32x32x16_bf16 v[16:31], a[184:187], v[212:215], v[16:31]
    v_mfma_f32_32x32x16_bf16 v[32:47], a[188:191], v[212:215], v[32:47]
    buffer_load_dwordx4 v[124:127], v0, s[8:11], s28 offen offset:1024 sc1
    s_waitcnt vmcnt(9)
    v_mfma_f32_32x32x16_bf16 v[48:63], a[184:187], v[216:219], v[48:63]
    v_mfma_f32_32x32x16_bf16 v[64:79], a[188:191], v[216:219], v[64:79]
    buffer_load_dwordx4 v[128:131], v0, s[8:11], s29 offen offset:1024 sc1
    s_waitcnt vmcnt(9)
    v_mfma_f32_32x32x16_bf16 v[16:31], a[192:195], v[220:223], v[16:31]
    v_mfma_f32_32x32x16_bf16 v[32:47], a[196:199], v[220:223], v[32:47]
    s_add_u32 s28, s24, 18432
    buffer_load_dwordx4 v[132:135], v0, s[8:11], s28 offen offset:0 sc1
    s_waitcnt vmcnt(9)
    v_mfma_f32_32x32x16_bf16 v[48:63], a[192:195], v[224:227], v[48:63]
    v_mfma_f32_32x32x16_bf16 v[64:79], a[196:199], v[224:227], v[64:79]
    s_add_u32 s29, s25, 18432
    buffer_load_dwordx4 v[136:139], v0, s[8:11], s29 offen offset:0 sc1
    s_waitcnt vmcnt(9)
    v_mfma_f32_32x32x16_bf16 v[16:31], a[32:35], v[100:103], v[16:31]
    v_mfma_f32_32x32x16_bf16 v[32:47], a[36:39], v[100:103], v[32:47]
    buffer_load_dword v12, v13, s[8:11], s34 offen sc1
    buffer_load_dwordx4 v[140:143], v0, s[8:11], s28 offen offset:1024 sc1
    s_waitcnt vmcnt(10)
    v_mfma_f32_32x32x16_bf16 v[48:63], a[32:35], v[104:107], v[48:63]
    v_mfma_f32_32x32x16_bf16 v[64:79], a[36:39], v[104:107], v[64:79]
    buffer_load_dwordx4 v[144:147], v0, s[8:11], s29 offen offset:1024 sc1
    s_waitcnt vmcnt(10)
    v_mfma_f32_32x32x16_bf16 v[16:31], a[40:43], v[108:111], v[16:31]
    v_mfma_f32_32x32x16_bf16 v[32:47], a[44:47], v[108:111], v[32:47]
    s_add_u32 s28, s24, 25600
    buffer_load_dwordx4 v[148:151], v0, s[8:11], s28 offen offset:0 sc1
    s_waitcnt vmcnt(10)
    v_mfma_f32_32x32x16_bf16 v[48:63], a[40:43], v[112:115], v[48:63]
    v_mfma_f32_32x32x16_bf16 v[64:79], a[44:47], v[112:115], v[64:79]
    s_add_u32 s29, s25, 25600
    buffer_load_dwordx4 v[152:155], v0, s[8:11], s29 offen offset:0 sc1
    s_waitcnt vmcnt(10)
    v_mfma_f32_32x32x16_bf16 v[16:31], a[88:91], v[116:119], v[16:31]
    v_mfma_f32_32x32x16_bf16 v[32:47], a[92:95], v[116:119], v[32:47]
    buffer_load_dwordx4 v[156:159], v0, s[8:11], s28 offen offset:1024 sc1
    s_waitcnt vmcnt(10)
    v_mfma_f32_32x32x16_bf16 v[48:63], a[88:91], v[120:123], v[48:63]
    v_mfma_f32_32x32x16_bf16 v[64:79], a[92:95], v[120:123], v[64:79]
    buffer_load_dwordx4 v[160:163], v0, s[8:11], s29 offen offset:1024 sc1
    s_waitcnt vmcnt(10)
    v_mfma_f32_32x32x16_bf16 v[16:31], a[96:99], v[124:127], v[16:31]
    v_mfma_f32_32x32x16_bf16 v[32:47], a[100:103], v[124:127], v[32:47]
    s_waitcnt vmcnt(6)
    v_subrev_u32 v12, s36, v12
    v_cmp_lt_u32 vcc, 15, v12
    s_and_b64 vcc, vcc, s[42:43]
    s_or_b32 s30, vcc_lo, vcc_hi
    s_or_b32 s30, s30, s33
    s_cbranch_scc0 Lck_75
    s_mov_b64 exec, s[42:43]
Lw_76:
    s_add_u32 s39, s39, 1
    s_cmp_gt_u32 s39, 1048576
    s_cbranch_scc1 Lwx_77
    buffer_load_dword v14, v13, s[8:11], s34 offen sc1
    s_waitcnt vmcnt(0)
    v_subrev_u32 v14, s36, v14
    v_cmp_lt_u32 vcc, 15, v14
    s_cbranch_vccnz Lw_76
Lwx_77:
    s_mov_b64 exec, -1
    s_cmp_eq_u32 s33, 0
    s_cbranch_scc1 Lwf_78
    buffer_inv sc1
    s_waitcnt vmcnt(0)
Lwf_78:
Lck_75:
    s_add_u32 s36, s36, 1
    s_add_u32 s28, s24, 6144
    buffer_load_dwordx4 v[164:167], v0, s[8:11], s28 offen offset:0 sc1
    s_waitcnt vmcnt(10)
    v_mfma_f32_32x32x16_bf16 v[48:63], a[96:99], v[128:131], v[48:63]
    v_mfma_f32_32x32x16_bf16 v[64:79], a[100:103], v[128:131], v[64:79]
    s_add_u32 s29, s25, 6144
    buffer_load_dwordx4 v[168:171], v0, s[8:11], s29 offen offset:0 sc1
    s_waitcnt vmcnt(10)
    v_mfma_f32_32x32x16_bf16 v[16:31], a[144:147], v[132:135], v[16:31]
    v_mfma_f32_32x32x16_bf16 v[32:47], a[148:151], v[132:135], v[32:47]
    s_add_u32 s28, s24, 13312
    buffer_load_dwordx4 v[172:175], v0, s[8:11], s28 offen offset:0 sc1
    s_waitcnt vmcnt(10)
    v_mfma_f32_32x32x16_bf16 v[48:63], a[144:147], v[136:139], v[48:63]
    v_mfma_f32_32x32x16_bf16 v[64:79], a[148:151], v[136:139], v[64:79]
    s_add_u32 s29, s25, 13312
    buffer_load_dwordx4 v[176:179], v0, s[8:11], s29 offen offset:0 sc1
    s_xor_b32 s30, s3, 0
    s_mul_i32 s30, s30, 12288
    v_add_u32 v5, s30, v0
    s_xor_b32 s30, s3, 1
    s_mul_i32 s30, s30, 12288
    v_add_u32 v6, s30, v0
    s_xor_b32 s30, s3, 2
    s_mul_i32 s30, s30, 12288
    v_add_u32 v7, s30, v0
    s_xor_b32 s30, s3, 3
    s_mul_i32 s30, s30, 12288
    v_add_u32 v8, s30, v0
    s_waitcnt vmcnt(9)
    v_mfma_f32_32x32x16_bf16 v[16:31], a[152:155], v[140:143], v[16:31]
    v_mfma_f32_32x32x16_bf16 v[32:47], a[156:159], v[140:143], v[32:47]
    s_add_u32 s28, s24, 20480
    buffer_load_dwordx4 v[180:183], v0, s[8:11], s28 offen offset:0 sc1
    s_waitcnt vmcnt(9)
    v_mfma_f32_32x32x16_bf16 v[48:63], a[152:155], v[144:147], v[48:63]
    v_mfma_f32_32x32x16_bf16 v[64:79], a[156:159], v[144:147], v[64:79]
    s_add_u32 s29, s25, 20480
    buffer_load_dwordx4 v[184:187], v0, s[8:11], s29 offen offset:0 sc1
    s_waitcnt vmcnt(9)
    v_mfma_f32_32x32x16_bf16 v[16:31], a[200:203], v[148:151], v[16:31]
    v_mfma_f32_32x32x16_bf16 v[32:47], a[204:207], v[148:151], v[32:47]
    s_add_u32 s28, s24, 27648
    buffer_load_dwordx4 v[188:191], v0, s[8:11], s28 offen offset:0 sc1
    s_waitcnt vmcnt(9)
    v_mfma_f32_32x32x16_bf16 v[48:63], a[200:203], v[152:155], v[48:63]
    v_mfma_f32_32x32x16_bf16 v[64:79], a[204:207], v[152:155], v[64:79]
    s_add_u32 s29, s25, 27648
    buffer_load_dwordx4 v[192:195], v0, s[8:11], s29 offen offset:0 sc1
    s_waitcnt vmcnt(9)
    v_mfma_f32_32x32x16_bf16 v[16:31], a[208:211], v[156:159], v[16:31]
    v_mfma_f32_32x32x16_bf16 v[32:47], a[212:215], v[156:159], v[32:47]
    s_waitcnt vmcnt(8)
    v_mfma_f32_32x32x16_bf16 v[48:63], a[208:211], v[160:163], v[48:63]
    v_mfma_f32_32x32x16_bf16 v[64:79], a[212:215], v[160:163], v[64:79]
    s_waitcnt vmcnt(7)
    v_mfma_f32_32x32x16_bf16 v[16:31], a[48:51], v[164:167], v[16:31]
    v_mfma_f32_32x32x16_bf16 v[32:47], a[52:55], v[164:167], v[32:47]
    s_waitcnt vmcnt(6)
    v_mfma_f32_32x32x16_bf16 v[48:63], a[48:51], v[168:171], v[48:63]
    v_mfma_f32_32x32x16_bf16 v[64:79], a[52:55], v[168:171], v[64:79]
    s_waitcnt vmcnt(5)
    v_mfma_f32_32x32x16_bf16 v[16:31], a[104:107], v[172:175], v[16:31]
    v_mfma_f32_32x32x16_bf16 v[32:47], a[108:111], v[172:175], v[32:47]
    s_waitcnt vmcnt(4)
    v_mfma_f32_32x32x16_bf16 v[48:63], a[104:107], v[176:179], v[48:63]
    v_mfma_f32_32x32x16_bf16 v[64:79], a[108:111], v[176:179], v[64:79]
    s_waitcnt vmcnt(3)
    v_mfma_f32_32x32x16_bf16 v[16:31], a[160:163], v[180:183], v[16:31]
    v_mfma_f32_32x32x16_bf16 v[32:47], a[164:167], v[180:183], v[32:47]
    s_waitcnt vmcnt(2)
    v_mfma_f32_32x32x16_bf16 v[48:63], a[160:163], v[184:187], v[48:63]
    v_mfma_f32_32x32x16_bf16 v[64:79], a[164:167], v[184:187], v[64:79]
    s_waitcnt vmcnt(1)
    v_mfma_f32_32x32x16_bf16 v[16:31], a[216:219], v[188:191], v[16:31]
    v_mfma_f32_32x32x16_bf16 v[32:47], a[220:223], v[188:191], v[32:47]
    s_waitcnt vmcnt(0)
    v_mfma_f32_32x32x16_bf16 v[48:63], a[216:219], v[192:195], v[48:63]
    v_mfma_f32_32x32x16_bf16 v[64:79], a[220:223], v[192:195], v[64:79]
    s_or_b32 s30, s5, s37
    s_cbranch_scc1 Lnw_79
    s_mul_i32 s30, s3, 14336
    s_add_u32 s30, s30, 458752
    buffer_load_dwordx4 a[224:227], v0, s[8:11], s30 offen offset:0
    buffer_load_dwordx4 a[228:231], v0, s[8:11], s30 offen offset:1024
    buffer_load_dwordx4 a[232:235], v0, s[8:11], s30 offen offset:2048
    buffer_load_dwordx4 a[236:239], v0, s[8:11], s30 offen offset:3072
    s_add_u32 s30, s30, 4096
    buffer_load_dwordx4 a[240:243], v0, s[8:11], s30 offen offset:0
    buffer_load_dwordx4 a[244:247], v0, s[8:11], s30 offen offset:1024
    buffer_load_dwordx4 a[248:251], v0, s[8:11], s30 offen offset:2048
    buffer_load_dwordx4 a[252:255], v0, s[8:11], s30 offen offset:3072
    s_add_u32 s30, s30, 4096
    buffer_load_dwordx4 v[232:235], v0, s[8:11], s30 offen offset:0
    buffer_load_dwordx4 v[236:239], v0, s[8:11], s30 offen offset:1024
    buffer_load_dwordx4 v[240:243], v0, s[8:11], s30 offen offset:2048
    buffer_load_dwordx4 v[244:247], v0, s[8:11], s30 offen offset:3072
    s_add_u32 s30, s30, 4096
    buffer_load_dwordx4 v[248:251], v0, s[8:11], s30 offen offset:0
    buffer_load_dwordx4 v[252:255], v0, s[8:11], s30 offen offset:1024
Lnw_79:
    s_nop 5
    ds_write_b128 v6, v[32:35] offset:0
    ds_write_b128 v6, v[36:39] offset:1024
    ds_write_b128 v6, v[40:43] offset:2048
    ds_write_b128 v6, v[44:47] offset:3072
    ds_write_b128 v7, v[48:51] offset:4096
    ds_write_b128 v7, v[52:55] offset:5120
    ds_write_b128 v7, v[56:59] offset:6144
    ds_write_b128 v7, v[60:63] offset:7168
    s_nop 3
    ds_write_b128 v8, v[64:67] offset:8192
    ds_write_b128 v8, v[68:71] offset:9216
    ds_write_b128 v8, v[72:75] offset:10240
    ds_write_b128 v8, v[76:79] offset:11264
    s_lshl_b32 s29, s5, 2
    s_add_u32 s29, s29, s3
    s_lshl_b32 s28, s29, 7
    s_add_u32 s28, s28, 5791744
    s_mul_i32 s29, s29, 28672
    s_add_u32 s29, s29, 0
    buffer_load_dwordx4 v[132:135], v0, s[8:11], s29 offen offset:0
    buffer_load_dwordx4 v[136:139], v0, s[8:11], s29 offen offset:1024
    buffer_load_dwordx4 v[140:143], v0, s[8:11], s29 offen offset:2048
    buffer_load_dwordx4 v[144:147], v0, s[8:11], s29 offen offset:3072
    s_add_u32 s29, s29, 4096
    buffer_load_dwordx4 v[148:151], v0, s[8:11], s29 offen offset:0
    s_waitcnt lgkmcnt(0)
    s_barrier
    ds_read_b128 v[32:35], v5 offset:0
    ds_read_b128 v[36:39], v5 offset:1024
    ds_read_b128 v[40:43], v5 offset:2048
    ds_read_b128 v[44:47], v5 offset:3072
    ds_read_b128 v[48:51], v5 offset:4096
    ds_read_b128 v[52:55], v5 offset:5120
    ds_read_b128 v[56:59], v5 offset:6144
    ds_read_b128 v[60:63], v5 offset:7168
    ds_read_b128 v[64:67], v5 offset:8192
    ds_read_b128 v[68:71], v5 offset:9216
    ds_read_b128 v[72:75], v5 offset:10240
    ds_read_b128 v[76:79], v5 offset:11264
    buffer_load_dwordx4 v[152:155], v0, s[8:11], s29 offen offset:1024
    buffer_load_dwordx4 v[156:159], v0, s[8:11], s29 offen offset:2048
    buffer_load_dwordx4 v[160:163], v0, s[8:11], s29 offen offset:3072
    s_add_u32 s29, s29, 4096
    buffer_load_dwordx4 v[164:167], v0, s[8:11], s29 offen offset:0
    s_add_u32 s24, s47, 5809152
    s_mul_i32 s25, s45, 3584
    s_lshl_b32 s48, s46, 8
    s_add_u32 s25, s25, s48
    s_add_u32 s25, s25, 7644160
    s_waitcnt lgkmcnt(8)
    v_pk_add_f32 v[16:17], v[16:17], v[32:33]
    v_pk_add_f32 v[18:19], v[18:19], v[34:35]
    v_pk_add_f32 v[20:21], v[20:21], v[36:37]
    v_pk_add_f32 v[22:23], v[22:23], v[38:39]
    v_pk_add_f32 v[24:25], v[24:25], v[40:41]
    v_pk_add_f32 v[26:27], v[26:27], v[42:43]
    v_pk_add_f32 v[28:29], v[28:29], v[44:45]
    v_pk_add_f32 v[30:31], v[30:31], v[46:47]
    s_waitcnt lgkmcnt(4)
    v_pk_add_f32 v[16:17], v[16:17], v[48:49]
    v_pk_add_f32 v[18:19], v[18:19], v[50:51]
    v_pk_add_f32 v[20:21], v[20:21], v[52:53]
    v_pk_add_f32 v[22:23], v[22:23], v[54:55]
    v_pk_add_f32 v[24:25], v[24:25], v[56:57]
    v_pk_add_f32 v[26:27], v[26:27], v[58:59]
    v_pk_add_f32 v[28:29], v[28:29], v[60:61]
    v_pk_add_f32 v[30:31], v[30:31], v[62:63]
    s_waitcnt lgkmcnt(0)
    v_pk_add_f32 v[16:17], v[16:17], v[64:65]
    v_pk_add_f32 v[18:19], v[18:19], v[66:67]
    v_pk_add_f32 v[20:21], v[20:21], v[68:69]
    v_pk_add_f32 v[22:23], v[22:23], v[70:71]
    v_pk_add_f32 v[24:25], v[24:25], v[72:73]
    v_pk_add_f32 v[26:27], v[26:27], v[74:75]
    v_pk_add_f32 v[28:29], v[28:29], v[76:77]
    v_pk_add_f32 v[30:31], v[30:31], v[78:79]
    v_cvt_pk_bf16_f32 v80, v16, v17
    v_cvt_pk_bf16_f32 v81, v18, v19
    v_cvt_pk_bf16_f32 v82, v20, v21
    v_cvt_pk_bf16_f32 v83, v22, v23
    v_cvt_pk_bf16_f32 v84, v24, v25
    v_cvt_pk_bf16_f32 v85, v26, v27
    v_cvt_pk_bf16_f32 v86, v28, v29
    v_cvt_pk_bf16_f32 v87, v30, v31
    buffer_store_dwordx4 v[80:83], v0, s[8:11], s24 offen offset:0
    buffer_store_dwordx4 v[84:87], v0, s[8:11], s24 offen offset:1024
    v_pk_mul_f32 v[34:35], v[16:17], v[16:17]
    v_pk_add_f32 v[32:33], v[16:17], v[18:19]
    v_pk_fma_f32 v[34:35], v[18:19], v[18:19], v[34:35]
    v_pk_add_f32 v[32:33], v[32:33], v[20:21]
    v_pk_fma_f32 v[34:35], v[20:21], v[20:21], v[34:35]
    v_pk_add_f32 v[32:33], v[32:33], v[22:23]
    v_pk_fma_f32 v[34:35], v[22:23], v[22:23], v[34:35]
    v_pk_add_f32 v[32:33], v[32:33], v[24:25]
    v_pk_fma_f32 v[34:35], v[24:25], v[24:25], v[34:35]
    v_pk_add_f32 v[32:33], v[32:33], v[26:27]
    v_pk_fma_f32 v[34:35], v[26:27], v[26:27], v[34:35]
    v_pk_add_f32 v[32:33], v[32:33], v[28:29]
    v_pk_fma_f32 v[34:35], v[28:29], v[28:29], v[34:35]
    v_pk_add_f32 v[32:33], v[32:33], v[30:31]
    v_pk_fma_f32 v[34:35], v[30:31], v[30:31], v[34:35]
    v_lshlrev_b32 v5, 3, v1
    v_add_f32 v32, v32, v33
    v_add_f32 v33, v34, v35
    v_mov_b32 v34, v32
    v_mov_b32 v35, v33
    s_nop 1
    v_permlane32_swap_b32 v34, v32
    v_permlane32_swap_b32 v35, v33
    s_nop 1
    v_add_f32 v32, v32, v34
    v_add_f32 v33, v33, v35
    s_mov_b32 exec_hi, 0
    buffer_store_dwordx2 v[32:33], v5, s[8:11], s25 offen
    s_mov_b32 exec_hi, -1
    buffer_load_dwordx4 v[168:171], v0, s[8:11], s29 offen offset:1024
    buffer_load_dwordx4 v[172:175], v0, s[8:11], s29 offen offset:2048
    buffer_load_dwordx4 v[176:179], v0, s[8:11], s29 offen offset:3072
    s_add_u32 s29, s29, 4096
    buffer_load_dwordx4 v[180:183], v0, s[8:11], s29 offen offset:0
    buffer_load_dwordx4 v[184:187], v0, s[8:11], s29 offen offset:1024
    buffer_load_dwordx4 v[188:191], v0, s[8:11], s29 offen offset:2048
    buffer_load_dwordx4 v[192:195], v0, s[8:11], s29 offen offset:3072
    s_add_u32 s29, s29, 4096
    buffer_load_dwordx4 v[196:199], v0, s[8:11], s29 offen offset:0
    s_waitcnt vmcnt(8)
    v_mov_b32 v14, s36
    v_mov_b32 v15, 0
    s_cmp_lg_u32 s33, 0
    s_cbranch_scc1 Lps_80
    s_mov_b64 exec, 1
    buffer_store_dword v14, v15, s[8:11], s35 offen
    s_branch Lpd_81
Lps_80:
    s_waitcnt vmcnt(0)
    buffer_wbl2 sc1
    s_waitcnt vmcnt(0)
    s_mov_b64 exec, 1
    buffer_store_dword v14, v15, s[8:11], s35 offen sc1
Lpd_81:
    s_mov_b64 exec, -1
    s_barrier
    s_branch Lnx_82
Lskip_61:
    s_lshl_b32 s29, s5, 2
    s_add_u32 s29, s29, s3
    s_lshl_b32 s28, s29, 7
    s_add_u32 s28, s28, 5791744
    s_mul_i32 s29, s29, 28672
    s_add_u32 s29, s29, 0
    buffer_load_dwordx4 v[132:135], v0, s[8:11], s29 offen offset:0
    buffer_load_dwordx4 v[136:139], v0, s[8:11], s29 offen offset:1024
    buffer_load_dwordx4 v[140:143], v0, s[8:11], s29 offen offset:2048
    buffer_load_dwordx4 v[144:147], v0, s[8:11], s29 offen offset:3072
    s_add_u32 s29, s29, 4096
    buffer_load_dwordx4 v[148:151], v0, s[8:11], s29 offen offset:0
    buffer_load_dwordx4 v[152:155], v0, s[8:11], s29 offen offset:1024
    buffer_load_dwordx4 v[156:159], v0, s[8:11], s29 offen offset:2048
    buffer_load_dwordx4 v[160:163], v0, s[8:11], s29 offen offset:3072
    s_add_u32 s29, s29, 4096
    buffer_load_dwordx4 v[164:167], v0, s[8:11], s29 offen offset:0
    buffer_load_dwordx4 v[168:171], v0, s[8:11], s29 offen offset:1024
    buffer_load_dwordx4 v[172:175], v0, s[8:11], s29 offen offset:2048
    buffer_load_dwordx4 v[176:179], v0, s[8:11], s29 offen offset:3072
    s_add_u32 s29, s29, 4096
    buffer_load_dwordx4 v[180:183], v0, s[8:11], s29 offen offset:0
    buffer_load_dwordx4 v[184:187], v0, s[8:11], s29 offen offset:1024
    buffer_load_dwordx4 v[188:191], v0, s[8:11], s29 offen offset:2048
    buffer_load_dwordx4 v[192:195], v0, s[8:11], s29 offen offset:3072
    s_add_u32 s29, s29, 4096
    buffer_load_dwordx4 v[196:199], v0, s[8:11], s29 offen offset:0
Lnx_82:
    s_mov_b32 s37, 1
    s_add_u32 s7, s7, 262144
    s_branch Lpro_6
Ldown_60:
    s_cmp_lt_u32 s6, 14
    s_cbranch_scc1 Lgo_86
    s_nop 10
    v_fma_f32 v232, -v6, v80, v232
    v_fma_f32 v233, -v6, v81, v233
    v_fma_f32 v234, -v6, v82, v234
    v_fma_f32 v235, -v6, v83, v235
    v_fma_f32 v236, -v6, v84, v236
    v_fma_f32 v237, -v6, v85, v237
    v_fma_f32 v238, -v6, v86, v238
    v_fma_f32 v239, -v6, v87, v239
    v_fma_f32 v240, -v6, v88, v240
    v_fma_f32 v241, -v6, v89, v241
    v_fma_f32 v242, -v6, v90, v242
    v_fma_f32 v243, -v6, v91, v243
    v_fma_f32 v244, -v6, v92, v244
    v_fma_f32 v245, -v6, v93, v245
    v_fma_f32 v246, -v6, v94, v246
    v_fma_f32 v247, -v6, v95, v247
    v_mul_f32 v232, v9, v232
    v_mul_f32 v233, v9, v233
    v_exp_f32 v232, v232
    v_mul_f32 v234, v9, v234
    v_exp_f32 v233, v233
    v_mul_f32 v235, v9, v235
    v_fma_f32 v232, v232, v7, v7
    v_exp_f32 v234, v234
    v_mul_f32 v236, v9, v236
    v_fma_f32 v233, v233, v7, v7
    v_rcp_f32 v232, v232
    v_exp_f32 v235, v235
    v_mul_f32 v237, v9, v237
    v_fma_f32 v234, v234, v7, v7
    v_rcp_f32 v233, v233
    v_mul_f32 v240, v232, v240
    v_exp_f32 v236, v236
    v_mul_f32 v238, v9, v238
    v_fma_f32 v235, v235, v7, v7
    v_rcp_f32 v234, v234
    v_mul_f32 v241, v233, v241
    v_exp_f32 v237, v237
    v_mul_f32 v239, v9, v239
    v_fma_f32 v236, v236, v7, v7
    v_rcp_f32 v235, v235
    v_mul_f32 v242, v234, v242
    v_cvt_pk_bf16_f32 v96, v240, v241
    v_exp_f32 v238, v238
    v_fma_f32 v237, v237, v7, v7
    v_rcp_f32 v236, v236
    v_mul_f32 v243, v235, v243
    v_exp_f32 v239, v239
    v_fma_f32 v238, v238, v7, v7
    v_rcp_f32 v237, v237
    v_mul_f32 v244, v236, v244
    v_cvt_pk_bf16_f32 v97, v242, v243
    v_fma_f32 v239, v239, v7, v7
    v_rcp_f32 v238, v238
    v_mul_f32 v245, v237, v245
    v_rcp_f32 v239, v239
    v_mul_f32 v246, v238, v246
    v_cvt_pk_bf16_f32 v98, v244, v245
    v_mul_f32 v247, v239, v247
    v_cvt_pk_bf16_f32 v99, v246, v247
    buffer_store_dwordx4 v[96:99], v0, s[8:11], s27 offen offset:0
    s_add_u32 s36, s36, 1
    s_waitcnt vmcnt(0)
    v_mov_b32 v14, s36
    v_mov_b32 v15, 0
    s_cmp_lg_u32 s33, 0
    s_cbranch_scc1 Lps_87
    s_mov_b64 exec, 1
    buffer_store_dword v14, v15, s[8:11], s35 offen
    s_branch Lpd_88
Lps_87:
    s_waitcnt vmcnt(0)
    buffer_wbl2 sc1
    s_waitcnt vmcnt(0)
    s_mov_b64 exec, 1
    buffer_store_dword v14, v15, s[8:11], s35 offen sc1
Lpd_88:
    s_mov_b64 exec, -1
    s_add_u32 s36, s36, 1
    s_branch Lskip_83
Lgo_86:
    s_waitcnt vmcnt(11)
    v_lshlrev_b32 v16, 16, v64
    v_and_b32 v17, 0xffff0000, v64
    v_lshlrev_b32 v18, 16, v65
    v_and_b32 v19, 0xffff0000, v65
    v_lshlrev_b32 v20, 16, v66
    v_and_b32 v21, 0xffff0000, v66
    v_lshlrev_b32 v22, 16, v67
    v_and_b32 v23, 0xffff0000, v67
    v_lshlrev_b32 v24, 16, v68
    v_and_b32 v25, 0xffff0000, v68
    v_lshlrev_b32 v26, 16, v69
    v_and_b32 v27, 0xffff0000, v69
    v_lshlrev_b32 v28, 16, v70
    v_and_b32 v29, 0xffff0000, v70
    v_lshlrev_b32 v30, 16, v71
    v_and_b32 v31, 0xffff0000, v71
    s_waitcnt vmcnt(10)
    v_mfma_f32_32x32x16_bf16 v[16:31], a[40:43], v[100:103], v[16:31]
    v_fma_f32 v232, -v6, v80, v232
    v_fma_f32 v233, -v6, v81, v233
    v_fma_f32 v234, -v6, v82, v234
    v_fma_f32 v235, -v6, v83, v235
    v_fma_f32 v236, -v6, v84, v236
    v_mfma_f32_32x32x16_bf16 v[32:47], a[44:47], v[100:103], 0
    v_fma_f32 v237, -v6, v85, v237
    v_fma_f32 v238, -v6, v86, v238
    v_fma_f32 v239, -v6, v87, v239
    v_fma_f32 v240, -v6, v88, v240
    s_waitcnt vmcnt(0)
    v_mov_b32 v14, s36
    v_mov_b32 v15, 0
    s_cmp_lg_u32 s33, 0
    s_cbranch_scc1 Lps_89
    s_mov_b64 exec, 1
    buffer_store_dword v14, v15, s[8:11], s35 offen
    s_branch Lpd_90
Lps_89:
    s_waitcnt vmcnt(0)
    buffer_wbl2 sc1
    s_waitcnt vmcnt(0)
    s_mov_b64 exec, 1
    buffer_store_dword v14, v15, s[8:11], s35 offen sc1
Lpd_90:
    s_mov_b64 exec, -1
    s_add_u32 s36, s36, 1
    buffer_load_dwordx4 v[140:143], v0, s[8:11], s28 offen offset:1024 sc1
    s_waitcnt vmcnt(11)
    v_mfma_f32_32x32x16_bf16 v[48:63], a[40:43], v[104:107], 0
    v_fma_f32 v241, -v6, v89, v241
    v_fma_f32 v242, -v6, v90, v242
    v_fma_f32 v243, -v6, v91, v243
    v_fma_f32 v244, -v6, v92, v244
    v_fma_f32 v245, -v6, v93, v245
    v_mfma_f32_32x32x16_bf16 v[64:79], a[44:47], v[104:107], 0
    v_fma_f32 v246, -v6, v94, v246
    v_fma_f32 v247, -v6, v95, v247
    v_mul_f32 v232, v9, v232
    v_mul_f32 v233, v9, v233
    buffer_load_dwordx4 v[144:147], v0, s[8:11], s29 offen offset:1024 sc1
    s_waitcnt vmcnt(11)
    v_mfma_f32_32x32x16_bf16 v[16:31], a[48:51], v[108:111], v[16:31]
    v_exp_f32 v232, v232
    v_mul_f32 v234, v9, v234
    v_exp_f32 v233, v233
    v_mfma_f32_32x32x16_bf16 v[32:47], a[52:55], v[108:111], v[32:47]
    v_mul_f32 v235, v9, v235
    v_fma_f32 v232, v232, v7, v7
    v_exp_f32 v234, v234
    buffer_load_dwordx4 v[148:151], v0, s[8:11], s28 offen offset:2048 sc1
    s_waitcnt vmcnt(11)
    v_mfma_f32_32x32x16_bf16 v[48:63], a[48:51], v[112:115], v[48:63]
    v_mul_f32 v236, v9, v236
    v_fma_f32 v233, v233, v7, v7
    v_rcp_f32 v232, v232
    v_mfma_f32_32x32x16_bf16 v[64:79], a[52:55], v[112:115], v[64:79]
    v_exp_f32 v235, v235
    v_mul_f32 v237, v9, v237
    v_fma_f32 v234, v234, v7, v7
    buffer_load_dwordx4 v[152:155], v0, s[8:11], s29 offen offset:2048 sc1
    s_waitcnt vmcnt(11)
    v_mfma_f32_32x32x16_bf16 v[16:31], a[16:19], v[116:119], v[16:31]
    v_rcp_f32 v233, v233
    v_mul_f32 v240, v232, v240
    v_exp_f32 v236, v236
    v_mfma_f32_32x32x16_bf16 v[32:47], a[20:23], v[116:119], v[32:47]
    v_mul_f32 v238, v9, v238
    v_fma_f32 v235, v235, v7, v7
    v_rcp_f32 v234, v234
    buffer_load_dwordx4 v[156:159], v0, s[8:11], s28 offen offset:3072 sc1
    s_waitcnt vmcnt(11)
    v_mfma_f32_32x32x16_bf16 v[48:63], a[16:19], v[120:123], v[48:63]
    v_mul_f32 v241, v233, v241
    v_exp_f32 v237, v237
    v_mul_f32 v239, v9, v239
    v_fma_f32 v236, v236, v7, v7
    v_mfma_f32_32x32x16_bf16 v[64:79], a[20:23], v[120:123], v[64:79]
    v_rcp_f32 v235, v235
    v_mul_f32 v242, v234, v242
    v_cvt_pk_bf16_f32 v96, v240, v241
    buffer_load_dwordx4 v[160:163], v0, s[8:11], s29 offen offset:3072 sc1
    s_waitcnt vmcnt(11)
    v_mfma_f32_32x32x16_bf16 v[16:31], a[24:27], v[124:127], v[16:31]
    v_exp_f32 v238, v238
    v_fma_f32 v237, v237, v7, v7
    v_rcp_f32 v236, v236
    v_mfma_f32_32x32x16_bf16 v[32:47], a[28:31], v[124:127], v[32:47]
    v_mul_f32 v243, v235, v243
    v_exp_f32 v239, v239
    v_fma_f32 v238, v238, v7, v7
    s_add_u32 s28, s24, 14336
    buffer_load_dwordx4 v[164:167], v0, s[8:11], s28 offen offset:0 sc1
    s_waitcnt vmcnt(11)
    v_mfma_f32_32x32x16_bf16 v[48:63], a[24:27], v[128:131], v[48:63]
    v_rcp_f32 v237, v237
    v_mul_f32 v244, v236, v244
    v_cvt_pk_bf16_f32 v97, v242, v243
    v_fma_f32 v239, v239, v7, v7
    v_mfma_f32_32x32x16_bf16 v[64:79], a[28:31], v[128:131], v[64:79]
    v_rcp_f32 v238, v238
    v_mul_f32 v245, v237, v245
    s_add_u32 s29, s25, 14336
    buffer_load_dwordx4 v[168:171], v0, s[8:11], s29 offen offset:0 sc1
    s_waitcnt vmcnt(11)
    v_mfma_f32_32x32x16_bf16 v[16:31], a[96:99], v[132:135], v[16:31]
    v_rcp_f32 v239, v239
    v_mul_f32 v246, v238, v246
    v_cvt_pk_bf16_f32 v98, v244, v245
    v_mul_f32 v247, v239, v247
    v_mfma_f32_32x32x16_bf16 v[32:47], a[100:103], v[132:135], v[32:47]
    v_cvt_pk_bf16_f32 v99, v246, v247
    buffer_store_dwordx4 v[96:99], v0, s[8:11], s27 offen offset:0
    buffer_load_dwordx4 v[172:175], v0, s[8:11], s28 offen offset:1024 sc1
    s_waitcnt vmcnt(12)
    v_mfma_f32_32x32x16_bf16 v[48:63], a[96:99], v[136:139], v[48:63]
    v_mfma_f32_32x32x16_bf16 v[64:79], a[100:103], v[136:139], v[64:79]
    buffer_load_dwordx4 v[176:179], v0, s[8:11], s29 offen offset:1024 sc1
    s_waitcnt vmcnt(10)
    v_mfma_f32_32x32x16_bf16 v[16:31], a[104:107], v[140:143], v[16:31]
    v_mfma_f32_32x32x16_bf16 v[32:47], a[108:111], v[140:143], v[32:47]
    buffer_load_dwordx4 v[180:183], v0, s[8:11], s28 offen offset:2048 sc1
    s_waitcnt vmcnt(10)
    v_mfma_f32_32x32x16_bf16 v[48:63], a[104:107], v[144:147], v[48:63]
    v_mfma_f32_32x32x16_bf16 v[64:79], a[108:111], v[144:147], v[64:79]
    buffer_load_dwordx4 v[184:187], v0, s[8:11], s29 offen offset:2048 sc1
    s_waitcnt vmcnt(10)
    v_mfma_f32_32x32x16_bf16 v[16:31], a[72:75], v[148:151], v[16:31]
    v_mfma_f32_32x32x16_bf16 v[32:47], a[76:79], v[148:151], v[32:47]
    s_waitcnt vmcnt(4)
    v_mov_b32 v14, s36
    v_mov_b32 v15, 0
    s_cmp_lg_u32 s33, 0
    s_cbranch_scc1 Lps_91
    s_mov_b64 exec, 1
    buffer_store_dword v14, v15, s[8:11], s35 offen
    s_branch Lpd_92
Lps_91:
    s_waitcnt vmcnt(0)
    buffer_wbl2 sc1
    s_waitcnt vmcnt(0)
    s_mov_b64 exec, 1
    buffer_store_dword v14, v15, s[8:11], s35 offen sc1
Lpd_92:
    s_mov_b64 exec, -1
    buffer_load_dwordx4 v[188:191], v0, s[8:11], s28 offen offset:3072 sc1
    s_waitcnt vmcnt(11)
    v_mfma_f32_32x32x16_bf16 v[48:63], a[72:75], v[152:155], v[48:63]
    v_mfma_f32_32x32x16_bf16 v[64:79], a[76:79], v[152:155], v[64:79]
    buffer_load_dwordx4 v[192:195], v0, s[8:11], s29 offen offset:3072 sc1
    s_waitcnt vmcnt(11)
    v_mfma_f32_32x32x16_bf16 v[16:31], a[80:83], v[156:159], v[16:31]
    v_mfma_f32_32x32x16_bf16 v[32:47], a[84:87], v[156:159], v[32:47]
    s_add_u32 s28, s24, 21504
    buffer_load_dwordx4 v[196:199], v0, s[8:11], s28 offen offset:0 sc1
    s_waitcnt vmcnt(11)
    v_mfma_f32_32x32x16_bf16 v[48:63], a[80:83], v[160:163], v[48:63]
    v_mfma_f32_32x32x16_bf16 v[64:79], a[84:87], v[160:163], v[64:79]
    s_add_u32 s29, s25, 21504
    buffer_load_dwordx4 v[200:203], v0, s[8:11], s29 offen offset:0 sc1
    s_waitcnt vmcnt(11)
    v_mfma_f32_32x32x16_bf16 v[16:31], a[152:155], v[164:167], v[16:31]
    v_mfma_f32_32x32x16_bf16 v[32:47], a[156:159], v[164:167], v[32:47]
    buffer_load_dword v12, v13, s[8:11], s34 offen sc1
    buffer_load_dwordx4 v[204:207], v0, s[8:11], s28 offen offset:1024 sc1
    s_waitcnt vmcnt(12)
    v_mfma_f32_32x32x16_bf16 v[48:63], a[152:155], v[168:171], v[48:63]
    v_mfma_f32_32x32x16_bf16 v[64:79], a[156:159], v[168:171], v[64:79]
    buffer_load_dwordx4 v[208:211], v0, s[8:11], s29 offen offset:1024 sc1
    s_waitcnt vmcnt(11)
    v_mfma_f32_32x32x16_bf16 v[16:31], a[160:163], v[172:175], v[16:31]
    v_mfma_f32_32x32x16_bf16 v[32:47], a[164:167], v[172:175], v[32:47]
    buffer_load_dwordx4 v[212:215], v0, s[8:11], s28 offen offset:2048 sc1
    s_waitcnt vmcnt(11)
    v_mfma_f32_32x32x16_bf16 v[48:63], a[160:163], v[176:179], v[48:63]
    v_mfma_f32_32x32x16_bf16 v[64:79], a[164:167], v[176:179], v[64:79]
    buffer_load_dwordx4 v[216:219], v0, s[8:11], s29 offen offset:2048 sc1
    s_waitcnt vmcnt(11)
    v_mfma_f32_32x32x16_bf16 v[16:31], a[128:131], v[180:183], v[16:31]
    v_mfma_f32_32x32x16_bf16 v[32:47], a[132:135], v[180:183], v[32:47]
    buffer_load_dwordx4 v[220:223], v0, s[8:11], s28 offen offset:3072 sc1
    s_waitcnt vmcnt(11)
    v_mfma_f32_32x32x16_bf16 v[48:63], a[128:131], v[184:187], v[48:63]
    v_mfma_f32_32x32x16_bf16 v[64:79], a[132:135], v[184:187], v[64:79]
    buffer_load_dwordx4 v[224:227], v0, s[8:11], s29 offen offset:3072 sc1
    s_waitcnt vmcnt(10)
    v_mfma_f32_32x32x16_bf16 v[16:31], a[136:139], v[188:191], v[16:31]
    v_mfma_f32_32x32x16_bf16 v[32:47], a[140:143], v[188:191], v[32:47]
    s_sub_u32 s36, s36, 1
    s_waitcnt vmcnt(6)
    v_subrev_u32 v12, s36, v12
    v_cmp_lt_u32 vcc, 15, v12
    s_and_b64 vcc, vcc, s[42:43]
    s_or_b32 s30, vcc_lo, vcc_hi
    s_or_b32 s30, s30, s33
    s_cbranch_scc0 Lck_93
    s_mov_b64 exec, s[42:43]
Lw_94:
    s_add_u32 s39, s39, 1
    s_cmp_gt_u32 s39, 1048576
    s_cbranch_scc1 Lwx_95
    buffer_load_dword v14, v13, s[8:11], s34 offen sc1
    s_waitcnt vmcnt(0)
    v_subrev_u32 v14, s36, v14
    v_cmp_lt_u32 vcc, 15, v14
    s_cbranch_vccnz Lw_94
Lwx_95:
    s_mov_b64 exec, -1
    s_cmp_eq_u32 s33, 0
    s_cbranch_scc1 Lwf_96
    buffer_inv sc1
    s_waitcnt vmcnt(0)
Lwf_96:
Lck_93:
    s_add_u32 s36, s36, 1
    s_add_u32 s28, s24, 4096
    buffer_load_dwordx4 v[100:103], v0, s[8:11], s28 offen offset:0 sc1
    s_waitcnt vmcnt(10)
    v_mfma_f32_32x32x16_bf16 v[48:63], a[136:139], v[192:195], v[48:63]
    v_mfma_f32_32x32x16_bf16 v[64:79], a[140:143], v[192:195], v[64:79]
    s_add_u32 s29, s25, 4096
    buffer_load_dwordx4 v[104:107], v0, s[8:11], s29 offen offset:0 sc1
    s_waitcnt vmcnt(10)
    v_mfma_f32_32x32x16_bf16 v[16:31], a[208:211], v[196:199], v[16:31]
    v_mfma_f32_32x32x16_bf16 v[32:47], a[212:215], v[196:199], v[32:47]
    buffer_load_dwordx4 v[108:111], v0, s[8:11], s28 offen offset:1024 sc1
    s_waitcnt vmcnt(10)
    v_mfma_f32_32x32x16_bf16 v[48:63], a[208:211], v[200:203], v[48:63]
    v_mfma_f32_32x32x16_bf16 v[64:79], a[212:215], v[200:203], v[64:79]
    buffer_load_dwordx4 v[112:115], v0, s[8:11], s29 offen offset:1024 sc1
    s_waitcnt vmcnt(9)
    v_mfma_f32_32x32x16_bf16 v[16:31], a[216:219], v[204:207], v[16:31]
    v_mfma_f32_32x32x16_bf16 v[32:47], a[220:223], v[204:207], v[32:47]
    s_add_u32 s28, s24, 11264
    buffer_load_dwordx4 v[116:119], v0, s[8:11], s28 offen offset:0 sc1
    s_waitcnt vmcnt(9)
    v_mfma_f32_32x32x16_bf16 v[48:63], a[216:219], v[208:211], v[48:63]
    v_mfma_f32_32x32x16_bf16 v[64:79], a[220:223], v[208:211], v[64:79]
    s_add_u32 s29, s25, 11264
    buffer_load_dwordx4 v[120:123], v0, s[8:11], s29 offen offset:0 sc1
    s_waitcnt vmcnt(9)
    v_mfma_f32_32x32x16_bf16 v[16:31], a[184:187], v[212:215], v[16:31]
    v_mfma_f32_32x32x16_bf16 v[32:47], a[188:191], v[212:215], v[32:47]
    buffer_load_dwordx4 v[124:127], v0, s[8:11], s28 offen offset:1024 sc1
    s_waitcnt vmcnt(9)
    v_mfma_f32_32x32x16_bf16 v[48:63], a[184:187], v[216:219], v[48:63]
    v_mfma_f32_32x32x16_bf16 v[64:79], a[188:191], v[216:219], v[64:79]
    buffer_load_dwordx4 v[128:131], v0, s[8:11], s29 offen offset:1024 sc1
    s_waitcnt vmcnt(9)
    v_mfma_f32_32x32x16_bf16 v[16:31], a[192:195], v[220:223], v[16:31]
    v_mfma_f32_32x32x16_bf16 v[32:47], a[196:199], v[220:223], v[32:47]
    s_add_u32 s28, s24, 18432
    buffer_load_dwordx4 v[132:135], v0, s[8:11], s28 offen offset:0 sc1
    s_waitcnt vmcnt(9)
    v_mfma_f32_32x32x16_bf16 v[48:63], a[192:195], v[224:227], v[48:63]
    v_mfma_f32_32x32x16_bf16 v[64:79], a[196:199], v[224:227], v[64:79]
    s_add_u32 s29, s25, 18432
    buffer_load_dwordx4 v[136:139], v0, s[8:11], s29 offen offset:0 sc1
    s_waitcnt vmcnt(9)
    v_mfma_f32_32x32x16_bf16 v[16:31], a[32:35], v[100:103], v[16:31]
    v_mfma_f32_32x32x16_bf16 v[32:47], a[36:39], v[100:103], v[32:47]
    buffer_load_dword v12, v13, s[8:11], s34 offen sc1
    buffer_load_dwordx4 v[140:143], v0, s[8:11], s28 offen offset:1024 sc1
    s_waitcnt vmcnt(10)
    v_mfma_f32_32x32x16_bf16 v[48:63], a[32:35], v[104:107], v[48:63]
    v_mfma_f32_32x32x16_bf16 v[64:79], a[36:39], v[104:107], v[64:79]
    buffer_load_dwordx4 v[144:147], v0, s[8:11], s29 offen offset:1024 sc1
    s_waitcnt vmcnt(10)
    v_mfma_f32_32x32x16_bf16 v[16:31], a[0:3], v[108:111], v[16:31]
    v_mfma_f32_32x32x16_bf16 v[32:47], a[4:7], v[108:111], v[32:47]
    s_add_u32 s28, s24, 25600
    buffer_load_dwordx4 v[148:151], v0, s[8:11], s28 offen offset:0 sc1
    s_waitcnt vmcnt(10)
    v_mfma_f32_32x32x16_bf16 v[48:63], a[0:3], v[112:115], v[48:63]
    v_mfma_f32_32x32x16_bf16 v[64:79], a[4:7], v[112:115], v[64:79]
    s_add_u32 s29, s25, 25600
    buffer_load_dwordx4 v[152:155], v0, s[8:11], s29 offen offset:0 sc1
    s_waitcnt vmcnt(10)
    v_mfma_f32_32x32x16_bf16 v[16:31], a[88:91], v[116:119], v[16:31]
    v_mfma_f32_32x32x16_bf16 v[32:47], a[92:95], v[116:119], v[32:47]
    buffer_load_dwordx4 v[156:159], v0, s[8:11], s28 offen offset:1024 sc1
    s_waitcnt vmcnt(10)
    v_mfma_f32_32x32x16_bf16 v[48:63], a[88:91], v[120:123], v[48:63]
    v_mfma_f32_32x32x16_bf16 v[64:79], a[92:95], v[120:123], v[64:79]
    buffer_load_dwordx4 v[160:163], v0, s[8:11], s29 offen offset:1024 sc1
    s_waitcnt vmcnt(10)
    v_mfma_f32_32x32x16_bf16 v[16:31], a[56:59], v[124:127], v[16:31]
    v_mfma_f32_32x32x16_bf16 v[32:47], a[60:63], v[124:127], v[32:47]
    s_waitcnt vmcnt(6)
    v_subrev_u32 v12, s36, v12
    v_cmp_lt_u32 vcc, 15, v12
    s_and_b64 vcc, vcc, s[42:43]
    s_or_b32 s30, vcc_lo, vcc_hi
    s_or_b32 s30, s30, s33
    s_cbranch_scc0 Lck_97
    s_mov_b64 exec, s[42:43]
Lw_98:
    s_add_u32 s39, s39, 1
    s_cmp_gt_u32 s39, 1048576
    s_cbranch_scc1 Lwx_99
    buffer_load_dword v14, v13, s[8:11], s34 offen sc1
    s_waitcnt vmcnt(0)
    v_subrev_u32 v14, s36, v14
    v_cmp_lt_u32 vcc, 15, v14
    s_cbranch_vccnz Lw_98
Lwx_99:
    s_mov_b64 exec, -1
    s_cmp_eq_u32 s33, 0
    s_cbranch_scc1 Lwf_100
    buffer_inv sc1
    s_waitcnt vmcnt(0)
Lwf_100:
Lck_97:
    s_add_u32 s36, s36, 1
    s_add_u32 s28, s24, 6144
    buffer_load_dwordx4 v[164:167], v0, s[8:11], s28 offen offset:0 sc1
    s_waitcnt vmcnt(10)
    v_mfma_f32_32x32x16_bf16 v[48:63], a[56:59], v[128:131], v[48:63]
    v_mfma_f32_32x32x16_bf16 v[64:79], a[60:63], v[128:131], v[64:79]
    s_add_u32 s29, s25, 6144
    buffer_load_dwordx4 v[168:171], v0, s[8:11], s29 offen offset:0 sc1
    s_waitcnt vmcnt(10)
    v_mfma_f32_32x32x16_bf16 v[16:31], a[144:147], v[132:135], v[16:31]
    v_mfma_f32_32x32x16_bf16 v[32:47], a[148:151], v[132:135], v[32:47]
    s_add_u32 s28, s24, 13312
    buffer_load_dwordx4 v[172:175], v0, s[8:11], s28 offen offset:0 sc1
    s_waitcnt vmcnt(10)
    v_mfma_f32_32x32x16_bf16 v[48:63], a[144:147], v[136:139], v[48:63]
    v_mfma_f32_32x32x16_bf16 v[64:79], a[148:151], v[136:139], v[64:79]
    s_add_u32 s29, s25, 13312
    buffer_load_dwordx4 v[176:179], v0, s[8:11], s29 offen offset:0 sc1
    s_xor_b32 s30, s3, 0
    s_mul_i32 s30, s30, 12288
    v_add_u32 v5, s30, v0
    s_xor_b32 s30, s3, 1
    s_mul_i32 s30, s30, 12288
    v_add_u32 v6, s30, v0
    s_xor_b32 s30, s3, 2
    s_mul_i32 s30, s30, 12288
    v_add_u32 v7, s30, v0
    s_xor_b32 s30, s3, 3
    s_mul_i32 s30, s30, 12288
    v_add_u32 v8, s30, v0
    s_waitcnt vmcnt(9)
    v_mfma_f32_32x32x16_bf16 v[16:31], a[112:115], v[140:143], v[16:31]
    v_mfma_f32_32x32x16_bf16 v[32:47], a[116:119], v[140:143], v[32:47]
    s_add_u32 s28, s24, 20480
    buffer_load_dwordx4 v[180:183], v0, s[8:11], s28 offen offset:0 sc1
    s_waitcnt vmcnt(9)
    v_mfma_f32_32x32x16_bf16 v[48:63], a[112:115], v[144:147], v[48:63]
    v_mfma_f32_32x32x16_bf16 v[64:79], a[116:119], v[144:147], v[64:79]
    s_add_u32 s29, s25, 20480
    buffer_load_dwordx4 v[184:187], v0, s[8:11], s29 offen offset:0 sc1
    s_waitcnt vmcnt(9)
    v_mfma_f32_32x32x16_bf16 v[16:31], a[200:203], v[148:151], v[16:31]
    v_mfma_f32_32x32x16_bf16 v[32:47], a[204:207], v[148:151], v[32:47]
    s_add_u32 s28, s24, 27648
    buffer_load_dwordx4 v[188:191], v0, s[8:11], s28 offen offset:0 sc1
    s_waitcnt vmcnt(9)
    v_mfma_f32_32x32x16_bf16 v[48:63], a[200:203], v[152:155], v[48:63]
    v_mfma_f32_32x32x16_bf16 v[64:79], a[204:207], v[152:155], v[64:79]
    s_add_u32 s29, s25, 27648
    buffer_load_dwordx4 v[192:195], v0, s[8:11], s29 offen offset:0 sc1
    s_waitcnt vmcnt(9)
    v_mfma_f32_32x32x16_bf16 v[16:31], a[168:171], v[156:159], v[16:31]
    v_mfma_f32_32x32x16_bf16 v[32:47], a[172:175], v[156:159], v[32:47]
    s_waitcnt vmcnt(8)
    v_mfma_f32_32x32x16_bf16 v[48:63], a[168:171], v[160:163], v[48:63]
    v_mfma_f32_32x32x16_bf16 v[64:79], a[172:175], v[160:163], v[64:79]
    s_waitcnt vmcnt(7)
    v_mfma_f32_32x32x16_bf16 v[16:31], a[8:11], v[164:167], v[16:31]
    v_mfma_f32_32x32x16_bf16 v[32:47], a[12:15], v[164:167], v[32:47]
    s_waitcnt vmcnt(6)
    v_mfma_f32_32x32x16_bf16 v[48:63], a[8:11], v[168:171], v[48:63]
    v_mfma_f32_32x32x16_bf16 v[64:79], a[12:15], v[168:171], v[64:79]
    s_waitcnt vmcnt(5)
    v_mfma_f32_32x32x16_bf16 v[16:31], a[64:67], v[172:175], v[16:31]
    v_mfma_f32_32x32x16_bf16 v[32:47], a[68:71], v[172:175], v[32:47]
    s_waitcnt vmcnt(4)
    v_mfma_f32_32x32x16_bf16 v[48:63], a[64:67], v[176:179], v[48:63]
    v_mfma_f32_32x32x16_bf16 v[64:79], a[68:71], v[176:179], v[64:79]
    s_waitcnt vmcnt(3)
    v_mfma_f32_32x32x16_bf16 v[16:31], a[120:123], v[180:183], v[16:31]
    v_mfma_f32_32x32x16_bf16 v[32:47], a[124:127], v[180:183], v[32:47]
    s_waitcnt vmcnt(2)
    v_mfma_f32_32x32x16_bf16 v[48:63], a[120:123], v[184:187], v[48:63]
    v_mfma_f32_32x32x16_bf16 v[64:79], a[124:127], v[184:187], v[64:79]
    s_waitcnt vmcnt(1)
    v_mfma_f32_32x32x16_bf16 v[16:31], a[176:179], v[188:191], v[16:31]
    v_mfma_f32_32x32x16_bf16 v[32:47], a[180:183], v[188:191], v[32:47]
    s_waitcnt vmcnt(0)
    v_mfma_f32_32x32x16_bf16 v[48:63], a[176:179], v[192:195], v[48:63]
    v_mfma_f32_32x32x16_bf16 v[64:79], a[180:183], v[192:195], v[64:79]
    s_nop 5
    ds_write_b128 v6, v[32:35] offset:0
    ds_write_b128 v6, v[36:39] offset:1024
    ds_write_b128 v6, v[40:43] offset:2048
    ds_write_b128 v6, v[44:47] offset:3072
    ds_write_b128 v7, v[48:51] offset:4096
    ds_write_b128 v7, v[52:55] offset:5120
    ds_write_b128 v7, v[56:59] offset:6144
    ds_write_b128 v7, v[60:63] offset:7168
    s_nop 3
    ds_write_b128 v8, v[64:67] offset:8192
    ds_write_b128 v8, v[68:71] offset:9216
    ds_write_b128 v8, v[72:75] offset:10240
    ds_write_b128 v8, v[76:79] offset:11264
    s_waitcnt lgkmcnt(0)
    s_barrier
    ds_read_b128 v[32:35], v5 offset:0
    ds_read_b128 v[36:39], v5 offset:1024
    ds_read_b128 v[40:43], v5 offset:2048
    ds_read_b128 v[44:47], v5 offset:3072
    ds_read_b128 v[48:51], v5 offset:4096
    ds_read_b128 v[52:55], v5 offset:5120
    ds_read_b128 v[56:59], v5 offset:6144
    ds_read_b128 v[60:63], v5 offset:7168
    ds_read_b128 v[64:67], v5 offset:8192
    ds_read_b128 v[68:71], v5 offset:9216
    ds_read_b128 v[72:75], v5 offset:10240
    ds_read_b128 v[76:79], v5 offset:11264
    s_add_u32 s24, s47, 5809152
    s_mul_i32 s25, s45, 3584
    s_lshl_b32 s48, s46, 8
    s_add_u32 s25, s25, s48
    s_add_u32 s25, s25, 7644160
    s_waitcnt lgkmcnt(8)
    v_pk_add_f32 v[16:17], v[16:17], v[32:33]
    v_pk_add_f32 v[18:19], v[18:19], v[34:35]
    v_pk_add_f32 v[20:21], v[20:21], v[36:37]
    v_pk_add_f32 v[22:23], v[22:23], v[38:39]
    v_pk_add_f32 v[24:25], v[24:25], v[40:41]
    v_pk_add_f32 v[26:27], v[26:27], v[42:43]
    v_pk_add_f32 v[28:29], v[28:29], v[44:45]
    v_pk_add_f32 v[30:31], v[30:31], v[46:47]
    s_waitcnt lgkmcnt(4)
    v_pk_add_f32 v[16:17], v[16:17], v[48:49]
    v_pk_add_f32 v[18:19], v[18:19], v[50:51]
    v_pk_add_f32 v[20:21], v[20:21], v[52:53]
    v_pk_add_f32 v[22:23], v[22:23], v[54:55]
    v_pk_add_f32 v[24:25], v[24:25], v[56:57]
    v_pk_add_f32 v[26:27], v[26:27], v[58:59]
    v_pk_add_f32 v[28:29], v[28:29], v[60:61]
    v_pk_add_f32 v[30:31], v[30:31], v[62:63]
    s_waitcnt lgkmcnt(0)
    v_pk_add_f32 v[16:17], v[16:17], v[64:65]
    v_pk_add_f32 v[18:19], v[18:19], v[66:67]
    v_pk_add_f32 v[20:21], v[20:21], v[68:69]
    v_pk_add_f32 v[22:23], v[22:23], v[70:71]
    v_pk_add_f32 v[24:25], v[24:25], v[72:73]
    v_pk_add_f32 v[26:27], v[26:27], v[74:75]
    v_pk_add_f32 v[28:29], v[28:29], v[76:77]
    v_pk_add_f32 v[30:31], v[30:31], v[78:79]
    v_cvt_pk_bf16_f32 v80, v16, v17
    v_cvt_pk_bf16_f32 v81, v18, v19
    v_cvt_pk_bf16_f32 v82, v20, v21
    v_cvt_pk_bf16_f32 v83, v22, v23
    v_cvt_pk_bf16_f32 v84, v24, v25
    v_cvt_pk_bf16_f32 v85, v26, v27
    v_cvt_pk_bf16_f32 v86, v28, v29
    v_cvt_pk_bf16_f32 v87, v30, v31
    s_mul_i32 s24, s45, 28672
    s_lshl_b32 s25, s46, 6
    s_add_u32 s24, s24, s25
    v_mul_u32_u24 v5, 896, v1
    v_lshl_add_u32 v5, v2, 4, v5
    v_permlane32_swap_b32 v80, v82
    v_permlane32_swap_b32 v81, v83
    v_permlane32_swap_b32 v84, v86
    v_permlane32_swap_b32 v85, v87
    buffer_store_dwordx4 v[80:83], v5, s[12:15], s24 offen
    buffer_store_dwordx4 v[84:87], v5, s[12:15], s24 offen offset:32
Lskip_83:
    s_branch Lend_1
Lretry_5:
    s_waitcnt vmcnt(0)
    v_mov_b32 v80, 0xff800000
    v_mov_b32 v81, 0xff800000
    v_mov_b32 v82, 0xff800000
    v_mov_b32 v83, 0xff800000
    s_mov_b32 s26, 0
    s_mov_b32 s28, 16
Lmax_101:
    buffer_load_dwordx4 v[160:163], v0, s[20:23], s26 offen offset:0
    buffer_load_dwordx4 v[164:167], v0, s[20:23], s26 offen offset:1024
    s_add_u32 s26, s26, 4096
    s_waitcnt vmcnt(0)
    v_mfma_f32_32x32x16_bf16 v[48:63], v[160:163], v[16:19], 0
    v_mfma_f32_32x32x16_bf16 v[48:63], v[164:167], v[20:23], v[48:63]
    s_nop 12
    v_max3_f32 v80, v48, v49, v80
    v_max3_f32 v80, v50, v51, v80
    v_max3_f32 v80, v52, v53, v80
    v_max3_f32 v80, v54, v55, v80
    v_max3_f32 v80, v56, v57, v80
    v_max3_f32 v80, v58, v59, v80
    v_max3_f32 v80, v60, v61, v80
    v_max3_f32 v80, v62, v63, v80
    v_mfma_f32_32x32x16_bf16 v[48:63], v[160:163], v[24:27], 0
    v_mfma_f32_32x32x16_bf16 v[48:63], v[164:167], v[28:31], v[48:63]
    s_nop 12
    v_max3_f32 v81, v48, v49, v81
    v_max3_f32 v81, v50, v51, v81
    v_max3_f32 v81, v52, v53, v81
    v_max3_f32 v81, v54, v55, v81
    v_max3_f32 v81, v56, v57, v81
    v_max3_f32 v81, v58, v59, v81
    v_max3_f32 v81, v60, v61, v81
    v_max3_f32 v81, v62, v63, v81
    v_mfma_f32_32x32x16_bf16 v[48:63], v[160:163], v[32:35], 0
    v_mfma_f32_32x32x16_bf16 v[48:63], v[164:167], v[36:39], v[48:63]
    s_nop 12
    v_max3_f32 v82, v48, v49, v82
    v_max3_f32 v82, v50, v51, v82
    v_max3_f32 v82, v52, v53, v82
    v_max3_f32 v82, v54, v55, v82
    v_max3_f32 v82, v56, v57, v82
    v_max3_f32 v82, v58, v59, v82
    v_max3_f32 v82, v60, v61, v82
    v_max3_f32 v82, v62, v63, v82
    v_mfma_f32_32x32x16_bf16 v[48:63], v[160:163], v[40:43], 0
    v_mfma_f32_32x32x16_bf16 v[48:63], v[164:167], v[44:47], v[48:63]
    s_nop 12
    v_max3_f32 v83, v48, v49, v83
    v_max3_f32 v83, v50, v51, v83
    v_max3_f32 v83, v52, v53, v83
    v_max3_f32 v83, v54, v55, v83
    v_max3_f32 v83, v56, v57, v83
    v_max3_f32 v83, v58, v59, v83
    v_max3_f32 v83, v60, v61, v83
    v_max3_f32 v83, v62, v63, v83
    s_sub_u32 s28, s28, 1
    s_cmp_lg_u32 s28, 0
    s_cbranch_scc1 Lmax_101
    s_lshl_b32 s24, s3, 8
    v_add_u32 v6, s24, v13
    v_lshlrev_b32 v7, 2, v1
    s_add_u32 s30, s3, 0
    s_and_b32 s30, s30, 3
    s_mul_i32 s30, s30, 1024
    v_add_u32 v5, s30, v6
    ds_write_b32 v5, v80 offset:49152
    s_add_u32 s30, s3, 1
    s_and_b32 s30, s30, 3
    s_mul_i32 s30, s30, 1024
    v_add_u32 v5, s30, v6
    ds_write_b32 v5, v81 offset:49152
    s_add_u32 s30, s3, 2
    s_and_b32 s30, s30, 3
    s_mul_i32 s30, s30, 1024
    v_add_u32 v5, s30, v6
    ds_write_b32 v5, v82 offset:49152
    s_add_u32 s30, s3, 3
    s_and_b32 s30, s30, 3
    s_mul_i32 s30, s30, 1024
    v_add_u32 v5, s30, v6
    ds_write_b32 v5, v83 offset:49152
    s_waitcnt lgkmcnt(0)
    s_barrier
    s_add_u32 s30, s3, 0
    s_and_b32 s30, s30, 3
    s_mul_i32 s30, s30, 1024
    v_add_u32 v5, s30, v7
    ds_read_b32 v48, v5 offset:49152
    ds_read_b32 v49, v5 offset:49280
    ds_read_b32 v50, v5 offset:49408
    ds_read_b32 v51, v5 offset:49536
    ds_read_b32 v52, v5 offset:49664
    ds_read_b32 v53, v5 offset:49792
    ds_read_b32 v54, v5 offset:49920
    ds_read_b32 v55, v5 offset:50048
    s_waitcnt lgkmcnt(0)
    v_max3_f32 v48, v49, v50, v48
    v_max3_f32 v48, v51, v52, v48
    v_max3_f32 v48, v53, v54, v48
    v_max_f32 v48, v48, v55
    v_sub_f32 v8, 0, v48
    v_and_b32 v9, 0xffff0000, v8
    v_sub_f32 v8, v8, v9
    v_and_b32 v10, 0xffff0000, v8
    v_sub_f32 v8, v8, v10
    v_lshrrev_b32 v9, 16, v9
    s_mov_b32 exec_lo, 0
    v_or_b32 v22, v9, v10
    v_lshrrev_b32 v23, 16, v8
    s_mov_b32 exec_lo, -1
    s_add_u32 s30, s3, 1
    s_and_b32 s30, s30, 3
    s_mul_i32 s30, s30, 1024
    v_add_u32 v5, s30, v7
    ds_read_b32 v48, v5 offset:49152
    ds_read_b32 v49, v5 offset:49280
    ds_read_b32 v50, v5 offset:49408
    ds_read_b32 v51, v5 offset:49536
    ds_read_b32 v52, v5 offset:49664
    ds_read_b32 v53, v5 offset:49792
    ds_read_b32 v54, v5 offset:49920
    ds_read_b32 v55, v5 offset:50048
    s_waitcnt lgkmcnt(0)
    v_max3_f32 v48, v49, v50, v48
    v_max3_f32 v48, v51, v52, v48
    v_max3_f32 v48, v53, v54, v48
    v_max_f32 v48, v48, v55
    v_sub_f32 v8, 0, v48
    v_and_b32 v9, 0xffff0000, v8
    v_sub_f32 v8, v8, v9
    v_and_b32 v10, 0xffff0000, v8
    v_sub_f32 v8, v8, v10
    v_lshrrev_b32 v9, 16, v9
    s_mov_b32 exec_lo, 0
    v_or_b32 v30, v9, v10
    v_lshrrev_b32 v31, 16, v8
    s_mov_b32 exec_lo, -1
    s_add_u32 s30, s3, 2
    s_and_b32 s30, s30, 3
    s_mul_i32 s30, s30, 1024
    v_add_u32 v5, s30, v7
    ds_read_b32 v48, v5 offset:49152
    ds_read_b32 v49, v5 offset:49280
    ds_read_b32 v50, v5 offset:49408
    ds_read_b32 v51, v5 offset:49536
    ds_read_b32 v52, v5 offset:49664
    ds_read_b32 v53, v5 offset:49792
    ds_read_b32 v54, v5 offset:49920
    ds_read_b32 v55, v5 offset:50048
    s_waitcnt lgkmcnt(0)
    v_max3_f32 v48, v49, v50, v48
    v_max3_f32 v48, v51, v52, v48
    v_max3_f32 v48, v53, v54, v48
    v_max_f32 v48, v48, v55
    v_sub_f32 v8, 0, v48
    v_and_b32 v9, 0xffff0000, v8
    v_sub_f32 v8, v8, v9
    v_and_b32 v10, 0xffff0000, v8
    v_sub_f32 v8, v8, v10
    v_lshrrev_b32 v9, 16, v9
    s_mov_b32 exec_lo, 0
    v_or_b32 v38, v9, v10
    v_lshrrev_b32 v39, 16, v8
    s_mov_b32 exec_lo, -1
    s_add_u32 s30, s3, 3
    s_and_b32 s30, s30, 3
    s_mul_i32 s30, s30, 1024
    v_add_u32 v5, s30, v7
    ds_read_b32 v48, v5 offset:49152
    ds_read_b32 v49, v5 offset:49280
    ds_read_b32 v50, v5 offset:49408
    ds_read_b32 v51, v5 offset:49536
    ds_read_b32 v52, v5 offset:49664
    ds_read_b32 v53, v5 offset:49792
    ds_read_b32 v54, v5 offset:49920
    ds_read_b32 v55, v5 offset:50048
    s_waitcnt lgkmcnt(0)
    v_max3_f32 v48, v49, v50, v48
    v_max3_f32 v48, v51, v52, v48
    v_max3_f32 v48, v53, v54, v48
    v_max_f32 v48, v48, v55
    v_sub_f32 v8, 0, v48
    v_and_b32 v9, 0xffff0000, v8
    v_sub_f32 v8, v8, v9
    v_and_b32 v10, 0xffff0000, v8
    v_sub_f32 v8, v8, v10
    v_lshrrev_b32 v9, 16, v9
    s_mov_b32 exec_lo, 0
    v_or_b32 v46, v9, v10
    v_lshrrev_b32 v47, 16, v8
    s_mov_b32 exec_lo, -1
    s_barrier
    s_mov_b32 s26, 0
    buffer_load_dwordx4 v[160:163], v0, s[20:23], s26 offen offset:0
    buffer_load_dwordx4 v[164:167], v0, s[20:23], s26 offen offset:1024
    s_mov_b32 s27, 0
    buffer_load_dwordx4 v[168:171], v0, s[20:23], s27 offen offset:2048
    buffer_load_dwordx4 v[172:175], v0, s[20:23], s27 offen offset:3072
    s_mov_b32 s26, 4096
    buffer_load_dwordx4 v[176:179], v0, s[20:23], s26 offen offset:0
    buffer_load_dwordx4 v[180:183], v0, s[20:23], s26 offen offset:1024
    s_mov_b32 s27, 4096
    buffer_load_dwordx4 v[184:187], v0, s[20:23], s27 offen offset:2048
    buffer_load_dwordx4 v[188:191], v0, s[20:23], s27 offen offset:3072
    s_mov_b32 s26, 8192
    buffer_load_dwordx4 v[192:195], v0, s[20:23], s26 offen offset:0
    buffer_load_dwordx4 v[196:199], v0, s[20:23], s26 offen offset:1024
    s_mov_b32 s27, 8192
    buffer_load_dwordx4 v[200:203], v0, s[20:23], s27 offen offset:2048
    buffer_load_dwordx4 v[204:207], v0, s[20:23], s27 offen offset:3072
    s_mov_b32 s26, 12288
    buffer_load_dwordx4 v[208:211], v0, s[20:23], s26 offen offset:0
    buffer_load_dwordx4 v[212:215], v0, s[20:23], s26 offen offset:1024
    s_mov_b32 s29, 1
    s_branch Lagain_4
Lend_1:
    s_or_b32 s25, s2, s3
    s_cbranch_scc1 Lne_19
    s_add_u32 s56, s56, 1
    v_mov_b32 v14, s56
    v_mov_b32 v15, 0
    s_mov_b32 s25, 15766528
    s_mov_b64 exec, 1
    buffer_store_dword v14, v15, s[8:11], s25 offen sc1
    s_mov_b64 exec, -1
Lne_19:
Lfin_2:
    s_endpgm
Lcode_end:
.section .rodata,"a"
.p2align 6
.amdhsa_kernel interleave_layers__grouped_kv_mqa__glu_gated_glu__prompt_kernel
  .amdhsa_next_free_vgpr 512
  .amdhsa_next_free_sgpr 102
  .amdhsa_accum_offset 256
  .amdhsa_group_segment_fixed_size 0
  .amdhsa_kernarg_size 96
  .amdhsa_user_sgpr_count 2
  .amdhsa_user_sgpr_kernarg_segment_ptr 1
  .amdhsa_system_sgpr_workgroup_id_x 1
.end_amdhsa_kernel
```
